```python
import torch

def _softmax(x, axis=-1):
    return torch.softmax(x, dim=axis)
def _gelu(x):
    return torch.nn.functional.gelu(x, approximate="tanh")
def _silu(x):
    return torch.nn.functional.silu(x)
def _sigmoid(x):
    return torch.sigmoid(x)
def _layernorm(x, axis=-1, eps=1e-5):
    m = x.mean(dim=axis, keepdim=True)
    v = x.var(dim=axis, keepdim=True, unbiased=False)
    return (x - m) / torch.sqrt(v + eps)
def _scatter_add(tgt, idx, src, axis=0):
    return tgt.clone().index_add_(axis, idx, src)
def _segment_sum(src, seg, n):
    out = torch.zeros((n,) + src.shape[1:], dtype=src.dtype)
    return out.index_add_(0, seg, src)
def _pad(x, pw):
    flat = tuple(v for pair in reversed(pw) for v in pair)
    return torch.nn.functional.pad(x, flat)

kernel_name = 'parallel_sum__sliding_block__swiglu_ffn__prompt'

def setup_inputs():

    _w = (lambda a: (lambda t: t.to(torch.bfloat16) if t.is_floating_point() else t)(torch.as_tensor(a)))
    def _A_setup():
        B, S, D = 1, 2048, 512
        return {
            "x": _w((lambda *s: torch.randn(*s, dtype=torch.bfloat16) * 0.05)(B, S, D)),
            "wqkv": _w((lambda *s: torch.randn(*s, dtype=torch.bfloat16) * 0.05)(D, 3 * D)),
            "wo": _w((lambda *s: torch.randn(*s, dtype=torch.bfloat16) * 0.1)(D, D)),
        }
    _A_in = _A_setup()

    def _B_setup():
        B, S, D, F = 1, 2048, 512, 1792
        return {
            "x": _w((lambda *s: torch.randn(*s, dtype=torch.bfloat16) * 0.05)(B, S, D)),
            "w_gate": _w((lambda *s: torch.randn(*s, dtype=torch.bfloat16) * 0.05)(D, F)),
            "w_up": _w((lambda *s: torch.randn(*s, dtype=torch.bfloat16) * 0.05)(D, F)),
            "w_down": _w((lambda *s: torch.randn(*s, dtype=torch.bfloat16) * 0.05)(F, D)),
        }
    _B_in = _B_setup()

    return {
        "A_x": _A_in["x"],
        "A_wqkv": _A_in["wqkv"],
        "A_wo": _A_in["wo"],
        "B_x": _B_in["x"],
        "B_w_gate": _B_in["w_gate"],
        "B_w_up": _B_in["w_up"],
        "B_w_down": _B_in["w_down"],
    }

def reference(A_x, A_wqkv, A_wo, B_x, B_w_gate, B_w_up, B_w_down):
    def _A_ref(x, wqkv, wo):
        B, S, D = x.shape
        H = 32; Dh = D // H; W = 256
        qkv = (lambda x, *d: x.permute(*d))((x @ wqkv).reshape(B, S, 3, H, Dh), 2, 0, 3, 1, 4)
        q, k, v = qkv[0], qkv[1], qkv[2]
        scores = torch.einsum("bhqd,bhkd->bhqk", q, k) * (Dh ** -0.5)
        idx = torch.arange(S)
        mask = (idx[:, None] - idx[None, :] >= 0) & (idx[:, None] - idx[None, :] < W)
        scores = torch.where(mask[None, None], scores, -1e9)
        p = _softmax(scores, axis=-1)
        o = torch.einsum("bhqk,bhkd->bhqd", p, v)
        return (lambda x, *d: x.permute(*d))(o, 0, 2, 1, 3).reshape(B, S, D) @ wo

    def _B_ref(x, w_gate, w_up, w_down):
        g = _silu(x @ w_gate)
        u = x @ w_up
        return (g * u) @ w_down

    x = A_x
    xn = _layernorm(x, axis=-1)
    return x + _A_ref(xn, A_wqkv, A_wo) + _B_ref(xn, B_w_gate, B_w_up, B_w_down)
```

```asm
; @launch grid=(256,1,1) block=(256,1,1) lds=163840
.amdgcn_target "amdgcn-amd-amdhsa--gfx950"
.text
.globl parallel_sum__sliding_block__swiglu_ffn__prompt_kernel
.p2align 8
.type parallel_sum__sliding_block__swiglu_ffn__prompt_kernel,@function
parallel_sum__sliding_block__swiglu_ffn__prompt_kernel:
    s_cmp_ge_u32 s2, 256
    s_cbranch_scc1 L_end
    s_load_dwordx4 s[4:7], s[0:1], 0
    s_load_dwordx2 s[48:49], s[0:1], 72
    s_load_dwordx4 s[64:67], s[0:1], 32
    s_load_dwordx4 s[68:71], s[0:1], 48
    s_load_dwordx2 s[72:73], s[0:1], 16
    s_load_dwordx2 s[74:75], s[0:1], 64
    s_getpc_b64 s[100:101]
L_pc:
    v_and_b32 v1, 63, v0
    s_lshr_b32 s3, s2, 3
    s_lshl_b32 s3, s3, 11
    s_sub_u32 s3, s3, 6144
    v_lshlrev_b32 v6, 7, v1
    v_cmp_lt_u32 vcc, 47, v1
    v_mov_b32 v7, s3
    v_mov_b32 v9, s101
    v_cndmask_b32 v7, 0, v7, vcc
    v_add_u32 v6, v6, v7
    v_min_u32 v6, 0xbde8, v6
    v_add_co_u32 v8, vcc, s100, v6
    s_nop 1
    v_addc_co_u32 v9, vcc, 0, v9, vcc
    v_cmp_gt_u32 vcc, 64, v0
    s_nop 0
    s_and_saveexec_b64 s[88:89], vcc
    s_cbranch_execz L_pf0
    global_load_dword v27, v[8:9], off
L_pf0:
    s_mov_b64 exec, -1
    v_lshrrev_b32 v3, 6, v0
    v_and_b32 v1, 63, v0
    v_readfirstlane_b32 s24, v3
    s_and_b32 s3, s2, 7
    s_lshr_b32 s35, s2, 3
    s_and_b32 s25, s3, 1
    s_lshl_b32 s25, s25, 3
    s_and_b32 s34, s35, 7
    s_add_u32 s25, s25, s34
    s_lshr_b32 s29, s35, 3
    s_add_u32 s30, s25, s29
    s_and_b32 s30, s30, 3
    s_lshl_b32 s28, s25, 2
    s_add_u32 s28, s28, s24
    v_lshrrev_b32 v6, 3, v1
    v_and_b32 v7, 7, v1
    v_lshrrev_b32 v8, 4, v1
    v_xor_b32 v7, v7, v8
    v_lshlrev_b32 v7, 4, v7
    v_lshl_add_u32 v56, v6, 10, v7
    v_xor_b32 v57, 64, v56
    v_add_u32 v57, 7168, v57
    v_add_u32 v58, 14336, v56
    v_add_u32 v59, 14336, v57
    s_lshl_b32 s76, s28, 15
    s_lshl_b32 s77, s24, 15
    s_add_u32 s77, s77, 32768
    s_lshl_b32 s78, s30, 8
    s_waitcnt lgkmcnt(0)
    s_mov_b32 s8, s4
    s_mov_b32 s9, s5
    s_mov_b32 s10, 0x200000
    s_mov_b32 s11, 0x20000
    s_add_u32 m0, s77, 0
    s_add_u32 s79, s78, 0
    s_and_b32 s79, s79, 1023
    s_add_u32 s79, s79, s76
    buffer_load_dwordx4 v56, s[8:11], s79 offen offset:0 lds
    buffer_load_dwordx4 v57, s[8:11], s79 offen offset:1024 lds
    buffer_load_dwordx4 v58, s[8:11], s79 offen offset:2048 lds
    buffer_load_dwordx4 v59, s[8:11], s79 offen offset:3072 lds
    s_add_u32 m0, s77, 4096
    s_add_u32 s79, s78, 128
    s_and_b32 s79, s79, 1023
    s_add_u32 s79, s79, s76
    buffer_load_dwordx4 v56, s[8:11], s79 offen offset:0 lds
    buffer_load_dwordx4 v57, s[8:11], s79 offen offset:1024 lds
    buffer_load_dwordx4 v58, s[8:11], s79 offen offset:2048 lds
    buffer_load_dwordx4 v59, s[8:11], s79 offen offset:3072 lds
    s_mov_b32 s12, s6
    s_mov_b32 s13, s7
    s_mov_b32 s14, 0x180000
    s_mov_b32 s15, 0x20000
    s_mov_b32 s20, s48
    s_mov_b32 s21, s49
    s_mov_b32 s22, 0x1700000
    s_mov_b32 s23, 0x20000
    s_lshr_b32 s27, s3, 1
    s_lshl_b32 s26, s27, 1
    s_lshl_b32 s27, s27, 2
    s_add_u32 s27, s27, s29
    s_and_b32 s4, s29, 1
    s_add_u32 s26, s26, s4
    s_lshr_b32 s29, s29, 1
    s_lshl_b32 s27, s26, 1
    s_add_u32 s27, s27, s29
    s_and_b32 s4, s3, 1
    s_lshl_b32 s4, s4, 4
    s_lshr_b32 s31, s3, 1
    s_lshl_b32 s31, s31, 2
    s_add_u32 s31, s31, s4
    s_and_b32 s4, s35, 3
    s_add_u32 s31, s31, s4
    s_lshr_b32 s32, s35, 2
    s_cmp_ge_u32 s24, 2
    s_cselect_b32 s16, s66, s64
    s_cselect_b32 s17, s67, s65
    s_mov_b32 s18, 1835008
    s_mov_b32 s19, 0x20000
    s_mov_b32 s56, s68
    s_mov_b32 s57, s69
    s_mov_b32 s58, 0x1c0000
    s_mov_b32 s59, 0x20000
    s_mov_b32 s80, s72
    s_mov_b32 s81, s73
    s_mov_b32 s82, 0x80000
    s_mov_b32 s83, 0x20000
    s_mov_b32 s52, s70
    s_mov_b32 s53, s71
    s_mov_b32 s54, 0x200000
    s_mov_b32 s55, 0x20000
    s_mov_b32 s44, s74
    s_mov_b32 s45, s75
    s_mov_b32 s46, 0x100
    s_mov_b32 s47, 0x20000
    s_and_b32 s5, s24, 1
    s_lshr_b32 s6, s24, 1
    s_lshl_b32 s7, s26, 7
    s_mul_i32 s3, s26, 320
    s_add_u32 s3, s3, 1024
    s_and_b32 s4, s26, 1
    s_lshl_b32 s4, s4, 6
    s_add_u32 s41, s3, s4
    s_add_u32 s42, s41, 128
    s_lshl_b32 s4, s4, 2
    s_sub_u32 s4, 256, s4
    s_add_u32 s43, s3, s4
    s_cmp_eq_u32 s29, 0
    s_cselect_b32 s41, s7, s41
    s_add_u32 s4, s30, 0
    s_and_b32 s4, s4, 3
    s_mul_i32 s64, s4, 393216
    s_mul_i32 s68, s4, 458752
    s_add_u32 s4, s30, 1
    s_and_b32 s4, s4, 3
    s_mul_i32 s65, s4, 393216
    s_mul_i32 s69, s4, 458752
    s_add_u32 s4, s30, 2
    s_and_b32 s4, s4, 3
    s_mul_i32 s66, s4, 393216
    s_mul_i32 s70, s4, 458752
    s_add_u32 s4, s30, 3
    s_and_b32 s4, s4, 3
    s_mul_i32 s67, s4, 393216
    s_mul_i32 s71, s4, 458752
    s_mul_i32 s37, s5, 196608
    s_add_u32 s37, s37, s7
    s_lshl_b32 s3, s6, 10
    s_add_u32 s36, s37, s3
    s_add_u32 s36, s36, 1024
    s_mul_i32 s3, s5, 229376
    s_add_u32 s38, s3, s41
    s_add_u32 s39, s3, s42
    s_mov_b32 s40, s43
    v_mov_b32 v48, 0
    v_mov_b32 v49, 0
    v_mov_b32 v50, 0
    v_mov_b32 v51, 0
    v_mov_b32 v52, 0
    v_mov_b32 v53, 0
    v_mov_b32 v54, 0
    v_mov_b32 v55, 0
    s_mov_b32 s98, 0x3f803f80
    s_mov_b32 s50, 0xffff0000
    s_lshl_b32 s33, s24, 13
    v_lshrrev_b32 v40, 3, v1
    v_and_b32 v41, 7, v1
    v_bfe_u32 v42, v1, 4, 1
    v_lshlrev_b32 v42, 2, v42
    v_xor_b32 v41, v41, v42
    v_lshlrev_b32 v41, 4, v41
    v_mul_u32_u24 v42, 3584, v40
    v_add_u32 v20, v42, v41
    v_mul_u32_u24 v42, 3072, v40
    v_add_u32 v43, v42, v41
    v_lshl_add_u32 v61, v40, 10, v41
    v_lshrrev_b32 v40, 2, v1
    v_and_b32 v41, 3, v1
    v_lshlrev_b32 v41, 4, v41
    v_mul_u32_u24 v42, 3584, v40
    v_add_u32 v42, v42, v41
    s_cmp_eq_u32 s29, 0
    s_cselect_b64 vcc, -1, 0
    s_mov_b32 s4, 23552
    s_cselect_b32 s4, s4, 56320
    v_cndmask_b32 v16, v42, v43, vcc
    v_add_u32 v17, s4, v16
    v_add_u32 v21, 27648, v20
    v_add_u32 v18, s4, v17
    v_add_u32 v22, 55296, v20
    v_add_u32 v19, s4, v18
    v_add_u32 v23, 82944, v20
    s_cmp_eq_u32 s29, 0
    s_cbranch_scc0 L_HH
    s_lshr_b32 s90, s25, 2
    s_and_b32 s90, s90, 1
    s_xor_b32 s90, s90, 0
    s_lshl_b32 s91, s90, 12
    s_add_u32 m0, s33, s91
    s_mul_i32 s90, s90, 98304
    s_add_u32 s34, s36, s64
    s_add_u32 s34, s34, s90
    buffer_load_dwordx4 v16, s[12:15], s34 offen offset:0 lds
    buffer_load_dwordx4 v17, s[12:15], s34 offen offset:1024 lds
    buffer_load_dwordx4 v18, s[12:15], s34 offen offset:2048 lds
    buffer_load_dwordx4 v19, s[12:15], s34 offen offset:3072 lds
    s_mov_b32 s4, 0xfb0000
    buffer_load_dwordx2 v[4:5], off, s[20:23], s4 sc1
    v_and_b32 v40, 31, v1
    v_lshrrev_b32 v41, 5, v1
    v_bfe_u32 v42, v40, 1, 3
    v_xor_b32 v42, v42, v41
    v_lshlrev_b32 v42, 4, v42
    v_lshl_add_u32 v42, v40, 7, v42
    v_add_u32 v44, s77, v42
    v_xor_b32 v45, 32, v44
    v_xor_b32 v46, 64, v44
    v_xor_b32 v47, 96, v44
    v_lshlrev_b32 v2, 4, v1
    v_lshlrev_b32 v3, 3, v1
    s_nop 0
    s_cmp_eq_u32 s29, 0
    s_cselect_b32 s3, s6, s5
    s_mov_b32 s7, 393216
    s_cselect_b32 s7, s7, 458752
    s_add_u32 s3, s3, s30
    s_add_u32 s4, s3, 0
    s_and_b32 s4, s4, 3
    s_mul_i32 s72, s4, s7
    s_add_u32 s4, s3, 2
    s_and_b32 s4, s4, 3
    s_mul_i32 s73, s4, s7
    v_lshrrev_b32 v40, 5, v1
    v_bfe_u32 v41, v1, 2, 2
    v_lshl_add_u32 v42, v40, 3, v41
    v_lshl_add_u32 v39, v40, 2, v41
    v_bfe_u32 v43, v1, 4, 1
    v_lshlrev_b32 v43, 5, v43
    v_and_b32 v38, 3, v1
    v_lshl_add_u32 v43, v38, 3, v43
    v_lshl_add_u32 v12, v39, 6, v43
    v_bfe_u32 v38, v41, 1, 1
    v_lshl_add_u32 v43, v38, 6, v43
    v_lshl_add_u32 v6, v39, 7, v43
    v_xor_b32 v9, 64, v6
    v_add_u32 v7, 0x10000, v6
    v_add_u32 v10, 0x10000, v9
    v_add_u32 v13, 0x10000, v12
    s_add_u32 s48, s33, 131072
    v_lshl_add_u32 v8, v39, 7, v43
    v_add_u32 v8, s48, v8
    v_xor_b32 v11, 64, v8
    s_mul_i32 s3, s28, 147456
    s_lshl_b32 s41, s41, 5
    s_add_u32 s41, s41, s3
    s_lshl_b32 s42, s42, 5
    s_add_u32 s42, s42, s3
    s_lshl_b32 s43, s43, 5
    s_add_u32 s43, s43, s3
    s_lshl_b32 s74, s32, 7
    s_lshl_b32 s99, s24, 17
    s_add_u32 s99, s99, s74
    s_add_u32 s3, s32, s31
    s_and_b32 s4, s3, 1
    s_mul_i32 s4, s4, 12
    s_mul_i32 s7, s24, 20
    s_add_u32 s7, s7, 32
    s_add_u32 s75, s7, s4
    s_sub_u32 s4, 12, s4
    s_add_u32 s4, s4, s7
    s_lshl_b32 s4, s4, 8
    s_or_b32 s75, s75, s4
    s_mul_i32 s88, s7, 0x101
    s_add_u32 s88, s88, 0x1004
    s_mul_i32 s4, s24, 0x808
    s_add_u32 s4, s4, 0x400
    s_lshl_b32 s4, s4, 16
    s_or_b32 s88, s88, s4
    s_add_u32 s89, s7, 8
    s_mul_i32 s4, s3, 205
    s_lshr_b32 s4, s4, 10
    s_mul_i32 s4, s4, 5
    s_sub_u32 s3, s3, s4
    s_lshl_b32 s3, s3, 3
    s_lshr_b64 s[90:91], s[88:89], s3
    s_sub_u32 s3, 40, s3
    s_lshl_b64 s[88:89], s[88:89], s3
    s_or_b64 s[88:89], s[88:89], s[90:91]
    s_lshl_b32 s4, s88, 16
    s_or_b32 s75, s75, s4
    s_lshr_b64 s[88:89], s[88:89], 16
    s_mov_b32 s49, s88
    v_and_b32 v32, 31, v1
    v_lshrrev_b32 v33, 5, v1
    v_lshlrev_b32 v33, 3, v33
    v_sub_u32 v32, v32, v33
    v_and_b32 v33, 1, v32
    v_lshlrev_b32 v33, 4, v33
    v_mov_b32 v34, 0x3f80
    v_lshlrev_b32 v33, v33, v34
    v_ashrrev_i32 v32, 1, v32
    v_cmp_eq_u32 s[88:89], 0, v32
    v_cmp_eq_u32 s[90:91], 1, v32
    s_nop 0
    v_cndmask_b32 v34, 0, v33, s[88:89]
    v_accvgpr_write_b32 a184, v34
    v_cmp_eq_u32 s[88:89], 2, v32
    v_cndmask_b32 v34, 0, v33, s[90:91]
    v_accvgpr_write_b32 a185, v34
    v_cmp_eq_u32 s[90:91], 3, v32
    v_cndmask_b32 v34, 0, v33, s[88:89]
    v_accvgpr_write_b32 a186, v34
    v_cmp_eq_u32 s[88:89], 8, v32
    v_cndmask_b32 v34, 0, v33, s[90:91]
    v_accvgpr_write_b32 a187, v34
    v_cmp_eq_u32 s[90:91], 9, v32
    v_cndmask_b32 v34, 0, v33, s[88:89]
    v_accvgpr_write_b32 a188, v34
    v_cmp_eq_u32 s[88:89], 10, v32
    v_cndmask_b32 v34, 0, v33, s[90:91]
    v_accvgpr_write_b32 a189, v34
    v_cmp_eq_u32 s[90:91], 11, v32
    v_cndmask_b32 v34, 0, v33, s[88:89]
    v_accvgpr_write_b32 a190, v34
    s_nop 0
    v_cndmask_b32 v34, 0, v33, s[90:91]
    v_accvgpr_write_b32 a191, v34
    s_add_u32 m0, s77, 8192
    s_add_u32 s79, s78, 256
    s_and_b32 s79, s79, 1023
    s_add_u32 s79, s79, s76
    buffer_load_dwordx4 v56, s[8:11], s79 offen offset:0 lds
    buffer_load_dwordx4 v57, s[8:11], s79 offen offset:1024 lds
    buffer_load_dwordx4 v58, s[8:11], s79 offen offset:2048 lds
    buffer_load_dwordx4 v59, s[8:11], s79 offen offset:3072 lds
    s_add_u32 m0, s77, 12288
    s_add_u32 s79, s78, 384
    s_and_b32 s79, s79, 1023
    s_add_u32 s79, s79, s76
    buffer_load_dwordx4 v56, s[8:11], s79 offen offset:0 lds
    buffer_load_dwordx4 v57, s[8:11], s79 offen offset:1024 lds
    buffer_load_dwordx4 v58, s[8:11], s79 offen offset:2048 lds
    buffer_load_dwordx4 v59, s[8:11], s79 offen offset:3072 lds
    s_waitcnt vmcnt(17)
    ds_read_b128 v[192:195], v44 offset:0
    ds_read_b128 v[196:199], v45 offset:0
    ds_read_b128 v[200:203], v46 offset:0
    ds_read_b128 v[204:207], v47 offset:0
    s_add_u32 m0, s77, 16384
    s_add_u32 s79, s78, 512
    s_and_b32 s79, s79, 1023
    s_add_u32 s79, s79, s76
    buffer_load_dwordx4 v56, s[8:11], s79 offen offset:0 lds
    buffer_load_dwordx4 v57, s[8:11], s79 offen offset:1024 lds
    buffer_load_dwordx4 v58, s[8:11], s79 offen offset:2048 lds
    buffer_load_dwordx4 v59, s[8:11], s79 offen offset:3072 lds
    s_waitcnt vmcnt(17)
    ds_read_b128 v[208:211], v44 offset:4096
    ds_read_b128 v[212:215], v45 offset:4096
    ds_read_b128 v[216:219], v46 offset:4096
    ds_read_b128 v[220:223], v47 offset:4096
    s_waitcnt lgkmcnt(4)
    v_dot2_f32_bf16 v48, v192, s98, v48
    v_dot2_f32_bf16 v52, v192, v192, v52
    v_dot2_f32_bf16 v49, v193, s98, v49
    v_dot2_f32_bf16 v53, v193, v193, v53
    v_dot2_f32_bf16 v50, v194, s98, v50
    v_dot2_f32_bf16 v54, v194, v194, v54
    v_dot2_f32_bf16 v51, v195, s98, v51
    v_dot2_f32_bf16 v55, v195, v195, v55
    v_dot2_f32_bf16 v48, v196, s98, v48
    v_dot2_f32_bf16 v52, v196, v196, v52
    v_dot2_f32_bf16 v49, v197, s98, v49
    v_dot2_f32_bf16 v53, v197, v197, v53
    v_dot2_f32_bf16 v50, v198, s98, v50
    v_dot2_f32_bf16 v54, v198, v198, v54
    v_dot2_f32_bf16 v51, v199, s98, v51
    v_dot2_f32_bf16 v55, v199, v199, v55
    v_dot2_f32_bf16 v48, v200, s98, v48
    v_dot2_f32_bf16 v52, v200, v200, v52
    v_dot2_f32_bf16 v49, v201, s98, v49
    v_dot2_f32_bf16 v53, v201, v201, v53
    v_dot2_f32_bf16 v50, v202, s98, v50
    v_dot2_f32_bf16 v54, v202, v202, v54
    v_dot2_f32_bf16 v51, v203, s98, v51
    v_dot2_f32_bf16 v55, v203, v203, v55
    v_dot2_f32_bf16 v48, v204, s98, v48
    v_dot2_f32_bf16 v52, v204, v204, v52
    v_dot2_f32_bf16 v49, v205, s98, v49
    v_dot2_f32_bf16 v53, v205, v205, v53
    v_dot2_f32_bf16 v50, v206, s98, v50
    v_dot2_f32_bf16 v54, v206, v206, v54
    v_dot2_f32_bf16 v51, v207, s98, v51
    v_dot2_f32_bf16 v55, v207, v207, v55
    s_add_u32 m0, s77, 20480
    s_add_u32 s79, s78, 640
    s_and_b32 s79, s79, 1023
    s_add_u32 s79, s79, s76
    buffer_load_dwordx4 v56, s[8:11], s79 offen offset:0 lds
    buffer_load_dwordx4 v57, s[8:11], s79 offen offset:1024 lds
    buffer_load_dwordx4 v58, s[8:11], s79 offen offset:2048 lds
    buffer_load_dwordx4 v59, s[8:11], s79 offen offset:3072 lds
    s_waitcnt vmcnt(12)
    ds_read_b128 v[224:227], v44 offset:8192
    ds_read_b128 v[228:231], v45 offset:8192
    ds_read_b128 v[232:235], v46 offset:8192
    ds_read_b128 v[236:239], v47 offset:8192
    s_waitcnt lgkmcnt(4)
    v_dot2_f32_bf16 v48, v208, s98, v48
    v_dot2_f32_bf16 v52, v208, v208, v52
    v_dot2_f32_bf16 v49, v209, s98, v49
    v_dot2_f32_bf16 v53, v209, v209, v53
    v_dot2_f32_bf16 v50, v210, s98, v50
    v_dot2_f32_bf16 v54, v210, v210, v54
    v_dot2_f32_bf16 v51, v211, s98, v51
    v_dot2_f32_bf16 v55, v211, v211, v55
    v_dot2_f32_bf16 v48, v212, s98, v48
    v_dot2_f32_bf16 v52, v212, v212, v52
    v_dot2_f32_bf16 v49, v213, s98, v49
    v_dot2_f32_bf16 v53, v213, v213, v53
    v_dot2_f32_bf16 v50, v214, s98, v50
    v_dot2_f32_bf16 v54, v214, v214, v54
    v_dot2_f32_bf16 v51, v215, s98, v51
    v_dot2_f32_bf16 v55, v215, v215, v55
    v_dot2_f32_bf16 v48, v216, s98, v48
    v_dot2_f32_bf16 v52, v216, v216, v52
    v_dot2_f32_bf16 v49, v217, s98, v49
    v_dot2_f32_bf16 v53, v217, v217, v53
    v_dot2_f32_bf16 v50, v218, s98, v50
    v_dot2_f32_bf16 v54, v218, v218, v54
    v_dot2_f32_bf16 v51, v219, s98, v51
    v_dot2_f32_bf16 v55, v219, v219, v55
    v_dot2_f32_bf16 v48, v220, s98, v48
    v_dot2_f32_bf16 v52, v220, v220, v52
    v_dot2_f32_bf16 v49, v221, s98, v49
    v_dot2_f32_bf16 v53, v221, v221, v53
    v_dot2_f32_bf16 v50, v222, s98, v50
    v_dot2_f32_bf16 v54, v222, v222, v54
    v_dot2_f32_bf16 v51, v223, s98, v51
    v_dot2_f32_bf16 v55, v223, v223, v55
    s_add_u32 m0, s77, 24576
    s_add_u32 s79, s78, 768
    s_and_b32 s79, s79, 1023
    s_add_u32 s79, s79, s76
    buffer_load_dwordx4 v56, s[8:11], s79 offen offset:0 lds
    buffer_load_dwordx4 v57, s[8:11], s79 offen offset:1024 lds
    buffer_load_dwordx4 v58, s[8:11], s79 offen offset:2048 lds
    buffer_load_dwordx4 v59, s[8:11], s79 offen offset:3072 lds
    s_waitcnt vmcnt(12)
    ds_read_b128 v[240:243], v44 offset:12288
    ds_read_b128 v[244:247], v45 offset:12288
    ds_read_b128 v[248:251], v46 offset:12288
    ds_read_b128 v[252:255], v47 offset:12288
    s_waitcnt lgkmcnt(4)
    v_dot2_f32_bf16 v48, v224, s98, v48
    v_dot2_f32_bf16 v52, v224, v224, v52
    v_dot2_f32_bf16 v49, v225, s98, v49
    v_dot2_f32_bf16 v53, v225, v225, v53
    v_dot2_f32_bf16 v50, v226, s98, v50
    v_dot2_f32_bf16 v54, v226, v226, v54
    v_dot2_f32_bf16 v51, v227, s98, v51
    v_dot2_f32_bf16 v55, v227, v227, v55
    v_dot2_f32_bf16 v48, v228, s98, v48
    v_dot2_f32_bf16 v52, v228, v228, v52
    v_dot2_f32_bf16 v49, v229, s98, v49
    v_dot2_f32_bf16 v53, v229, v229, v53
    v_dot2_f32_bf16 v50, v230, s98, v50
    v_dot2_f32_bf16 v54, v230, v230, v54
    v_dot2_f32_bf16 v51, v231, s98, v51
    v_dot2_f32_bf16 v55, v231, v231, v55
    v_dot2_f32_bf16 v48, v232, s98, v48
    v_dot2_f32_bf16 v52, v232, v232, v52
    v_dot2_f32_bf16 v49, v233, s98, v49
    v_dot2_f32_bf16 v53, v233, v233, v53
    v_dot2_f32_bf16 v50, v234, s98, v50
    v_dot2_f32_bf16 v54, v234, v234, v54
    v_dot2_f32_bf16 v51, v235, s98, v51
    v_dot2_f32_bf16 v55, v235, v235, v55
    v_dot2_f32_bf16 v48, v236, s98, v48
    v_dot2_f32_bf16 v52, v236, v236, v52
    v_dot2_f32_bf16 v49, v237, s98, v49
    v_dot2_f32_bf16 v53, v237, v237, v53
    v_dot2_f32_bf16 v50, v238, s98, v50
    v_dot2_f32_bf16 v54, v238, v238, v54
    v_dot2_f32_bf16 v51, v239, s98, v51
    v_dot2_f32_bf16 v55, v239, v239, v55
    s_add_u32 m0, s77, 28672
    s_add_u32 s79, s78, 896
    s_and_b32 s79, s79, 1023
    s_add_u32 s79, s79, s76
    buffer_load_dwordx4 v56, s[8:11], s79 offen offset:0 lds
    buffer_load_dwordx4 v57, s[8:11], s79 offen offset:1024 lds
    buffer_load_dwordx4 v58, s[8:11], s79 offen offset:2048 lds
    buffer_load_dwordx4 v59, s[8:11], s79 offen offset:3072 lds
    s_waitcnt vmcnt(12)
    ds_read_b128 v[128:131], v44 offset:16384
    ds_read_b128 v[132:135], v45 offset:16384
    ds_read_b128 v[136:139], v46 offset:16384
    ds_read_b128 v[140:143], v47 offset:16384
    s_waitcnt lgkmcnt(4)
    v_dot2_f32_bf16 v48, v240, s98, v48
    v_dot2_f32_bf16 v52, v240, v240, v52
    v_dot2_f32_bf16 v49, v241, s98, v49
    v_dot2_f32_bf16 v53, v241, v241, v53
    v_dot2_f32_bf16 v50, v242, s98, v50
    v_dot2_f32_bf16 v54, v242, v242, v54
    v_dot2_f32_bf16 v51, v243, s98, v51
    v_dot2_f32_bf16 v55, v243, v243, v55
    v_dot2_f32_bf16 v48, v244, s98, v48
    v_dot2_f32_bf16 v52, v244, v244, v52
    v_dot2_f32_bf16 v49, v245, s98, v49
    v_dot2_f32_bf16 v53, v245, v245, v53
    v_dot2_f32_bf16 v50, v246, s98, v50
    v_dot2_f32_bf16 v54, v246, v246, v54
    v_dot2_f32_bf16 v51, v247, s98, v51
    v_dot2_f32_bf16 v55, v247, v247, v55
    v_dot2_f32_bf16 v48, v248, s98, v48
    v_dot2_f32_bf16 v52, v248, v248, v52
    v_dot2_f32_bf16 v49, v249, s98, v49
    v_dot2_f32_bf16 v53, v249, v249, v53
    v_dot2_f32_bf16 v50, v250, s98, v50
    v_dot2_f32_bf16 v54, v250, v250, v54
    v_dot2_f32_bf16 v51, v251, s98, v51
    v_dot2_f32_bf16 v55, v251, v251, v55
    v_dot2_f32_bf16 v48, v252, s98, v48
    v_dot2_f32_bf16 v52, v252, v252, v52
    v_dot2_f32_bf16 v49, v253, s98, v49
    v_dot2_f32_bf16 v53, v253, v253, v53
    v_dot2_f32_bf16 v50, v254, s98, v50
    v_dot2_f32_bf16 v54, v254, v254, v54
    v_dot2_f32_bf16 v51, v255, s98, v51
    v_dot2_f32_bf16 v55, v255, v255, v55
    s_lshr_b32 s90, s25, 2
    s_and_b32 s90, s90, 1
    s_xor_b32 s90, s90, 1
    s_lshl_b32 s91, s90, 12
    s_add_u32 m0, s33, s91
    s_mul_i32 s90, s90, 98304
    s_add_u32 s34, s36, s64
    s_add_u32 s34, s34, s90
    buffer_load_dwordx4 v16, s[12:15], s34 offen offset:0 lds
    buffer_load_dwordx4 v17, s[12:15], s34 offen offset:1024 lds
    s_waitcnt vmcnt(10)
    ds_read_b128 v[144:147], v44 offset:20480
    ds_read_b128 v[148:151], v45 offset:20480
    ds_read_b128 v[152:155], v46 offset:20480
    ds_read_b128 v[156:159], v47 offset:20480
    s_waitcnt lgkmcnt(4)
    v_dot2_f32_bf16 v48, v128, s98, v48
    v_dot2_f32_bf16 v52, v128, v128, v52
    v_dot2_f32_bf16 v49, v129, s98, v49
    v_dot2_f32_bf16 v53, v129, v129, v53
    v_dot2_f32_bf16 v50, v130, s98, v50
    v_dot2_f32_bf16 v54, v130, v130, v54
    v_dot2_f32_bf16 v51, v131, s98, v51
    v_dot2_f32_bf16 v55, v131, v131, v55
    v_dot2_f32_bf16 v48, v132, s98, v48
    v_dot2_f32_bf16 v52, v132, v132, v52
    v_dot2_f32_bf16 v49, v133, s98, v49
    v_dot2_f32_bf16 v53, v133, v133, v53
    v_dot2_f32_bf16 v50, v134, s98, v50
    v_dot2_f32_bf16 v54, v134, v134, v54
    v_dot2_f32_bf16 v51, v135, s98, v51
    v_dot2_f32_bf16 v55, v135, v135, v55
    buffer_load_dwordx4 v18, s[12:15], s34 offen offset:2048 lds
    buffer_load_dwordx4 v19, s[12:15], s34 offen offset:3072 lds
    v_dot2_f32_bf16 v48, v136, s98, v48
    v_dot2_f32_bf16 v52, v136, v136, v52
    v_dot2_f32_bf16 v49, v137, s98, v49
    v_dot2_f32_bf16 v53, v137, v137, v53
    v_dot2_f32_bf16 v50, v138, s98, v50
    v_dot2_f32_bf16 v54, v138, v138, v54
    v_dot2_f32_bf16 v51, v139, s98, v51
    v_dot2_f32_bf16 v55, v139, v139, v55
    v_dot2_f32_bf16 v48, v140, s98, v48
    v_dot2_f32_bf16 v52, v140, v140, v52
    v_dot2_f32_bf16 v49, v141, s98, v49
    v_dot2_f32_bf16 v53, v141, v141, v53
    v_dot2_f32_bf16 v50, v142, s98, v50
    v_dot2_f32_bf16 v54, v142, v142, v54
    v_dot2_f32_bf16 v51, v143, s98, v51
    v_dot2_f32_bf16 v55, v143, v143, v55
    s_waitcnt vmcnt(8)
    ds_read_b128 v[160:163], v44 offset:24576
    ds_read_b128 v[164:167], v45 offset:24576
    ds_read_b128 v[168:171], v46 offset:24576
    ds_read_b128 v[172:175], v47 offset:24576
    s_waitcnt lgkmcnt(4)
    v_dot2_f32_bf16 v48, v144, s98, v48
    v_dot2_f32_bf16 v52, v144, v144, v52
    v_dot2_f32_bf16 v49, v145, s98, v49
    v_dot2_f32_bf16 v53, v145, v145, v53
    v_dot2_f32_bf16 v50, v146, s98, v50
    v_dot2_f32_bf16 v54, v146, v146, v54
    v_dot2_f32_bf16 v51, v147, s98, v51
    v_dot2_f32_bf16 v55, v147, v147, v55
    v_dot2_f32_bf16 v48, v148, s98, v48
    v_dot2_f32_bf16 v52, v148, v148, v52
    v_dot2_f32_bf16 v49, v149, s98, v49
    v_dot2_f32_bf16 v53, v149, v149, v53
    v_dot2_f32_bf16 v50, v150, s98, v50
    v_dot2_f32_bf16 v54, v150, v150, v54
    v_dot2_f32_bf16 v51, v151, s98, v51
    v_dot2_f32_bf16 v55, v151, v151, v55
    v_dot2_f32_bf16 v48, v152, s98, v48
    v_dot2_f32_bf16 v52, v152, v152, v52
    v_dot2_f32_bf16 v49, v153, s98, v49
    v_dot2_f32_bf16 v53, v153, v153, v53
    v_dot2_f32_bf16 v50, v154, s98, v50
    v_dot2_f32_bf16 v54, v154, v154, v54
    v_dot2_f32_bf16 v51, v155, s98, v51
    v_dot2_f32_bf16 v55, v155, v155, v55
    v_dot2_f32_bf16 v48, v156, s98, v48
    v_dot2_f32_bf16 v52, v156, v156, v52
    v_dot2_f32_bf16 v49, v157, s98, v49
    v_dot2_f32_bf16 v53, v157, v157, v53
    v_dot2_f32_bf16 v50, v158, s98, v50
    v_dot2_f32_bf16 v54, v158, v158, v54
    v_dot2_f32_bf16 v51, v159, s98, v51
    v_dot2_f32_bf16 v55, v159, v159, v55
    s_and_b32 s88, s24, 1
    s_lshl_b32 s88, s88, 6
    v_xor_b32 v8, s88, v8
    v_xor_b32 v11, s88, v11
    v_add_u32 v57, 7168, v61
    v_add_u32 v58, 14336, v61
    v_add_u32 v59, 21504, v61
    v_mov_b32 v56, v61
    s_waitcnt vmcnt(4)
    ds_read_b128 v[176:179], v44 offset:28672
    ds_read_b128 v[180:183], v45 offset:28672
    ds_read_b128 v[184:187], v46 offset:28672
    ds_read_b128 v[188:191], v47 offset:28672
    s_waitcnt lgkmcnt(4)
    v_dot2_f32_bf16 v48, v160, s98, v48
    v_dot2_f32_bf16 v52, v160, v160, v52
    v_dot2_f32_bf16 v49, v161, s98, v49
    v_dot2_f32_bf16 v53, v161, v161, v53
    v_dot2_f32_bf16 v50, v162, s98, v50
    v_dot2_f32_bf16 v54, v162, v162, v54
    v_dot2_f32_bf16 v51, v163, s98, v51
    v_dot2_f32_bf16 v55, v163, v163, v55
    v_dot2_f32_bf16 v48, v164, s98, v48
    v_dot2_f32_bf16 v52, v164, v164, v52
    v_dot2_f32_bf16 v49, v165, s98, v49
    v_dot2_f32_bf16 v53, v165, v165, v53
    v_dot2_f32_bf16 v50, v166, s98, v50
    v_dot2_f32_bf16 v54, v166, v166, v54
    v_dot2_f32_bf16 v51, v167, s98, v51
    v_dot2_f32_bf16 v55, v167, v167, v55
    v_dot2_f32_bf16 v48, v168, s98, v48
    v_dot2_f32_bf16 v52, v168, v168, v52
    v_dot2_f32_bf16 v49, v169, s98, v49
    v_dot2_f32_bf16 v53, v169, v169, v53
    v_dot2_f32_bf16 v50, v170, s98, v50
    v_dot2_f32_bf16 v54, v170, v170, v54
    v_dot2_f32_bf16 v51, v171, s98, v51
    v_dot2_f32_bf16 v55, v171, v171, v55
    v_dot2_f32_bf16 v48, v172, s98, v48
    v_dot2_f32_bf16 v52, v172, v172, v52
    v_dot2_f32_bf16 v49, v173, s98, v49
    v_dot2_f32_bf16 v53, v173, v173, v53
    v_dot2_f32_bf16 v50, v174, s98, v50
    v_dot2_f32_bf16 v54, v174, v174, v54
    v_dot2_f32_bf16 v51, v175, s98, v51
    v_dot2_f32_bf16 v55, v175, v175, v55
    s_waitcnt lgkmcnt(0)
    v_dot2_f32_bf16 v48, v176, s98, v48
    v_dot2_f32_bf16 v52, v176, v176, v52
    v_dot2_f32_bf16 v49, v177, s98, v49
    v_dot2_f32_bf16 v53, v177, v177, v53
    v_dot2_f32_bf16 v50, v178, s98, v50
    v_dot2_f32_bf16 v54, v178, v178, v54
    v_dot2_f32_bf16 v51, v179, s98, v51
    v_dot2_f32_bf16 v55, v179, v179, v55
    v_dot2_f32_bf16 v48, v180, s98, v48
    v_dot2_f32_bf16 v52, v180, v180, v52
    v_dot2_f32_bf16 v49, v181, s98, v49
    v_dot2_f32_bf16 v53, v181, v181, v53
    v_dot2_f32_bf16 v50, v182, s98, v50
    v_dot2_f32_bf16 v54, v182, v182, v54
    v_dot2_f32_bf16 v51, v183, s98, v51
    v_dot2_f32_bf16 v55, v183, v183, v55
    v_dot2_f32_bf16 v48, v184, s98, v48
    v_dot2_f32_bf16 v52, v184, v184, v52
    v_dot2_f32_bf16 v49, v185, s98, v49
    v_dot2_f32_bf16 v53, v185, v185, v53
    v_dot2_f32_bf16 v50, v186, s98, v50
    v_dot2_f32_bf16 v54, v186, v186, v54
    v_dot2_f32_bf16 v51, v187, s98, v51
    v_dot2_f32_bf16 v55, v187, v187, v55
    v_dot2_f32_bf16 v48, v188, s98, v48
    v_dot2_f32_bf16 v52, v188, v188, v52
    v_dot2_f32_bf16 v49, v189, s98, v49
    v_dot2_f32_bf16 v53, v189, v189, v53
    v_dot2_f32_bf16 v50, v190, s98, v50
    v_dot2_f32_bf16 v54, v190, v190, v54
    v_dot2_f32_bf16 v51, v191, s98, v51
    v_dot2_f32_bf16 v55, v191, v191, v55
    s_nop 0
    v_add_f32 v48, v48, v49
    v_add_f32 v50, v50, v51
    v_add_f32 v52, v52, v53
    v_add_f32 v48, v48, v50
    v_add_f32 v54, v54, v55
    v_mov_b32 v49, v48
    v_add_f32 v61, v52, v54
    v_mov_b32 v15, v61
    v_permlane32_swap_b32 v48, v49
    s_nop 0
    v_permlane32_swap_b32 v61, v15
    v_add_f32 v48, v48, v49
    v_mul_f32 v14, 0x3b000000, v48
    v_cvt_pk_bf16_f32 v48, v14, v14
    v_and_b32 v48, 0xffff0000, v48
    v_xor_b32 v24, 0x80000000, v48
    v_mov_b32 v25, v24
    v_mov_b32 v26, v24
    v_mov_b32 v27, v24
    v_mov_b32 v28, v24
    v_mov_b32 v29, v24
    v_mov_b32 v30, v24
    v_mov_b32 v31, v24
    v_mov_b32 v32, v24
    v_mov_b32 v33, v24
    v_mov_b32 v34, v24
    v_mov_b32 v35, v24
    v_mov_b32 v36, v24
    v_mov_b32 v37, v24
    v_mov_b32 v38, v24
    v_mov_b32 v39, v24
    s_nop 1
    v_mfma_f32_32x32x16_bf16 v[40:55], a[184:187], v[192:195], v[24:39]
    v_mfma_f32_32x32x16_bf16 v[40:55], a[188:191], v[196:199], v[40:55]
    s_waitcnt vmcnt(0)
    s_barrier
    ds_read_b64_tr_b16 a[0:1], v6 offset:0
    ds_read_b64_tr_b16 a[2:3], v6 offset:1024
    ds_read_b64_tr_b16 a[4:5], v9 offset:0
    ds_read_b64_tr_b16 a[6:7], v9 offset:1024
    ds_read_b64_tr_b16 a[8:9], v6 offset:16384
    ds_read_b64_tr_b16 a[10:11], v6 offset:17408
    ds_read_b64_tr_b16 a[12:13], v9 offset:16384
    ds_read_b64_tr_b16 a[14:15], v9 offset:17408
    s_add_u32 m0, s33, 32768
    s_add_u32 s34, s36, s65
    buffer_load_dwordx4 v16, s[12:15], s34 offen offset:0 lds
    buffer_load_dwordx4 v17, s[12:15], s34 offen offset:1024 lds
    v_cvt_pk_bf16_f32 v192, v40, v41
    v_cvt_pk_bf16_f32 v193, v42, v43
    v_cvt_pk_bf16_f32 v194, v44, v45
    v_cvt_pk_bf16_f32 v195, v46, v47
    v_cvt_pk_bf16_f32 v196, v48, v49
    v_cvt_pk_bf16_f32 v197, v50, v51
    v_cvt_pk_bf16_f32 v198, v52, v53
    v_cvt_pk_bf16_f32 v199, v54, v55
    s_waitcnt lgkmcnt(4)
    v_mfma_f32_32x32x16_bf16 v[64:79], a[0:3], v[192:195], 0
    ds_read_b64_tr_b16 a[16:17], v6 offset:2048
    ds_read_b64_tr_b16 a[18:19], v6 offset:3072
    v_mfma_f32_32x32x16_bf16 v[40:55], a[184:187], v[200:203], v[24:39]
    buffer_load_dwordx4 v18, s[12:15], s34 offen offset:2048 lds
    v_mfma_f32_32x32x16_bf16 v[80:95], a[4:7], v[192:195], 0
    buffer_load_dwordx4 v19, s[12:15], s34 offen offset:3072 lds
    ds_read_b64_tr_b16 a[20:21], v9 offset:2048
    ds_read_b64_tr_b16 a[22:23], v9 offset:3072
    v_mfma_f32_32x32x16_bf16 v[40:55], a[188:191], v[204:207], v[40:55]
    s_add_u32 m0, s33, 36864
    s_add_u32 s34, s34, 98304
    s_waitcnt lgkmcnt(4)
    v_mfma_f32_32x32x16_bf16 v[96:111], v[192:195], a[8:11], 0
    buffer_load_dwordx4 v16, s[12:15], s34 offen offset:0 lds
    ds_read_b64_tr_b16 a[24:25], v6 offset:18432
    ds_read_b64_tr_b16 a[26:27], v6 offset:19456
    v_mfma_f32_32x32x16_bf16 v[112:127], v[192:195], a[12:15], 0
    ds_read_b64_tr_b16 a[28:29], v9 offset:18432
    ds_read_b64_tr_b16 a[30:31], v9 offset:19456
    v_add_f32 v61, v61, v15
    s_waitcnt lgkmcnt(4)
    v_mfma_f32_32x32x16_bf16 v[64:79], a[16:19], v[196:199], v[64:79]
    ds_read_b64_tr_b16 a[0:1], v6 offset:4096
    ds_read_b64_tr_b16 a[2:3], v6 offset:5120
    v_cvt_pk_bf16_f32 v200, v40, v41
    v_cvt_pk_bf16_f32 v201, v42, v43
    v_mul_f32 v61, 0x3b000000, v61
    v_mfma_f32_32x32x16_bf16 v[80:95], a[20:23], v[196:199], v[80:95]
    buffer_load_dwordx4 v17, s[12:15], s34 offen offset:1024 lds
    ds_read_b64_tr_b16 a[4:5], v9 offset:4096
    ds_read_b64_tr_b16 a[6:7], v9 offset:5120
    v_cvt_pk_bf16_f32 v202, v44, v45
    v_cvt_pk_bf16_f32 v203, v46, v47
    s_waitcnt lgkmcnt(4)
    v_mfma_f32_32x32x16_bf16 v[96:111], v[196:199], a[24:27], v[96:111]
    ds_read_b64_tr_b16 a[8:9], v6 offset:20480
    ds_read_b64_tr_b16 a[10:11], v6 offset:21504
    v_cvt_pk_bf16_f32 v204, v48, v49
    v_cvt_pk_bf16_f32 v205, v50, v51
    v_fma_f32 v61, -v14, v14, v61
    v_mfma_f32_32x32x16_bf16 v[112:127], v[196:199], a[28:31], v[112:127]
    buffer_load_dwordx4 v18, s[12:15], s34 offen offset:2048 lds
    ds_read_b64_tr_b16 a[12:13], v9 offset:20480
    ds_read_b64_tr_b16 a[14:15], v9 offset:21504
    v_cvt_pk_bf16_f32 v206, v52, v53
    v_cvt_pk_bf16_f32 v207, v54, v55
    v_max_f32 v61, 0, v61
    s_waitcnt lgkmcnt(4)
    v_mfma_f32_32x32x16_bf16 v[64:79], a[0:3], v[200:203], v[64:79]
    buffer_load_dwordx4 v19, s[12:15], s34 offen offset:3072 lds
    ds_read_b64_tr_b16 a[16:17], v6 offset:6144
    ds_read_b64_tr_b16 a[18:19], v6 offset:7168
    s_add_u32 m0, s33, 65536
    s_add_u32 s34, s36, s66
    v_mfma_f32_32x32x16_bf16 v[40:55], a[184:187], v[208:211], v[24:39]
    buffer_load_dwordx4 v16, s[12:15], s34 offen offset:0 lds
    v_mfma_f32_32x32x16_bf16 v[80:95], a[4:7], v[200:203], v[80:95]
    buffer_load_dwordx4 v17, s[12:15], s34 offen offset:1024 lds
    ds_read_b64_tr_b16 a[20:21], v9 offset:6144
    ds_read_b64_tr_b16 a[22:23], v9 offset:7168
    v_mfma_f32_32x32x16_bf16 v[40:55], a[188:191], v[212:215], v[40:55]
    v_cvt_pk_bf16_f32 v61, v61, v61
    s_waitcnt lgkmcnt(4)
    v_mfma_f32_32x32x16_bf16 v[96:111], v[200:203], a[8:11], v[96:111]
    buffer_load_dwordx4 v18, s[12:15], s34 offen offset:2048 lds
    ds_read_b64_tr_b16 a[24:25], v6 offset:22528
    ds_read_b64_tr_b16 a[26:27], v6 offset:23552
    v_mfma_f32_32x32x16_bf16 v[112:127], v[200:203], a[12:15], v[112:127]
    ds_read_b64_tr_b16 a[28:29], v9 offset:22528
    ds_read_b64_tr_b16 a[30:31], v9 offset:23552
    v_and_b32 v61, 0xffff0000, v61
    s_waitcnt lgkmcnt(4)
    v_mfma_f32_32x32x16_bf16 v[64:79], a[16:19], v[204:207], v[64:79]
    ds_read_b64_tr_b16 a[0:1], v6 offset:8192
    ds_read_b64_tr_b16 a[2:3], v6 offset:9216
    v_cvt_pk_bf16_f32 v208, v40, v41
    v_cvt_pk_bf16_f32 v209, v42, v43
    v_add_f32 v61, 0x3727c5ac, v61
    v_mfma_f32_32x32x16_bf16 v[80:95], a[20:23], v[204:207], v[80:95]
    buffer_load_dwordx4 v19, s[12:15], s34 offen offset:3072 lds
    ds_read_b64_tr_b16 a[4:5], v9 offset:8192
    ds_read_b64_tr_b16 a[6:7], v9 offset:9216
    v_cvt_pk_bf16_f32 v210, v44, v45
    v_cvt_pk_bf16_f32 v211, v46, v47
    s_waitcnt lgkmcnt(4)
    v_mfma_f32_32x32x16_bf16 v[96:111], v[204:207], a[24:27], v[96:111]
    ds_read_b64_tr_b16 a[8:9], v6 offset:24576
    ds_read_b64_tr_b16 a[10:11], v6 offset:25600
    s_add_u32 m0, s33, 69632
    s_add_u32 s34, s34, 98304
    v_cvt_pk_bf16_f32 v212, v48, v49
    v_cvt_pk_bf16_f32 v213, v50, v51
    v_cvt_pk_bf16_f32 v61, v61, v61
    v_mfma_f32_32x32x16_bf16 v[112:127], v[204:207], a[28:31], v[112:127]
    buffer_load_dwordx4 v16, s[12:15], s34 offen offset:0 lds
    ds_read_b64_tr_b16 a[12:13], v9 offset:24576
    ds_read_b64_tr_b16 a[14:15], v9 offset:25600
    v_cvt_pk_bf16_f32 v214, v52, v53
    v_cvt_pk_bf16_f32 v215, v54, v55
    s_waitcnt lgkmcnt(4)
    v_mfma_f32_32x32x16_bf16 v[64:79], a[0:3], v[208:211], v[64:79]
    buffer_load_dwordx4 v17, s[12:15], s34 offen offset:1024 lds
    ds_read_b64_tr_b16 a[16:17], v6 offset:10240
    ds_read_b64_tr_b16 a[18:19], v6 offset:11264
    v_mfma_f32_32x32x16_bf16 v[40:55], a[184:187], v[216:219], v[24:39]
    buffer_load_dwordx4 v18, s[12:15], s34 offen offset:2048 lds
    v_and_b32 v61, 0xffff0000, v61
    v_mfma_f32_32x32x16_bf16 v[80:95], a[4:7], v[208:211], v[80:95]
    buffer_load_dwordx4 v19, s[12:15], s34 offen offset:3072 lds
    ds_read_b64_tr_b16 a[20:21], v9 offset:10240
    ds_read_b64_tr_b16 a[22:23], v9 offset:11264
    v_mfma_f32_32x32x16_bf16 v[40:55], a[188:191], v[220:223], v[40:55]
    s_add_u32 m0, s33, 98304
    s_add_u32 s34, s36, s67
    v_sqrt_f32 v61, v61
    s_waitcnt lgkmcnt(4)
    v_mfma_f32_32x32x16_bf16 v[96:111], v[208:211], a[8:11], v[96:111]
    buffer_load_dwordx4 v16, s[12:15], s34 offen offset:0 lds
    ds_read_b64_tr_b16 a[24:25], v6 offset:26624
    ds_read_b64_tr_b16 a[26:27], v6 offset:27648
    v_mfma_f32_32x32x16_bf16 v[112:127], v[208:211], a[12:15], v[112:127]
    ds_read_b64_tr_b16 a[28:29], v9 offset:26624
    ds_read_b64_tr_b16 a[30:31], v9 offset:27648
    v_mov_b32 v14, 0x9e3779b9
    s_waitcnt lgkmcnt(4)
    v_mfma_f32_32x32x16_bf16 v[64:79], a[16:19], v[212:215], v[64:79]
    ds_read_b64_tr_b16 a[0:1], v6 offset:12288
    ds_read_b64_tr_b16 a[2:3], v6 offset:13312
    v_cvt_pk_bf16_f32 v216, v40, v41
    v_cvt_pk_bf16_f32 v217, v42, v43
    v_cvt_pk_bf16_f32 v61, v61, v61
    v_mfma_f32_32x32x16_bf16 v[80:95], a[20:23], v[212:215], v[80:95]
    buffer_load_dwordx4 v17, s[12:15], s34 offen offset:1024 lds
    ds_read_b64_tr_b16 a[4:5], v9 offset:12288
    ds_read_b64_tr_b16 a[6:7], v9 offset:13312
    v_cvt_pk_bf16_f32 v218, v44, v45
    v_cvt_pk_bf16_f32 v219, v46, v47
    s_waitcnt lgkmcnt(4)
    v_mfma_f32_32x32x16_bf16 v[96:111], v[212:215], a[24:27], v[96:111]
    ds_read_b64_tr_b16 a[8:9], v6 offset:28672
    ds_read_b64_tr_b16 a[10:11], v6 offset:29696
    v_cvt_pk_bf16_f32 v220, v48, v49
    v_cvt_pk_bf16_f32 v221, v50, v51
    v_and_b32 v61, 0xffff0000, v61
    v_mfma_f32_32x32x16_bf16 v[112:127], v[212:215], a[28:31], v[112:127]
    buffer_load_dwordx4 v18, s[12:15], s34 offen offset:2048 lds
    ds_read_b64_tr_b16 a[12:13], v9 offset:28672
    ds_read_b64_tr_b16 a[14:15], v9 offset:29696
    v_cvt_pk_bf16_f32 v222, v52, v53
    v_cvt_pk_bf16_f32 v223, v54, v55
    s_waitcnt lgkmcnt(4)
    v_mfma_f32_32x32x16_bf16 v[64:79], a[0:3], v[216:219], v[64:79]
    buffer_load_dwordx4 v19, s[12:15], s34 offen offset:3072 lds
    ds_read_b64_tr_b16 a[16:17], v6 offset:14336
    ds_read_b64_tr_b16 a[18:19], v6 offset:15360
    s_add_u32 m0, s33, 102400
    s_add_u32 s34, s34, 98304
    v_mfma_f32_32x32x16_bf16 v[40:55], a[184:187], v[224:227], v[24:39]
    buffer_load_dwordx4 v16, s[12:15], s34 offen offset:0 lds
    v_rcp_f32 v0, v61
    v_mfma_f32_32x32x16_bf16 v[80:95], a[4:7], v[216:219], v[80:95]
    buffer_load_dwordx4 v17, s[12:15], s34 offen offset:1024 lds
    ds_read_b64_tr_b16 a[20:21], v9 offset:14336
    ds_read_b64_tr_b16 a[22:23], v9 offset:15360
    v_mfma_f32_32x32x16_bf16 v[40:55], a[188:191], v[228:231], v[40:55]
    v_add_co_u32 v4, vcc, 0x7f4a7c15, v4
    s_nop 1
    v_addc_co_u32 v5, vcc, v14, v5, vcc
    s_waitcnt lgkmcnt(4)
    v_mfma_f32_32x32x16_bf16 v[96:111], v[216:219], a[8:11], v[96:111]
    buffer_load_dwordx4 v18, s[12:15], s34 offen offset:2048 lds
    ds_read_b64_tr_b16 a[24:25], v6 offset:30720
    ds_read_b64_tr_b16 a[26:27], v6 offset:31744
    v_mfma_f32_32x32x16_bf16 v[112:127], v[216:219], a[12:15], v[112:127]
    ds_read_b64_tr_b16 a[28:29], v9 offset:30720
    ds_read_b64_tr_b16 a[30:31], v9 offset:31744
    s_waitcnt vmcnt(15)
    s_barrier
    s_waitcnt lgkmcnt(4)
    v_mfma_f32_32x32x16_bf16 v[64:79], a[16:19], v[220:223], v[64:79]
    ds_read_b64_tr_b16 a[0:1], v6 offset:32768
    ds_read_b64_tr_b16 a[2:3], v6 offset:33792
    v_cvt_pk_bf16_f32 v224, v40, v41
    v_cvt_pk_bf16_f32 v225, v42, v43
    v_mfma_f32_32x32x16_bf16 v[80:95], a[20:23], v[220:223], v[80:95]
    buffer_load_dwordx4 v19, s[12:15], s34 offen offset:3072 lds
    ds_read_b64_tr_b16 a[4:5], v9 offset:32768
    ds_read_b64_tr_b16 a[6:7], v9 offset:33792
    v_cvt_pk_bf16_f32 v226, v44, v45
    v_cvt_pk_bf16_f32 v227, v46, v47
    s_waitcnt lgkmcnt(4)
    v_mfma_f32_32x32x16_bf16 v[96:111], v[220:223], a[24:27], v[96:111]
    ds_read_b64_tr_b16 a[8:9], v6 offset:49152
    ds_read_b64_tr_b16 a[10:11], v6 offset:50176
    v_cvt_pk_bf16_f32 v228, v48, v49
    v_cvt_pk_bf16_f32 v229, v50, v51
    v_mfma_f32_32x32x16_bf16 v[112:127], v[220:223], a[28:31], v[112:127]
    ds_read_b64_tr_b16 a[12:13], v9 offset:49152
    ds_read_b64_tr_b16 a[14:15], v9 offset:50176
    v_cvt_pk_bf16_f32 v230, v52, v53
    v_cvt_pk_bf16_f32 v231, v54, v55
    s_waitcnt lgkmcnt(4)
    v_mfma_f32_32x32x16_bf16 v[64:79], a[0:3], v[224:227], v[64:79]
    ds_read_b64_tr_b16 a[16:17], v6 offset:34816
    ds_read_b64_tr_b16 a[18:19], v6 offset:35840
    s_add_u32 m0, s48, 0
    s_bfe_u32 s76, s75, 0x80000
    s_lshl_b32 s76, s76, 14
    s_add_u32 s76, s76, s74
    v_mfma_f32_32x32x16_bf16 v[40:55], a[184:187], v[232:235], v[24:39]
    buffer_load_dwordx4 v56, s[56:59], s76 offen offset:0 lds
    v_mfma_f32_32x32x16_bf16 v[80:95], a[4:7], v[224:227], v[80:95]
    buffer_load_dwordx4 v57, s[56:59], s76 offen offset:1024 lds
    ds_read_b64_tr_b16 a[20:21], v9 offset:34816
    ds_read_b64_tr_b16 a[22:23], v9 offset:35840
    v_mfma_f32_32x32x16_bf16 v[40:55], a[188:191], v[236:239], v[40:55]
    s_waitcnt lgkmcnt(4)
    v_mfma_f32_32x32x16_bf16 v[96:111], v[224:227], a[8:11], v[96:111]
    buffer_load_dwordx4 v58, s[56:59], s76 offen offset:2048 lds
    ds_read_b64_tr_b16 a[24:25], v6 offset:51200
    ds_read_b64_tr_b16 a[26:27], v6 offset:52224
    v_mfma_f32_32x32x16_bf16 v[112:127], v[224:227], a[12:15], v[112:127]
    ds_read_b64_tr_b16 a[28:29], v9 offset:51200
    ds_read_b64_tr_b16 a[30:31], v9 offset:52224
    s_waitcnt lgkmcnt(4)
    v_mfma_f32_32x32x16_bf16 v[64:79], a[16:19], v[228:231], v[64:79]
    ds_read_b64_tr_b16 a[0:1], v6 offset:36864
    ds_read_b64_tr_b16 a[2:3], v6 offset:37888
    v_cvt_pk_bf16_f32 v232, v40, v41
    v_cvt_pk_bf16_f32 v233, v42, v43
    v_mfma_f32_32x32x16_bf16 v[80:95], a[20:23], v[228:231], v[80:95]
    ds_read_b64_tr_b16 a[4:5], v9 offset:36864
    ds_read_b64_tr_b16 a[6:7], v9 offset:37888
    v_cvt_pk_bf16_f32 v234, v44, v45
    v_cvt_pk_bf16_f32 v235, v46, v47
    s_waitcnt lgkmcnt(4)
    v_mfma_f32_32x32x16_bf16 v[96:111], v[228:231], a[24:27], v[96:111]
    ds_read_b64_tr_b16 a[8:9], v6 offset:53248
    ds_read_b64_tr_b16 a[10:11], v6 offset:54272
    v_cvt_pk_bf16_f32 v236, v48, v49
    v_cvt_pk_bf16_f32 v237, v50, v51
    v_mfma_f32_32x32x16_bf16 v[112:127], v[228:231], a[28:31], v[112:127]
    ds_read_b64_tr_b16 a[12:13], v9 offset:53248
    ds_read_b64_tr_b16 a[14:15], v9 offset:54272
    v_cvt_pk_bf16_f32 v238, v52, v53
    v_cvt_pk_bf16_f32 v239, v54, v55
    s_waitcnt lgkmcnt(4)
    v_mfma_f32_32x32x16_bf16 v[64:79], a[0:3], v[232:235], v[64:79]
    buffer_load_dwordx4 v59, s[56:59], s76 offen offset:3072 lds
    ds_read_b64_tr_b16 a[16:17], v6 offset:38912
    ds_read_b64_tr_b16 a[18:19], v6 offset:39936
    v_mfma_f32_32x32x16_bf16 v[40:55], a[184:187], v[240:243], v[24:39]
    s_add_u32 m0, s48, 4096
    s_add_u32 s76, s76, 32768
    v_mfma_f32_32x32x16_bf16 v[80:95], a[4:7], v[232:235], v[80:95]
    buffer_load_dwordx4 v56, s[56:59], s76 offen offset:0 lds
    ds_read_b64_tr_b16 a[20:21], v9 offset:38912
    ds_read_b64_tr_b16 a[22:23], v9 offset:39936
    v_mfma_f32_32x32x16_bf16 v[40:55], a[188:191], v[244:247], v[40:55]
    s_waitcnt lgkmcnt(4)
    v_mfma_f32_32x32x16_bf16 v[96:111], v[232:235], a[8:11], v[96:111]
    buffer_load_dwordx4 v57, s[56:59], s76 offen offset:1024 lds
    ds_read_b64_tr_b16 a[24:25], v6 offset:55296
    ds_read_b64_tr_b16 a[26:27], v6 offset:56320
    v_mfma_f32_32x32x16_bf16 v[112:127], v[232:235], a[12:15], v[112:127]
    ds_read_b64_tr_b16 a[28:29], v9 offset:55296
    ds_read_b64_tr_b16 a[30:31], v9 offset:56320
    s_waitcnt lgkmcnt(4)
    v_mfma_f32_32x32x16_bf16 v[64:79], a[16:19], v[236:239], v[64:79]
    ds_read_b64_tr_b16 a[0:1], v6 offset:40960
    ds_read_b64_tr_b16 a[2:3], v6 offset:41984
    v_cvt_pk_bf16_f32 v240, v40, v41
    v_cvt_pk_bf16_f32 v241, v42, v43
    v_mfma_f32_32x32x16_bf16 v[80:95], a[20:23], v[236:239], v[80:95]
    ds_read_b64_tr_b16 a[4:5], v9 offset:40960
    ds_read_b64_tr_b16 a[6:7], v9 offset:41984
    v_cvt_pk_bf16_f32 v242, v44, v45
    v_cvt_pk_bf16_f32 v243, v46, v47
    s_waitcnt lgkmcnt(4)
    v_mfma_f32_32x32x16_bf16 v[96:111], v[236:239], a[24:27], v[96:111]
    buffer_load_dwordx4 v58, s[56:59], s76 offen offset:2048 lds
    ds_read_b64_tr_b16 a[8:9], v6 offset:57344
    ds_read_b64_tr_b16 a[10:11], v6 offset:58368
    v_cvt_pk_bf16_f32 v244, v48, v49
    v_cvt_pk_bf16_f32 v245, v50, v51
    v_mfma_f32_32x32x16_bf16 v[112:127], v[236:239], a[28:31], v[112:127]
    ds_read_b64_tr_b16 a[12:13], v9 offset:57344
    ds_read_b64_tr_b16 a[14:15], v9 offset:58368
    v_cvt_pk_bf16_f32 v246, v52, v53
    v_cvt_pk_bf16_f32 v247, v54, v55
    s_waitcnt lgkmcnt(4)
    v_mfma_f32_32x32x16_bf16 v[64:79], a[0:3], v[240:243], v[64:79]
    buffer_load_dwordx4 v59, s[56:59], s76 offen offset:3072 lds
    ds_read_b64_tr_b16 a[16:17], v6 offset:43008
    ds_read_b64_tr_b16 a[18:19], v6 offset:44032
    v_mfma_f32_32x32x16_bf16 v[40:55], a[184:187], v[248:251], v[24:39]
    s_lshl_b32 s3, s2, 2
    s_add_u32 s3, s3, s24
    s_mul_i32 s4, s3, 1536
    s_and_b32 s5, s24, 1
    s_lshl_b32 s6, s2, 1
    s_add_u32 s6, s6, s5
    s_mul_i32 s6, s6, 3584
    v_mfma_f32_32x32x16_bf16 v[80:95], a[4:7], v[240:243], v[80:95]
    buffer_load_dword v60, v2, s[12:15], s4 offen
    ds_read_b64_tr_b16 a[20:21], v9 offset:43008
    ds_read_b64_tr_b16 a[22:23], v9 offset:44032
    v_mfma_f32_32x32x16_bf16 v[40:55], a[188:191], v[252:255], v[40:55]
    s_mov_b32 exec_hi, 0
    buffer_load_dword v60, v2, s[12:15], s4 offen offset:1024
    s_mov_b32 exec_hi, -1
    s_waitcnt lgkmcnt(4)
    v_mfma_f32_32x32x16_bf16 v[96:111], v[240:243], a[8:11], v[96:111]
    ds_read_b64_tr_b16 a[24:25], v6 offset:59392
    ds_read_b64_tr_b16 a[26:27], v6 offset:60416
    v_mfma_f32_32x32x16_bf16 v[112:127], v[240:243], a[12:15], v[112:127]
    ds_read_b64_tr_b16 a[28:29], v9 offset:59392
    ds_read_b64_tr_b16 a[30:31], v9 offset:60416
    s_waitcnt lgkmcnt(4)
    v_mfma_f32_32x32x16_bf16 v[64:79], a[16:19], v[244:247], v[64:79]
    ds_read_b64_tr_b16 a[0:1], v6 offset:45056
    ds_read_b64_tr_b16 a[2:3], v6 offset:46080
    v_cvt_pk_bf16_f32 v248, v40, v41
    v_cvt_pk_bf16_f32 v249, v42, v43
    v_mfma_f32_32x32x16_bf16 v[80:95], a[20:23], v[244:247], v[80:95]
    ds_read_b64_tr_b16 a[4:5], v9 offset:45056
    ds_read_b64_tr_b16 a[6:7], v9 offset:46080
    v_cvt_pk_bf16_f32 v250, v44, v45
    v_cvt_pk_bf16_f32 v251, v46, v47
    s_waitcnt lgkmcnt(4)
    v_mfma_f32_32x32x16_bf16 v[96:111], v[244:247], a[24:27], v[96:111]
    buffer_load_dword v60, v2, s[16:19], s6 offen offset:0
    ds_read_b64_tr_b16 a[8:9], v6 offset:61440
    ds_read_b64_tr_b16 a[10:11], v6 offset:62464
    v_cvt_pk_bf16_f32 v252, v48, v49
    v_cvt_pk_bf16_f32 v253, v50, v51
    v_mfma_f32_32x32x16_bf16 v[112:127], v[244:247], a[28:31], v[112:127]
    ds_read_b64_tr_b16 a[12:13], v9 offset:61440
    ds_read_b64_tr_b16 a[14:15], v9 offset:62464
    v_cvt_pk_bf16_f32 v254, v52, v53
    v_cvt_pk_bf16_f32 v255, v54, v55
    s_waitcnt lgkmcnt(4)
    v_mfma_f32_32x32x16_bf16 v[64:79], a[0:3], v[248:251], v[64:79]
    buffer_load_dword v60, v2, s[16:19], s6 offen offset:1024
    ds_read_b64_tr_b16 a[16:17], v6 offset:47104
    ds_read_b64_tr_b16 a[18:19], v6 offset:48128
    v_mfma_f32_32x32x16_bf16 v[40:55], a[184:187], v[128:131], v[24:39]
    v_mfma_f32_32x32x16_bf16 v[80:95], a[4:7], v[248:251], v[80:95]
    buffer_load_dword v60, v2, s[16:19], s6 offen offset:2048
    ds_read_b64_tr_b16 a[20:21], v9 offset:47104
    ds_read_b64_tr_b16 a[22:23], v9 offset:48128
    v_mfma_f32_32x32x16_bf16 v[40:55], a[188:191], v[132:135], v[40:55]
    s_mov_b32 exec_hi, 0
    buffer_load_dword v60, v2, s[16:19], s6 offen offset:3072
    s_mov_b32 exec_hi, -1
    s_waitcnt lgkmcnt(4)
    v_mfma_f32_32x32x16_bf16 v[96:111], v[248:251], a[8:11], v[96:111]
    ds_read_b64_tr_b16 a[24:25], v6 offset:63488
    ds_read_b64_tr_b16 a[26:27], v6 offset:64512
    v_mfma_f32_32x32x16_bf16 v[112:127], v[248:251], a[12:15], v[112:127]
    ds_read_b64_tr_b16 a[28:29], v9 offset:63488
    ds_read_b64_tr_b16 a[30:31], v9 offset:64512
    s_waitcnt vmcnt(22)
    s_barrier
    s_waitcnt lgkmcnt(4)
    v_mfma_f32_32x32x16_bf16 v[64:79], a[16:19], v[252:255], v[64:79]
    ds_read_b64_tr_b16 a[0:1], v7 offset:0
    ds_read_b64_tr_b16 a[2:3], v7 offset:1024
    v_cvt_pk_bf16_f32 v128, v40, v41
    v_cvt_pk_bf16_f32 v129, v42, v43
    v_cvt_pk_bf16_f32 v130, v44, v45
    v_mfma_f32_32x32x16_bf16 v[80:95], a[20:23], v[252:255], v[80:95]
    ds_read_b64_tr_b16 a[4:5], v10 offset:0
    ds_read_b64_tr_b16 a[6:7], v10 offset:1024
    v_cvt_pk_bf16_f32 v131, v46, v47
    v_accvgpr_write_b32 a192, v128
    v_cvt_pk_bf16_f32 v132, v48, v49
    s_waitcnt lgkmcnt(4)
    v_mfma_f32_32x32x16_bf16 v[96:111], v[252:255], a[24:27], v[96:111]
    ds_read_b64_tr_b16 a[8:9], v7 offset:16384
    ds_read_b64_tr_b16 a[10:11], v7 offset:17408
    v_accvgpr_write_b32 a193, v129
    v_cvt_pk_bf16_f32 v133, v50, v51
    v_accvgpr_write_b32 a194, v130
    v_mfma_f32_32x32x16_bf16 v[112:127], v[252:255], a[28:31], v[112:127]
    ds_read_b64_tr_b16 a[12:13], v10 offset:16384
    ds_read_b64_tr_b16 a[14:15], v10 offset:17408
    v_cvt_pk_bf16_f32 v134, v52, v53
    v_accvgpr_write_b32 a195, v131
    v_cvt_pk_bf16_f32 v135, v54, v55
    s_waitcnt lgkmcnt(4)
    v_mfma_f32_32x32x16_bf16 v[64:79], a[0:3], a[192:195], v[64:79]
    ds_read_b64_tr_b16 a[16:17], v7 offset:2048
    ds_read_b64_tr_b16 a[18:19], v7 offset:3072
    s_waitcnt vmcnt(10)
    ds_read_b64_tr_b16 a[32:33], v8 offset:0
    v_accvgpr_write_b32 a196, v132
    v_mfma_f32_32x32x16_bf16 v[40:55], a[184:187], v[136:139], v[24:39]
    ds_read_b64_tr_b16 a[34:35], v8 offset:1024
    ds_read_b64_tr_b16 a[36:37], v11 offset:0
    ds_read_b64_tr_b16 a[38:39], v11 offset:1024
    v_mfma_f32_32x32x16_bf16 v[80:95], a[4:7], a[192:195], v[80:95]
    ds_read_b64_tr_b16 a[20:21], v10 offset:2048
    ds_read_b64_tr_b16 a[22:23], v10 offset:3072
    v_accvgpr_write_b32 a197, v133
    v_mfma_f32_32x32x16_bf16 v[40:55], a[188:191], v[140:143], v[40:55]
    ds_read_b64_tr_b16 a[40:41], v8 offset:2048
    s_waitcnt lgkmcnt(9)
    v_mfma_f32_32x32x16_bf16 v[96:111], a[192:195], a[8:11], v[96:111]
    ds_read_b64_tr_b16 a[24:25], v7 offset:18432
    ds_read_b64_tr_b16 a[26:27], v7 offset:19456
    v_accvgpr_write_b32 a198, v134
    v_mfma_f32_32x32x16_bf16 v[112:127], a[192:195], a[12:15], v[112:127]
    ds_read_b64_tr_b16 a[28:29], v10 offset:18432
    ds_read_b64_tr_b16 a[30:31], v10 offset:19456
    v_accvgpr_write_b32 a199, v135
    s_waitcnt lgkmcnt(5)
    s_nop 0
    v_mfma_f32_32x32x16_bf16 v[64:79], a[16:19], a[196:199], v[64:79]
    ds_read_b64_tr_b16 a[0:1], v7 offset:4096
    ds_read_b64_tr_b16 a[2:3], v7 offset:5120
    v_cvt_pk_bf16_f32 v136, v40, v41
    v_cvt_pk_bf16_f32 v137, v42, v43
    v_cvt_pk_bf16_f32 v138, v44, v45
    v_mfma_f32_32x32x16_bf16 v[80:95], a[20:23], a[196:199], v[80:95]
    ds_read_b64_tr_b16 a[4:5], v10 offset:4096
    ds_read_b64_tr_b16 a[6:7], v10 offset:5120
    v_cvt_pk_bf16_f32 v139, v46, v47
    v_accvgpr_write_b32 a200, v136
    v_cvt_pk_bf16_f32 v140, v48, v49
    s_waitcnt lgkmcnt(4)
    v_mfma_f32_32x32x16_bf16 v[96:111], a[196:199], a[24:27], v[96:111]
    ds_read_b64_tr_b16 a[8:9], v7 offset:20480
    ds_read_b64_tr_b16 a[10:11], v7 offset:21504
    v_accvgpr_write_b32 a201, v137
    v_cvt_pk_bf16_f32 v141, v50, v51
    v_accvgpr_write_b32 a202, v138
    v_mfma_f32_32x32x16_bf16 v[112:127], a[196:199], a[28:31], v[112:127]
    ds_read_b64_tr_b16 a[12:13], v10 offset:20480
    ds_read_b64_tr_b16 a[14:15], v10 offset:21504
    v_cvt_pk_bf16_f32 v142, v52, v53
    v_accvgpr_write_b32 a203, v139
    v_cvt_pk_bf16_f32 v143, v54, v55
    s_waitcnt lgkmcnt(4)
    v_mfma_f32_32x32x16_bf16 v[64:79], a[0:3], a[200:203], v[64:79]
    ds_read_b64_tr_b16 a[16:17], v7 offset:6144
    ds_read_b64_tr_b16 a[18:19], v7 offset:7168
    ds_read_b64_tr_b16 a[42:43], v8 offset:3072
    v_accvgpr_write_b32 a204, v140
    v_mfma_f32_32x32x16_bf16 v[40:55], a[184:187], v[144:147], v[24:39]
    ds_read_b64_tr_b16 a[44:45], v11 offset:2048
    ds_read_b64_tr_b16 a[46:47], v11 offset:3072
    s_waitcnt lgkmcnt(0)
    s_add_u32 m0, s48, 0
    s_bfe_u32 s76, s75, 0x80008
    s_lshl_b32 s76, s76, 14
    s_add_u32 s76, s76, s74
    v_mfma_f32_32x32x16_bf16 v[80:95], a[4:7], a[200:203], v[80:95]
    buffer_load_dwordx4 v56, s[56:59], s76 offen offset:0 lds
    ds_read_b64_tr_b16 a[20:21], v10 offset:6144
    ds_read_b64_tr_b16 a[22:23], v10 offset:7168
    v_accvgpr_write_b32 a205, v141
    v_mfma_f32_32x32x16_bf16 v[40:55], a[188:191], v[148:151], v[40:55]
    v_mfma_f32_32x32x16_bf16 v[96:111], a[200:203], a[8:11], v[96:111]
    buffer_load_dwordx4 v57, s[56:59], s76 offen offset:1024 lds
    ds_read_b64_tr_b16 a[24:25], v7 offset:22528
    ds_read_b64_tr_b16 a[26:27], v7 offset:23552
    v_accvgpr_write_b32 a206, v142
    v_mfma_f32_32x32x16_bf16 v[112:127], a[200:203], a[12:15], v[112:127]
    ds_read_b64_tr_b16 a[28:29], v10 offset:22528
    ds_read_b64_tr_b16 a[30:31], v10 offset:23552
    v_accvgpr_write_b32 a207, v143
    s_waitcnt lgkmcnt(4)
    s_nop 0
    v_mfma_f32_32x32x16_bf16 v[64:79], a[16:19], a[204:207], v[64:79]
    ds_read_b64_tr_b16 a[0:1], v7 offset:8192
    ds_read_b64_tr_b16 a[2:3], v7 offset:9216
    v_cvt_pk_bf16_f32 v144, v40, v41
    v_cvt_pk_bf16_f32 v145, v42, v43
    v_cvt_pk_bf16_f32 v146, v44, v45
    v_mfma_f32_32x32x16_bf16 v[80:95], a[20:23], a[204:207], v[80:95]
    ds_read_b64_tr_b16 a[4:5], v10 offset:8192
    ds_read_b64_tr_b16 a[6:7], v10 offset:9216
    v_cvt_pk_bf16_f32 v147, v46, v47
    v_accvgpr_write_b32 a208, v144
    v_cvt_pk_bf16_f32 v148, v48, v49
    s_waitcnt lgkmcnt(4)
    v_mfma_f32_32x32x16_bf16 v[96:111], a[204:207], a[24:27], v[96:111]
    ds_read_b64_tr_b16 a[8:9], v7 offset:24576
    ds_read_b64_tr_b16 a[10:11], v7 offset:25600
    v_accvgpr_write_b32 a209, v145
    v_cvt_pk_bf16_f32 v149, v50, v51
    v_accvgpr_write_b32 a210, v146
    v_mfma_f32_32x32x16_bf16 v[112:127], a[204:207], a[28:31], v[112:127]
    ds_read_b64_tr_b16 a[12:13], v10 offset:24576
    ds_read_b64_tr_b16 a[14:15], v10 offset:25600
    v_cvt_pk_bf16_f32 v150, v52, v53
    v_accvgpr_write_b32 a211, v147
    v_cvt_pk_bf16_f32 v151, v54, v55
    s_waitcnt lgkmcnt(4)
    v_mfma_f32_32x32x16_bf16 v[64:79], a[0:3], a[208:211], v[64:79]
    ds_read_b64_tr_b16 a[16:17], v7 offset:10240
    ds_read_b64_tr_b16 a[18:19], v7 offset:11264
    v_accvgpr_write_b32 a212, v148
    v_mfma_f32_32x32x16_bf16 v[40:55], a[184:187], v[152:155], v[24:39]
    buffer_load_dwordx4 v58, s[56:59], s76 offen offset:2048 lds
    v_mfma_f32_32x32x16_bf16 v[80:95], a[4:7], a[208:211], v[80:95]
    buffer_load_dwordx4 v59, s[56:59], s76 offen offset:3072 lds
    ds_read_b64_tr_b16 a[20:21], v10 offset:10240
    ds_read_b64_tr_b16 a[22:23], v10 offset:11264
    s_add_u32 m0, s33, 0
    s_add_u32 s34, s37, s72
    v_accvgpr_write_b32 a213, v149
    v_mfma_f32_32x32x16_bf16 v[40:55], a[188:191], v[156:159], v[40:55]
    buffer_load_dwordx4 v16, s[12:15], s34 offen offset:0 lds
    s_waitcnt lgkmcnt(4)
    v_mfma_f32_32x32x16_bf16 v[96:111], a[208:211], a[8:11], v[96:111]
    buffer_load_dwordx4 v17, s[12:15], s34 offen offset:1024 lds
    ds_read_b64_tr_b16 a[24:25], v7 offset:26624
    ds_read_b64_tr_b16 a[26:27], v7 offset:27648
    v_accvgpr_write_b32 a214, v150
    v_mfma_f32_32x32x16_bf16 v[112:127], a[208:211], a[12:15], v[112:127]
    buffer_load_dwordx4 v18, s[12:15], s34 offen offset:2048 lds
    ds_read_b64_tr_b16 a[28:29], v10 offset:26624
    ds_read_b64_tr_b16 a[30:31], v10 offset:27648
    v_accvgpr_write_b32 a215, v151
    s_waitcnt lgkmcnt(4)
    s_nop 0
    v_mfma_f32_32x32x16_bf16 v[64:79], a[16:19], a[212:215], v[64:79]
    buffer_load_dwordx4 v19, s[12:15], s34 offen offset:3072 lds
    ds_read_b64_tr_b16 a[0:1], v7 offset:12288
    ds_read_b64_tr_b16 a[2:3], v7 offset:13312
    v_cvt_pk_bf16_f32 v152, v40, v41
    v_cvt_pk_bf16_f32 v153, v42, v43
    v_cvt_pk_bf16_f32 v154, v44, v45
    v_mfma_f32_32x32x16_bf16 v[80:95], a[20:23], a[212:215], v[80:95]
    ds_read_b64_tr_b16 a[4:5], v10 offset:12288
    ds_read_b64_tr_b16 a[6:7], v10 offset:13312
    v_cvt_pk_bf16_f32 v155, v46, v47
    v_accvgpr_write_b32 a216, v152
    v_cvt_pk_bf16_f32 v156, v48, v49
    s_waitcnt lgkmcnt(4)
    v_mfma_f32_32x32x16_bf16 v[96:111], a[212:215], a[24:27], v[96:111]
    ds_read_b64_tr_b16 a[8:9], v7 offset:28672
    ds_read_b64_tr_b16 a[10:11], v7 offset:29696
    v_accvgpr_write_b32 a217, v153
    v_cvt_pk_bf16_f32 v157, v50, v51
    v_accvgpr_write_b32 a218, v154
    v_mfma_f32_32x32x16_bf16 v[112:127], a[212:215], a[28:31], v[112:127]
    ds_read_b64_tr_b16 a[12:13], v10 offset:28672
    ds_read_b64_tr_b16 a[14:15], v10 offset:29696
    v_cvt_pk_bf16_f32 v158, v52, v53
    v_accvgpr_write_b32 a219, v155
    v_cvt_pk_bf16_f32 v159, v54, v55
    s_waitcnt lgkmcnt(4)
    v_mfma_f32_32x32x16_bf16 v[64:79], a[0:3], a[216:219], v[64:79]
    ds_read_b64_tr_b16 a[16:17], v7 offset:14336
    ds_read_b64_tr_b16 a[18:19], v7 offset:15360
    s_add_u32 m0, s33, 4096
    s_add_u32 s34, s34, 98304
    v_accvgpr_write_b32 a220, v156
    v_mfma_f32_32x32x16_bf16 v[40:55], a[184:187], v[160:163], v[24:39]
    buffer_load_dwordx4 v16, s[12:15], s34 offen offset:0 lds
    v_mfma_f32_32x32x16_bf16 v[80:95], a[4:7], a[216:219], v[80:95]
    buffer_load_dwordx4 v17, s[12:15], s34 offen offset:1024 lds
    ds_read_b64_tr_b16 a[20:21], v10 offset:14336
    ds_read_b64_tr_b16 a[22:23], v10 offset:15360
    v_accvgpr_write_b32 a221, v157
    v_mfma_f32_32x32x16_bf16 v[40:55], a[188:191], v[164:167], v[40:55]
    buffer_load_dwordx4 v18, s[12:15], s34 offen offset:2048 lds
    s_waitcnt lgkmcnt(4)
    v_mfma_f32_32x32x16_bf16 v[96:111], a[216:219], a[8:11], v[96:111]
    buffer_load_dwordx4 v19, s[12:15], s34 offen offset:3072 lds
    ds_read_b64_tr_b16 a[24:25], v7 offset:30720
    ds_read_b64_tr_b16 a[26:27], v7 offset:31744
    s_lshl_b32 s3, s2, 2
    s_add_u32 s3, s3, s24
    s_mul_i32 s4, s3, 1792
    s_lshl_b32 s5, s3, 9
    v_accvgpr_write_b32 a222, v158
    v_mfma_f32_32x32x16_bf16 v[112:127], a[216:219], a[12:15], v[112:127]
    buffer_load_dword v60, v2, s[56:59], s4 offen
    ds_read_b64_tr_b16 a[28:29], v10 offset:30720
    ds_read_b64_tr_b16 a[30:31], v10 offset:31744
    v_accvgpr_write_b32 a223, v159
    s_barrier
    s_waitcnt lgkmcnt(4)
    v_mfma_f32_32x32x16_bf16 v[64:79], a[16:19], a[220:223], v[64:79]
    buffer_load_dword v60, v2, s[56:59], s4 offen offset:768
    ds_read_b64_tr_b16 a[0:1], v7 offset:32768
    ds_read_b64_tr_b16 a[2:3], v7 offset:33792
    v_cvt_pk_bf16_f32 v160, v40, v41
    v_cvt_pk_bf16_f32 v161, v42, v43
    v_cvt_pk_bf16_f32 v162, v44, v45
    v_mfma_f32_32x32x16_bf16 v[80:95], a[20:23], a[220:223], v[80:95]
    ds_read_b64_tr_b16 a[4:5], v10 offset:32768
    ds_read_b64_tr_b16 a[6:7], v10 offset:33792
    v_cvt_pk_bf16_f32 v163, v46, v47
    v_accvgpr_write_b32 a224, v160
    v_cvt_pk_bf16_f32 v164, v48, v49
    s_waitcnt lgkmcnt(4)
    v_mfma_f32_32x32x16_bf16 v[96:111], a[220:223], a[24:27], v[96:111]
    ds_read_b64_tr_b16 a[8:9], v7 offset:49152
    ds_read_b64_tr_b16 a[10:11], v7 offset:50176
    v_accvgpr_write_b32 a225, v161
    v_cvt_pk_bf16_f32 v165, v50, v51
    v_accvgpr_write_b32 a226, v162
    v_mfma_f32_32x32x16_bf16 v[112:127], a[220:223], a[28:31], v[112:127]
    ds_read_b64_tr_b16 a[12:13], v10 offset:49152
    ds_read_b64_tr_b16 a[14:15], v10 offset:50176
    v_cvt_pk_bf16_f32 v166, v52, v53
    v_accvgpr_write_b32 a227, v163
    v_cvt_pk_bf16_f32 v167, v54, v55
    s_mov_b32 exec_hi, 0
    buffer_load_dword v60, v2, s[80:83], s5 offen
    s_mov_b32 exec_hi, -1
    s_cmp_lg_u32 s24, 0
    s_cbranch_scc1 L_ct_1
    s_and_b32 s3, s35, 15
    s_mul_i32 s3, s3, 768
    s_add_u32 s3, s3, 0x2bb8
    v_lshlrev_b32 v14, 7, v1
    v_add_u32 v14, s3, v14
    v_min_u32 v14, 0xbde8, v14
    v_mov_b32 v15, s101
    v_add_co_u32 v14, vcc, s100, v14
    s_nop 1
    v_addc_co_u32 v15, vcc, 0, v15, vcc
    s_mov_b64 exec, 63
    global_load_dword v60, v[14:15], off
    s_mov_b64 exec, -1
L_ct_1:
    s_waitcnt lgkmcnt(4)
    v_mfma_f32_32x32x16_bf16 v[64:79], a[0:3], a[224:227], v[64:79]
    ds_read_b64_tr_b16 a[16:17], v7 offset:34816
    ds_read_b64_tr_b16 a[18:19], v7 offset:35840
    s_waitcnt vmcnt(21)
    ds_read_b64_tr_b16 a[48:49], v8 offset:4096
    v_accvgpr_write_b32 a228, v164
    v_mfma_f32_32x32x16_bf16 v[40:55], a[184:187], v[168:171], v[24:39]
    ds_read_b64_tr_b16 a[50:51], v8 offset:5120
    ds_read_b64_tr_b16 a[52:53], v11 offset:4096
    ds_read_b64_tr_b16 a[54:55], v11 offset:5120
    v_mfma_f32_32x32x16_bf16 v[80:95], a[4:7], a[224:227], v[80:95]
    ds_read_b64_tr_b16 a[20:21], v10 offset:34816
    ds_read_b64_tr_b16 a[22:23], v10 offset:35840
    v_accvgpr_write_b32 a229, v165
    v_mfma_f32_32x32x16_bf16 v[40:55], a[188:191], v[172:175], v[40:55]
    ds_read_b64_tr_b16 a[56:57], v8 offset:6144
    s_waitcnt lgkmcnt(9)
    v_mfma_f32_32x32x16_bf16 v[96:111], a[224:227], a[8:11], v[96:111]
    ds_read_b64_tr_b16 a[24:25], v7 offset:51200
    ds_read_b64_tr_b16 a[26:27], v7 offset:52224
    v_accvgpr_write_b32 a230, v166
    v_mfma_f32_32x32x16_bf16 v[112:127], a[224:227], a[12:15], v[112:127]
    ds_read_b64_tr_b16 a[28:29], v10 offset:51200
    ds_read_b64_tr_b16 a[30:31], v10 offset:52224
    v_accvgpr_write_b32 a231, v167
    s_waitcnt lgkmcnt(5)
    s_nop 0
    v_mfma_f32_32x32x16_bf16 v[64:79], a[16:19], a[228:231], v[64:79]
    ds_read_b64_tr_b16 a[0:1], v7 offset:36864
    ds_read_b64_tr_b16 a[2:3], v7 offset:37888
    v_cvt_pk_bf16_f32 v168, v40, v41
    v_cvt_pk_bf16_f32 v169, v42, v43
    v_cvt_pk_bf16_f32 v170, v44, v45
    v_mfma_f32_32x32x16_bf16 v[80:95], a[20:23], a[228:231], v[80:95]
    ds_read_b64_tr_b16 a[4:5], v10 offset:36864
    ds_read_b64_tr_b16 a[6:7], v10 offset:37888
    v_cvt_pk_bf16_f32 v171, v46, v47
    v_accvgpr_write_b32 a232, v168
    v_cvt_pk_bf16_f32 v172, v48, v49
    s_waitcnt lgkmcnt(4)
    v_mfma_f32_32x32x16_bf16 v[96:111], a[228:231], a[24:27], v[96:111]
    ds_read_b64_tr_b16 a[8:9], v7 offset:53248
    ds_read_b64_tr_b16 a[10:11], v7 offset:54272
    v_accvgpr_write_b32 a233, v169
    v_cvt_pk_bf16_f32 v173, v50, v51
    v_accvgpr_write_b32 a234, v170
    v_mfma_f32_32x32x16_bf16 v[112:127], a[228:231], a[28:31], v[112:127]
    ds_read_b64_tr_b16 a[12:13], v10 offset:53248
    ds_read_b64_tr_b16 a[14:15], v10 offset:54272
    v_cvt_pk_bf16_f32 v174, v52, v53
    v_accvgpr_write_b32 a235, v171
    v_cvt_pk_bf16_f32 v175, v54, v55
    s_waitcnt lgkmcnt(4)
    v_mfma_f32_32x32x16_bf16 v[64:79], a[0:3], a[232:235], v[64:79]
    ds_read_b64_tr_b16 a[16:17], v7 offset:38912
    ds_read_b64_tr_b16 a[18:19], v7 offset:39936
    ds_read_b64_tr_b16 a[58:59], v8 offset:7168
    v_accvgpr_write_b32 a236, v172
    v_mfma_f32_32x32x16_bf16 v[40:55], a[184:187], v[176:179], v[24:39]
    ds_read_b64_tr_b16 a[60:61], v11 offset:6144
    ds_read_b64_tr_b16 a[62:63], v11 offset:7168
    s_waitcnt lgkmcnt(0)
    s_add_u32 m0, s48, 4096
    s_add_u32 s76, s76, 32768
    v_mfma_f32_32x32x16_bf16 v[80:95], a[4:7], a[232:235], v[80:95]
    buffer_load_dwordx4 v56, s[56:59], s76 offen offset:0 lds
    ds_read_b64_tr_b16 a[20:21], v10 offset:38912
    ds_read_b64_tr_b16 a[22:23], v10 offset:39936
    v_accvgpr_write_b32 a237, v173
    v_mfma_f32_32x32x16_bf16 v[40:55], a[188:191], v[180:183], v[40:55]
    v_mfma_f32_32x32x16_bf16 v[96:111], a[232:235], a[8:11], v[96:111]
    buffer_load_dwordx4 v57, s[56:59], s76 offen offset:1024 lds
    ds_read_b64_tr_b16 a[24:25], v7 offset:55296
    ds_read_b64_tr_b16 a[26:27], v7 offset:56320
    v_accvgpr_write_b32 a238, v174
    v_mfma_f32_32x32x16_bf16 v[112:127], a[232:235], a[12:15], v[112:127]
    ds_read_b64_tr_b16 a[28:29], v10 offset:55296
    ds_read_b64_tr_b16 a[30:31], v10 offset:56320
    v_accvgpr_write_b32 a239, v175
    s_waitcnt lgkmcnt(4)
    s_nop 0
    v_mfma_f32_32x32x16_bf16 v[64:79], a[16:19], a[236:239], v[64:79]
    ds_read_b64_tr_b16 a[0:1], v7 offset:40960
    ds_read_b64_tr_b16 a[2:3], v7 offset:41984
    v_cvt_pk_bf16_f32 v176, v40, v41
    v_cvt_pk_bf16_f32 v177, v42, v43
    v_cvt_pk_bf16_f32 v178, v44, v45
    v_mfma_f32_32x32x16_bf16 v[80:95], a[20:23], a[236:239], v[80:95]
    ds_read_b64_tr_b16 a[4:5], v10 offset:40960
    ds_read_b64_tr_b16 a[6:7], v10 offset:41984
    v_cvt_pk_bf16_f32 v179, v46, v47
    v_accvgpr_write_b32 a240, v176
    v_cvt_pk_bf16_f32 v180, v48, v49
    s_waitcnt lgkmcnt(4)
    v_mfma_f32_32x32x16_bf16 v[96:111], a[236:239], a[24:27], v[96:111]
    ds_read_b64_tr_b16 a[8:9], v7 offset:57344
    ds_read_b64_tr_b16 a[10:11], v7 offset:58368
    v_accvgpr_write_b32 a241, v177
    v_cvt_pk_bf16_f32 v181, v50, v51
    v_accvgpr_write_b32 a242, v178
    v_mfma_f32_32x32x16_bf16 v[112:127], a[236:239], a[28:31], v[112:127]
    ds_read_b64_tr_b16 a[12:13], v10 offset:57344
    ds_read_b64_tr_b16 a[14:15], v10 offset:58368
    v_cvt_pk_bf16_f32 v182, v52, v53
    v_accvgpr_write_b32 a243, v179
    v_cvt_pk_bf16_f32 v183, v54, v55
    s_waitcnt lgkmcnt(4)
    v_mfma_f32_32x32x16_bf16 v[64:79], a[0:3], a[240:243], v[64:79]
    ds_read_b64_tr_b16 a[16:17], v7 offset:43008
    ds_read_b64_tr_b16 a[18:19], v7 offset:44032
    v_accvgpr_write_b32 a244, v180
    v_mfma_f32_32x32x16_bf16 v[40:55], a[184:187], v[184:187], v[24:39]
    buffer_load_dwordx4 v58, s[56:59], s76 offen offset:2048 lds
    v_mfma_f32_32x32x16_bf16 v[80:95], a[4:7], a[240:243], v[80:95]
    buffer_load_dwordx4 v59, s[56:59], s76 offen offset:3072 lds
    ds_read_b64_tr_b16 a[20:21], v10 offset:43008
    ds_read_b64_tr_b16 a[22:23], v10 offset:44032
    v_accvgpr_write_b32 a245, v181
    v_mfma_f32_32x32x16_bf16 v[40:55], a[188:191], v[188:191], v[40:55]
    s_add_u32 m0, s33, 32768
    s_add_u32 s34, s37, s73
    s_waitcnt lgkmcnt(4)
    v_mfma_f32_32x32x16_bf16 v[96:111], a[240:243], a[8:11], v[96:111]
    buffer_load_dwordx4 v16, s[12:15], s34 offen offset:0 lds
    ds_read_b64_tr_b16 a[24:25], v7 offset:59392
    ds_read_b64_tr_b16 a[26:27], v7 offset:60416
    v_accvgpr_write_b32 a246, v182
    v_mfma_f32_32x32x16_bf16 v[112:127], a[240:243], a[12:15], v[112:127]
    ds_read_b64_tr_b16 a[28:29], v10 offset:59392
    ds_read_b64_tr_b16 a[30:31], v10 offset:60416
    v_accvgpr_write_b32 a247, v183
    s_waitcnt lgkmcnt(4)
    s_nop 0
    v_mfma_f32_32x32x16_bf16 v[64:79], a[16:19], a[244:247], v[64:79]
    buffer_load_dwordx4 v17, s[12:15], s34 offen offset:1024 lds
    ds_read_b64_tr_b16 a[0:1], v7 offset:45056
    ds_read_b64_tr_b16 a[2:3], v7 offset:46080
    v_cvt_pk_bf16_f32 v184, v40, v41
    v_cvt_pk_bf16_f32 v185, v42, v43
    v_cvt_pk_bf16_f32 v186, v44, v45
    v_mfma_f32_32x32x16_bf16 v[80:95], a[20:23], a[244:247], v[80:95]
    ds_read_b64_tr_b16 a[4:5], v10 offset:45056
    ds_read_b64_tr_b16 a[6:7], v10 offset:46080
    v_cvt_pk_bf16_f32 v187, v46, v47
    v_accvgpr_write_b32 a248, v184
    v_cvt_pk_bf16_f32 v188, v48, v49
    s_waitcnt lgkmcnt(4)
    v_mfma_f32_32x32x16_bf16 v[96:111], a[244:247], a[24:27], v[96:111]
    ds_read_b64_tr_b16 a[8:9], v7 offset:61440
    ds_read_b64_tr_b16 a[10:11], v7 offset:62464
    v_accvgpr_write_b32 a249, v185
    v_cvt_pk_bf16_f32 v189, v50, v51
    v_accvgpr_write_b32 a250, v186
    v_mfma_f32_32x32x16_bf16 v[112:127], a[244:247], a[28:31], v[112:127]
    ds_read_b64_tr_b16 a[12:13], v10 offset:61440
    ds_read_b64_tr_b16 a[14:15], v10 offset:62464
    v_cvt_pk_bf16_f32 v190, v52, v53
    v_accvgpr_write_b32 a251, v187
    v_cvt_pk_bf16_f32 v191, v54, v55
    s_waitcnt lgkmcnt(4)
    v_mfma_f32_32x32x16_bf16 v[64:79], a[0:3], a[248:251], v[64:79]
    ds_read_b64_tr_b16 a[16:17], v7 offset:47104
    ds_read_b64_tr_b16 a[18:19], v7 offset:48128
    v_accvgpr_write_b32 a252, v188
    v_mfma_f32_32x32x16_bf16 v[80:95], a[4:7], a[248:251], v[80:95]
    buffer_load_dwordx4 v18, s[12:15], s34 offen offset:2048 lds
    ds_read_b64_tr_b16 a[20:21], v10 offset:47104
    ds_read_b64_tr_b16 a[22:23], v10 offset:48128
    v_accvgpr_write_b32 a253, v189
    s_waitcnt lgkmcnt(4)
    v_mfma_f32_32x32x16_bf16 v[96:111], a[248:251], a[8:11], v[96:111]
    buffer_load_dwordx4 v19, s[12:15], s34 offen offset:3072 lds
    ds_read_b64_tr_b16 a[24:25], v7 offset:63488
    ds_read_b64_tr_b16 a[26:27], v7 offset:64512
    s_add_u32 m0, s33, 36864
    s_add_u32 s34, s34, 98304
    v_accvgpr_write_b32 a254, v190
    v_mfma_f32_32x32x16_bf16 v[112:127], a[248:251], a[12:15], v[112:127]
    buffer_load_dwordx4 v16, s[12:15], s34 offen offset:0 lds
    ds_read_b64_tr_b16 a[28:29], v10 offset:63488
    ds_read_b64_tr_b16 a[30:31], v10 offset:64512
    v_accvgpr_write_b32 a255, v191
    buffer_load_dwordx4 v17, s[12:15], s34 offen offset:1024 lds
    s_waitcnt vmcnt(13)
    s_barrier
    s_waitcnt lgkmcnt(4)
    v_mfma_f32_32x32x16_bf16 v[64:79], a[16:19], a[252:255], v[64:79]
    ds_read_b64_tr_b16 a[0:1], v6 offset:0
    ds_read_b64_tr_b16 a[2:3], v6 offset:1024
    v_mul_f32 v28, 0xbfb8aa3b, v0
    v_mul_f32 v29, v61, v61
    v_mul_f32 v30, 0x3eb8aa3b, v0
    v_mfma_f32_32x32x16_bf16 v[80:95], a[20:23], a[252:255], v[80:95]
    buffer_load_dwordx4 v18, s[12:15], s34 offen offset:2048 lds
    ds_read_b64_tr_b16 a[4:5], v9 offset:0
    ds_read_b64_tr_b16 a[6:7], v9 offset:1024
    v_lshrrev_b32 v31, 2, v1
    v_and_b32 v27, 3, v1
    v_lshlrev_b32 v27, 7, v27
    v_lshl_add_u32 v31, v31, 11, v27
    s_waitcnt lgkmcnt(4)
    v_mfma_f32_32x32x16_bf16 v[96:111], a[252:255], a[24:27], v[96:111]
    buffer_load_dwordx4 v19, s[12:15], s34 offen offset:3072 lds
    ds_read_b64_tr_b16 a[8:9], v6 offset:2048
    ds_read_b64_tr_b16 a[10:11], v6 offset:3072
    v_mfma_f32_32x32x16_bf16 v[112:127], a[252:255], a[28:31], v[112:127]
    ds_read_b64_tr_b16 a[12:13], v9 offset:2048
    ds_read_b64_tr_b16 a[14:15], v9 offset:3072
L_mid0:
    s_waitcnt lgkmcnt(4)
    v_mfma_f32_32x32x16_bf16 v[128:143], a[0:3], v[192:195], 0
    ds_read_b64_tr_b16 a[16:17], v6 offset:4096
    ds_read_b64_tr_b16 a[18:19], v6 offset:5120
    s_add_u32 m0, s33, 65536
    s_add_u32 s34, s38, s68
    v_mfma_f32_32x32x16_bf16 v[144:159], a[4:7], v[192:195], 0
    buffer_load_dwordx4 v20, s[16:19], s34 offen offset:0 lds
    ds_read_b64_tr_b16 a[20:21], v9 offset:4096
    ds_read_b64_tr_b16 a[22:23], v9 offset:5120
    s_waitcnt lgkmcnt(4)
    v_mfma_f32_32x32x16_bf16 v[128:143], a[8:11], v[196:199], v[128:143]
    ds_read_b64_tr_b16 a[24:25], v6 offset:6144
    ds_read_b64_tr_b16 a[26:27], v6 offset:7168
    v_mfma_f32_32x32x16_bf16 v[144:159], a[12:15], v[196:199], v[144:159]
    ds_read_b64_tr_b16 a[28:29], v9 offset:6144
    ds_read_b64_tr_b16 a[30:31], v9 offset:7168
    s_mul_i32 s60, s26, 262144
    s_lshl_b32 s61, s28, 10
    s_add_u32 s62, s60, s61
    s_add_u32 s60, s62, s61
    v_lshrrev_b32 v27, 5, v1
    v_lshlrev_b32 v27, 4, v27
    s_waitcnt lgkmcnt(4)
    v_mfma_f32_32x32x16_bf16 v[128:143], a[16:19], v[200:203], v[128:143]
    ds_read_b64_tr_b16 a[0:1], v6 offset:8192
    ds_read_b64_tr_b16 a[2:3], v6 offset:9216
    v_mul_f32 v64, v0, v64
    v_mul_f32 v65, v0, v65
    v_mfma_f32_32x32x16_bf16 v[144:159], a[20:23], v[200:203], v[144:159]
    buffer_load_dwordx4 v21, s[16:19], s34 offen offset:1024 lds
    ds_read_b64_tr_b16 a[4:5], v9 offset:8192
    ds_read_b64_tr_b16 a[6:7], v9 offset:9216
    ds_bpermute_b32 v32, v27, v0 offset:0
    v_mul_f32 v66, v0, v66
    v_mul_f32 v67, v0, v67
    s_waitcnt lgkmcnt(5)
    v_mfma_f32_32x32x16_bf16 v[128:143], a[24:27], v[204:207], v[128:143]
    ds_read_b64_tr_b16 a[8:9], v6 offset:10240
    ds_read_b64_tr_b16 a[10:11], v6 offset:11264
    ds_bpermute_b32 v33, v27, v0 offset:4
    v_mul_f32 v68, v0, v68
    v_mfma_f32_32x32x16_bf16 v[144:159], a[28:31], v[204:207], v[144:159]
    ds_read_b64_tr_b16 a[12:13], v9 offset:10240
    ds_read_b64_tr_b16 a[14:15], v9 offset:11264
    v_mul_f32 v69, v0, v69
    s_waitcnt lgkmcnt(6)
    v_mfma_f32_32x32x16_bf16 v[128:143], a[0:3], v[208:211], v[128:143]
    ds_read_b64_tr_b16 a[16:17], v6 offset:12288
    ds_read_b64_tr_b16 a[18:19], v6 offset:13312
    ds_bpermute_b32 v34, v27, v0 offset:8
    v_mul_f32 v70, v0, v70
    v_mul_f32 v71, v0, v71
    v_mfma_f32_32x32x16_bf16 v[144:159], a[4:7], v[208:211], v[144:159]
    buffer_load_dwordx4 v22, s[16:19], s34 offen offset:2048 lds
    ds_read_b64_tr_b16 a[20:21], v9 offset:12288
    ds_read_b64_tr_b16 a[22:23], v9 offset:13312
    ds_bpermute_b32 v35, v27, v0 offset:12
    v_cvt_pk_bf16_f32 v40, v64, v65
    v_cvt_pk_bf16_f32 v41, v66, v67
    s_waitcnt lgkmcnt(6)
    v_mfma_f32_32x32x16_bf16 v[128:143], a[8:11], v[212:215], v[128:143]
    ds_read_b64_tr_b16 a[24:25], v6 offset:14336
    ds_read_b64_tr_b16 a[26:27], v6 offset:15360
    v_cvt_pk_bf16_f32 v42, v68, v69
    v_cvt_pk_bf16_f32 v43, v70, v71
    v_mfma_f32_32x32x16_bf16 v[144:159], a[12:15], v[212:215], v[144:159]
    ds_read_b64_tr_b16 a[28:29], v9 offset:14336
    ds_read_b64_tr_b16 a[30:31], v9 offset:15360
    s_add_u32 s63, s62, 0xb00000
    s_waitcnt lgkmcnt(5)
    v_mfma_f32_32x32x16_bf16 v[128:143], a[16:19], v[216:219], v[128:143]
    buffer_store_dwordx4 v[40:43], v2, s[20:23], s63 offen offset:0 sc1
    ds_read_b64_tr_b16 a[0:1], v6 offset:16384
    ds_read_b64_tr_b16 a[2:3], v6 offset:17408
    v_mul_f32 v72, v0, v72
    v_mul_f32 v73, v0, v73
    v_mfma_f32_32x32x16_bf16 v[144:159], a[20:23], v[216:219], v[144:159]
    buffer_load_dwordx4 v23, s[16:19], s34 offen offset:3072 lds
    ds_read_b64_tr_b16 a[4:5], v9 offset:16384
    ds_read_b64_tr_b16 a[6:7], v9 offset:17408
    ds_bpermute_b32 v36, v27, v0 offset:32
    v_mul_f32 v74, v0, v74
    v_mul_f32 v75, v0, v75
    s_waitcnt lgkmcnt(5)
    v_mfma_f32_32x32x16_bf16 v[128:143], a[24:27], v[220:223], v[128:143]
    ds_read_b64_tr_b16 a[8:9], v6 offset:18432
    ds_read_b64_tr_b16 a[10:11], v6 offset:19456
    ds_bpermute_b32 v37, v27, v0 offset:36
    v_mul_f32 v76, v0, v76
    v_mfma_f32_32x32x16_bf16 v[144:159], a[28:31], v[220:223], v[144:159]
    ds_read_b64_tr_b16 a[12:13], v9 offset:18432
    ds_read_b64_tr_b16 a[14:15], v9 offset:19456
    s_add_u32 m0, s33, 69632
    s_add_u32 s34, s34, 114688
    v_mul_f32 v77, v0, v77
    s_waitcnt lgkmcnt(6)
    v_mfma_f32_32x32x16_bf16 v[128:143], a[0:3], v[224:227], v[128:143]
    buffer_load_dwordx4 v20, s[16:19], s34 offen offset:0 lds
    ds_read_b64_tr_b16 a[16:17], v6 offset:20480
    ds_read_b64_tr_b16 a[18:19], v6 offset:21504
    ds_bpermute_b32 v38, v27, v0 offset:40
    v_mul_f32 v78, v0, v78
    v_mul_f32 v79, v0, v79
    v_mfma_f32_32x32x16_bf16 v[144:159], a[4:7], v[224:227], v[144:159]
    ds_read_b64_tr_b16 a[20:21], v9 offset:20480
    ds_read_b64_tr_b16 a[22:23], v9 offset:21504
    ds_bpermute_b32 v39, v27, v0 offset:44
    v_cvt_pk_bf16_f32 v44, v72, v73
    v_cvt_pk_bf16_f32 v45, v74, v75
    s_waitcnt lgkmcnt(6)
    v_mfma_f32_32x32x16_bf16 v[128:143], a[8:11], v[228:231], v[128:143]
    ds_read_b64_tr_b16 a[24:25], v6 offset:22528
    ds_read_b64_tr_b16 a[26:27], v6 offset:23552
    v_cvt_pk_bf16_f32 v46, v76, v77
    v_cvt_pk_bf16_f32 v47, v78, v79
    v_mfma_f32_32x32x16_bf16 v[144:159], a[12:15], v[228:231], v[144:159]
    ds_read_b64_tr_b16 a[28:29], v9 offset:22528
    ds_read_b64_tr_b16 a[30:31], v9 offset:23552
    s_add_u32 s63, s62, 0xb10000
    s_waitcnt lgkmcnt(5)
    v_mfma_f32_32x32x16_bf16 v[128:143], a[16:19], v[232:235], v[128:143]
    buffer_store_dwordx4 v[44:47], v2, s[20:23], s63 offen offset:0 sc1
    ds_read_b64_tr_b16 a[0:1], v6 offset:24576
    ds_read_b64_tr_b16 a[2:3], v6 offset:25600
    v_mul_f32 v80, v0, v80
    v_mul_f32 v81, v0, v81
    v_mfma_f32_32x32x16_bf16 v[144:159], a[20:23], v[232:235], v[144:159]
    buffer_load_dwordx4 v21, s[16:19], s34 offen offset:1024 lds
    ds_read_b64_tr_b16 a[4:5], v9 offset:24576
    ds_read_b64_tr_b16 a[6:7], v9 offset:25600
    ds_bpermute_b32 v48, v27, v0 offset:64
    v_mul_f32 v82, v0, v82
    v_mul_f32 v83, v0, v83
    s_waitcnt lgkmcnt(5)
    v_mfma_f32_32x32x16_bf16 v[128:143], a[24:27], v[236:239], v[128:143]
    ds_read_b64_tr_b16 a[8:9], v6 offset:26624
    ds_read_b64_tr_b16 a[10:11], v6 offset:27648
    ds_bpermute_b32 v49, v27, v0 offset:68
    v_mul_f32 v84, v0, v84
    v_mfma_f32_32x32x16_bf16 v[144:159], a[28:31], v[236:239], v[144:159]
    buffer_load_dwordx4 v22, s[16:19], s34 offen offset:2048 lds
    ds_read_b64_tr_b16 a[12:13], v9 offset:26624
    ds_read_b64_tr_b16 a[14:15], v9 offset:27648
    v_mul_f32 v85, v0, v85
    s_waitcnt lgkmcnt(6)
    v_mfma_f32_32x32x16_bf16 v[128:143], a[0:3], v[240:243], v[128:143]
    ds_read_b64_tr_b16 a[16:17], v6 offset:28672
    ds_read_b64_tr_b16 a[18:19], v6 offset:29696
    ds_bpermute_b32 v50, v27, v0 offset:72
    v_mul_f32 v86, v0, v86
    v_mul_f32 v87, v0, v87
    v_mfma_f32_32x32x16_bf16 v[144:159], a[4:7], v[240:243], v[144:159]
    ds_read_b64_tr_b16 a[20:21], v9 offset:28672
    ds_read_b64_tr_b16 a[22:23], v9 offset:29696
    ds_bpermute_b32 v51, v27, v0 offset:76
    v_cvt_pk_bf16_f32 v40, v80, v81
    v_cvt_pk_bf16_f32 v41, v82, v83
    s_waitcnt lgkmcnt(6)
    v_mfma_f32_32x32x16_bf16 v[128:143], a[8:11], v[244:247], v[128:143]
    ds_read_b64_tr_b16 a[24:25], v6 offset:30720
    ds_read_b64_tr_b16 a[26:27], v6 offset:31744
    v_cvt_pk_bf16_f32 v42, v84, v85
    v_cvt_pk_bf16_f32 v43, v86, v87
    v_mfma_f32_32x32x16_bf16 v[144:159], a[12:15], v[244:247], v[144:159]
    buffer_load_dwordx4 v23, s[16:19], s34 offen offset:3072 lds
    ds_read_b64_tr_b16 a[28:29], v9 offset:30720
    ds_read_b64_tr_b16 a[30:31], v9 offset:31744
    s_add_u32 s63, s62, 0xb20000
    buffer_store_dwordx4 v[40:43], v2, s[20:23], s63 offen offset:0 sc1
    s_waitcnt vmcnt(11)
    s_barrier
    s_waitcnt lgkmcnt(5)
    v_mfma_f32_32x32x16_bf16 v[128:143], a[16:19], v[248:251], v[128:143]
    ds_read_b64_tr_b16 a[0:1], v6 offset:32768
    ds_read_b64_tr_b16 a[2:3], v6 offset:33792
    v_mul_f32 v88, v0, v88
    v_mul_f32 v89, v0, v89
    v_mfma_f32_32x32x16_bf16 v[144:159], a[20:23], v[248:251], v[144:159]
    ds_read_b64_tr_b16 a[4:5], v9 offset:32768
    ds_read_b64_tr_b16 a[6:7], v9 offset:33792
    ds_bpermute_b32 v52, v27, v0 offset:96
    v_mul_f32 v90, v0, v90
    v_mul_f32 v91, v0, v91
    s_waitcnt lgkmcnt(5)
    v_mfma_f32_32x32x16_bf16 v[128:143], a[24:27], v[252:255], v[128:143]
    ds_read_b64_tr_b16 a[8:9], v6 offset:34816
    ds_read_b64_tr_b16 a[10:11], v6 offset:35840
    ds_bpermute_b32 v53, v27, v0 offset:100
    v_mul_f32 v92, v0, v92
    v_mfma_f32_32x32x16_bf16 v[144:159], a[28:31], v[252:255], v[144:159]
    ds_read_b64_tr_b16 a[12:13], v9 offset:34816
    ds_read_b64_tr_b16 a[14:15], v9 offset:35840
    v_mul_f32 v93, v0, v93
    s_waitcnt lgkmcnt(6)
    v_mfma_f32_32x32x16_bf16 v[128:143], a[0:3], a[192:195], v[128:143]
    ds_read_b64_tr_b16 a[16:17], v6 offset:36864
    ds_read_b64_tr_b16 a[18:19], v6 offset:37888
    ds_bpermute_b32 v54, v27, v0 offset:104
    v_mul_f32 v94, v0, v94
    v_mul_f32 v95, v0, v95
    v_mfma_f32_32x32x16_bf16 v[144:159], a[4:7], a[192:195], v[144:159]
    ds_read_b64_tr_b16 a[20:21], v9 offset:36864
    ds_read_b64_tr_b16 a[22:23], v9 offset:37888
    ds_bpermute_b32 v55, v27, v0 offset:108
    v_cvt_pk_bf16_f32 v44, v88, v89
    v_cvt_pk_bf16_f32 v45, v90, v91
    s_waitcnt lgkmcnt(6)
    v_mfma_f32_32x32x16_bf16 v[128:143], a[8:11], a[196:199], v[128:143]
    ds_read_b64_tr_b16 a[24:25], v6 offset:38912
    ds_read_b64_tr_b16 a[26:27], v6 offset:39936
    ds_read_b64_tr_b16 a[64:65], v8 offset:0
    v_cvt_pk_bf16_f32 v46, v92, v93
    v_cvt_pk_bf16_f32 v47, v94, v95
    v_mfma_f32_32x32x16_bf16 v[144:159], a[12:15], a[196:199], v[144:159]
    ds_read_b64_tr_b16 a[28:29], v9 offset:38912
    ds_read_b64_tr_b16 a[30:31], v9 offset:39936
    ds_read_b64_tr_b16 a[66:67], v8 offset:1024
    s_add_u32 s63, s62, 0xb30000
    s_waitcnt lgkmcnt(6)
    v_mfma_f32_32x32x16_bf16 v[128:143], a[16:19], a[200:203], v[128:143]
    buffer_store_dwordx4 v[44:47], v2, s[20:23], s63 offen offset:0 sc1
    ds_read_b64_tr_b16 a[0:1], v6 offset:40960
    ds_read_b64_tr_b16 a[2:3], v6 offset:41984
    ds_read_b64_tr_b16 a[68:69], v11 offset:0
    v_mul_f32 v96, v32, v96
    v_mul_f32 v97, v33, v97
    v_mfma_f32_32x32x16_bf16 v[144:159], a[20:23], a[200:203], v[144:159]
    ds_read_b64_tr_b16 a[4:5], v9 offset:40960
    ds_read_b64_tr_b16 a[6:7], v9 offset:41984
    ds_read_b64_tr_b16 a[70:71], v11 offset:1024
    v_mul_f32 v98, v34, v98
    v_mul_f32 v99, v35, v99
    v_mul_f32 v100, v36, v100
    s_waitcnt lgkmcnt(7)
    v_mfma_f32_32x32x16_bf16 v[128:143], a[24:27], a[204:207], v[128:143]
    ds_read_b64_tr_b16 a[8:9], v6 offset:43008
    ds_read_b64_tr_b16 a[10:11], v6 offset:44032
    ds_read_b64_tr_b16 a[72:73], v8 offset:2048
    v_mul_f32 v101, v37, v101
    v_mul_f32 v102, v38, v102
    v_mfma_f32_32x32x16_bf16 v[144:159], a[28:31], a[204:207], v[144:159]
    ds_read_b64_tr_b16 a[12:13], v9 offset:43008
    ds_read_b64_tr_b16 a[14:15], v9 offset:44032
    v_mul_f32 v103, v39, v103
    v_cvt_pk_bf16_f32 v40, v96, v97
    s_waitcnt lgkmcnt(6)
    v_mfma_f32_32x32x16_bf16 v[128:143], a[0:3], a[208:211], v[128:143]
    ds_read_b64_tr_b16 a[16:17], v6 offset:45056
    ds_read_b64_tr_b16 a[18:19], v6 offset:46080
    ds_read_b64_tr_b16 a[74:75], v8 offset:3072
    v_cvt_pk_bf16_f32 v41, v98, v99
    v_cvt_pk_bf16_f32 v42, v100, v101
    v_mfma_f32_32x32x16_bf16 v[144:159], a[4:7], a[208:211], v[144:159]
    ds_read_b64_tr_b16 a[20:21], v9 offset:45056
    ds_read_b64_tr_b16 a[22:23], v9 offset:46080
    ds_read_b64_tr_b16 a[76:77], v11 offset:2048
    v_cvt_pk_bf16_f32 v43, v102, v103
    s_waitcnt lgkmcnt(6)
    v_mfma_f32_32x32x16_bf16 v[128:143], a[8:11], a[212:215], v[128:143]
    ds_read_b64_tr_b16 a[24:25], v6 offset:47104
    ds_read_b64_tr_b16 a[26:27], v6 offset:48128
    s_add_u32 s63, s60, 0xd00000
    v_mul_f32 v104, v48, v104
    v_mul_f32 v105, v49, v105
    v_mfma_f32_32x32x16_bf16 v[144:159], a[12:15], a[212:215], v[144:159]
    buffer_store_dwordx4 v[40:43], v2, s[20:23], s63 offen offset:0 sc1
    ds_read_b64_tr_b16 a[28:29], v9 offset:47104
    ds_read_b64_tr_b16 a[30:31], v9 offset:48128
    ds_read_b64_tr_b16 a[78:79], v11 offset:3072
    v_mul_f32 v106, v50, v106
    v_mul_f32 v107, v51, v107
    s_waitcnt lgkmcnt(6)
    v_mfma_f32_32x32x16_bf16 v[128:143], a[16:19], a[216:219], v[128:143]
    ds_read_b64_tr_b16 a[0:1], v6 offset:49152
    ds_read_b64_tr_b16 a[2:3], v6 offset:50176
    s_waitcnt lgkmcnt(2)
    s_add_u32 m0, s48, 0
    s_bfe_u32 s76, s75, 0x80010
    s_lshl_b32 s76, s76, 14
    s_add_u32 s76, s76, s74
    v_mul_f32 v108, v52, v108
    v_mul_f32 v109, v53, v109
    v_mfma_f32_32x32x16_bf16 v[144:159], a[20:23], a[216:219], v[144:159]
    buffer_load_dwordx4 v56, s[56:59], s76 offen offset:0 lds
    ds_read_b64_tr_b16 a[4:5], v9 offset:49152
    ds_read_b64_tr_b16 a[6:7], v9 offset:50176
    v_mul_f32 v110, v54, v110
    v_mul_f32 v111, v55, v111
    v_cvt_pk_bf16_f32 v44, v104, v105
    v_mfma_f32_32x32x16_bf16 v[128:143], a[24:27], a[220:223], v[128:143]
    ds_read_b64_tr_b16 a[8:9], v6 offset:51200
    ds_read_b64_tr_b16 a[10:11], v6 offset:52224
    v_cvt_pk_bf16_f32 v45, v106, v107
    v_cvt_pk_bf16_f32 v46, v108, v109
    v_mfma_f32_32x32x16_bf16 v[144:159], a[28:31], a[220:223], v[144:159]
    buffer_load_dwordx4 v57, s[56:59], s76 offen offset:1024 lds
    ds_read_b64_tr_b16 a[12:13], v9 offset:51200
    ds_read_b64_tr_b16 a[14:15], v9 offset:52224
    v_cvt_pk_bf16_f32 v47, v110, v111
    s_waitcnt lgkmcnt(4)
    v_mfma_f32_32x32x16_bf16 v[128:143], a[0:3], a[224:227], v[128:143]
    buffer_load_dwordx4 v58, s[56:59], s76 offen offset:2048 lds
    ds_read_b64_tr_b16 a[16:17], v6 offset:53248
    ds_read_b64_tr_b16 a[18:19], v6 offset:54272
    v_mul_f32 v112, v32, v112
    v_mfma_f32_32x32x16_bf16 v[144:159], a[4:7], a[224:227], v[144:159]
    buffer_store_dwordx4 v[44:47], v2, s[20:23], s63 offen offset:1024 sc1
    ds_read_b64_tr_b16 a[20:21], v9 offset:53248
    ds_read_b64_tr_b16 a[22:23], v9 offset:54272
    v_mul_f32 v113, v33, v113
    v_mul_f32 v114, v34, v114
    s_waitcnt lgkmcnt(4)
    v_mfma_f32_32x32x16_bf16 v[128:143], a[8:11], a[228:231], v[128:143]
    buffer_load_dwordx4 v59, s[56:59], s76 offen offset:3072 lds
    ds_read_b64_tr_b16 a[24:25], v6 offset:55296
    ds_read_b64_tr_b16 a[26:27], v6 offset:56320
    s_add_u32 m0, s33, 98304
    s_add_u32 s34, s38, s69
    v_mul_f32 v115, v35, v115
    v_mul_f32 v116, v36, v116
    v_mfma_f32_32x32x16_bf16 v[144:159], a[12:15], a[228:231], v[144:159]
    buffer_load_dwordx4 v20, s[16:19], s34 offen offset:0 lds
    ds_read_b64_tr_b16 a[28:29], v9 offset:55296
    ds_read_b64_tr_b16 a[30:31], v9 offset:56320
    v_mul_f32 v117, v37, v117
    v_mul_f32 v118, v38, v118
    s_waitcnt lgkmcnt(4)
    v_mfma_f32_32x32x16_bf16 v[128:143], a[16:19], a[232:235], v[128:143]
    buffer_load_dwordx4 v21, s[16:19], s34 offen offset:1024 lds
    ds_read_b64_tr_b16 a[0:1], v6 offset:57344
    ds_read_b64_tr_b16 a[2:3], v6 offset:58368
    v_mul_f32 v119, v39, v119
    v_cvt_pk_bf16_f32 v40, v112, v113
    v_cvt_pk_bf16_f32 v41, v114, v115
    v_mfma_f32_32x32x16_bf16 v[144:159], a[20:23], a[232:235], v[144:159]
    ds_read_b64_tr_b16 a[4:5], v9 offset:57344
    ds_read_b64_tr_b16 a[6:7], v9 offset:58368
    v_cvt_pk_bf16_f32 v42, v116, v117
    v_cvt_pk_bf16_f32 v43, v118, v119
    s_waitcnt lgkmcnt(4)
    v_mfma_f32_32x32x16_bf16 v[128:143], a[24:27], a[236:239], v[128:143]
    buffer_load_dwordx4 v22, s[16:19], s34 offen offset:2048 lds
    ds_read_b64_tr_b16 a[8:9], v6 offset:59392
    ds_read_b64_tr_b16 a[10:11], v6 offset:60416
    s_add_u32 s63, s60, 0xd20000
    v_mul_f32 v120, v48, v120
    v_mfma_f32_32x32x16_bf16 v[144:159], a[28:31], a[236:239], v[144:159]
    buffer_store_dwordx4 v[40:43], v2, s[20:23], s63 offen offset:0 sc1
    ds_read_b64_tr_b16 a[12:13], v9 offset:59392
    ds_read_b64_tr_b16 a[14:15], v9 offset:60416
    v_mul_f32 v121, v49, v121
    v_mul_f32 v122, v50, v122
    s_waitcnt lgkmcnt(4)
    v_mfma_f32_32x32x16_bf16 v[128:143], a[0:3], a[240:243], v[128:143]
    buffer_load_dwordx4 v23, s[16:19], s34 offen offset:3072 lds
    ds_read_b64_tr_b16 a[16:17], v6 offset:61440
    ds_read_b64_tr_b16 a[18:19], v6 offset:62464
    s_add_u32 m0, s33, 102400
    s_add_u32 s34, s34, 114688
    v_mul_f32 v123, v51, v123
    v_mul_f32 v124, v52, v124
    v_mfma_f32_32x32x16_bf16 v[144:159], a[4:7], a[240:243], v[144:159]
    buffer_load_dwordx4 v20, s[16:19], s34 offen offset:0 lds
    ds_read_b64_tr_b16 a[20:21], v9 offset:61440
    ds_read_b64_tr_b16 a[22:23], v9 offset:62464
    v_mul_f32 v125, v53, v125
    v_mul_f32 v126, v54, v126
    s_waitcnt lgkmcnt(4)
    v_mfma_f32_32x32x16_bf16 v[128:143], a[8:11], a[244:247], v[128:143]
    buffer_load_dwordx4 v21, s[16:19], s34 offen offset:1024 lds
    ds_read_b64_tr_b16 a[24:25], v6 offset:63488
    ds_read_b64_tr_b16 a[26:27], v6 offset:64512
    v_mul_f32 v127, v55, v127
    v_cvt_pk_bf16_f32 v44, v120, v121
    v_cvt_pk_bf16_f32 v45, v122, v123
    v_mfma_f32_32x32x16_bf16 v[144:159], a[12:15], a[244:247], v[144:159]
    ds_read_b64_tr_b16 a[28:29], v9 offset:63488
    ds_read_b64_tr_b16 a[30:31], v9 offset:64512
    v_cvt_pk_bf16_f32 v46, v124, v125
    v_cvt_pk_bf16_f32 v47, v126, v127
    buffer_load_dwordx4 v22, s[16:19], s34 offen offset:2048 lds
    s_waitcnt vmcnt(16)
    s_barrier
    s_waitcnt lgkmcnt(4)
    v_mfma_f32_32x32x16_bf16 v[128:143], a[16:19], a[248:251], v[128:143]
    ds_read_b64_tr_b16 a[0:1], v7 offset:0
    ds_read_b64_tr_b16 a[2:3], v7 offset:1024
    v_mfma_f32_32x32x16_bf16 v[144:159], a[20:23], a[248:251], v[144:159]
    buffer_store_dwordx4 v[44:47], v2, s[20:23], s63 offen offset:1024 sc1
    ds_read_b64_tr_b16 a[4:5], v10 offset:0
    ds_read_b64_tr_b16 a[6:7], v10 offset:1024
    s_waitcnt lgkmcnt(4)
    v_mfma_f32_32x32x16_bf16 v[128:143], a[24:27], a[252:255], v[128:143]
    buffer_load_dwordx4 v23, s[16:19], s34 offen offset:3072 lds
    ds_read_b64_tr_b16 a[8:9], v7 offset:16384
    ds_read_b64_tr_b16 a[10:11], v7 offset:17408
    v_mfma_f32_32x32x16_bf16 v[144:159], a[28:31], a[252:255], v[144:159]
    ds_read_b64_tr_b16 a[12:13], v10 offset:16384
    ds_read_b64_tr_b16 a[14:15], v10 offset:17408
    s_waitcnt lgkmcnt(4)
    v_mfma_f32_32x32x16_bf16 v[64:79], a[0:3], v[192:195], 0
    ds_read_b64_tr_b16 a[16:17], v7 offset:2048
    ds_read_b64_tr_b16 a[18:19], v7 offset:3072
    ds_read_b64_tr_b16 a[80:81], v8 offset:4096
    v_mfma_f32_32x32x16_bf16 v[80:95], a[4:7], v[192:195], 0
    ds_read_b64_tr_b16 a[20:21], v10 offset:2048
    ds_read_b64_tr_b16 a[22:23], v10 offset:3072
    ds_read_b64_tr_b16 a[82:83], v8 offset:5120
    s_waitcnt lgkmcnt(6)
    v_mfma_f32_32x32x16_bf16 v[96:111], a[8:11], v[192:195], 0
    ds_read_b64_tr_b16 a[24:25], v7 offset:18432
    ds_read_b64_tr_b16 a[26:27], v7 offset:19456
    ds_read_b64_tr_b16 a[84:85], v11 offset:4096
    v_mfma_f32_32x32x16_bf16 v[112:127], a[12:15], v[192:195], 0
    ds_read_b64_tr_b16 a[28:29], v10 offset:18432
    ds_read_b64_tr_b16 a[30:31], v10 offset:19456
    ds_read_b64_tr_b16 a[86:87], v11 offset:5120
    v_mul_f32 v144, v30, v144
    v_mul_f32 v145, v30, v145
    s_waitcnt lgkmcnt(7)
    v_mfma_f32_32x32x16_bf16 v[64:79], a[16:19], v[196:199], v[64:79]
    ds_read_b64_tr_b16 a[0:1], v7 offset:4096
    ds_read_b64_tr_b16 a[2:3], v7 offset:5120
    ds_read_b64_tr_b16 a[88:89], v8 offset:6144
    v_mul_f32 v146, v30, v146
    v_mul_f32 v147, v30, v147
    v_mfma_f32_32x32x16_bf16 v[80:95], a[20:23], v[196:199], v[80:95]
    ds_read_b64_tr_b16 a[4:5], v10 offset:4096
    ds_read_b64_tr_b16 a[6:7], v10 offset:5120
    ds_read_b64_tr_b16 a[90:91], v8 offset:7168
    v_mul_f32 v148, v30, v148
    v_mul_f32 v149, v30, v149
    s_waitcnt lgkmcnt(7)
    v_mfma_f32_32x32x16_bf16 v[96:111], a[24:27], v[196:199], v[96:111]
    ds_read_b64_tr_b16 a[8:9], v7 offset:20480
    ds_read_b64_tr_b16 a[10:11], v7 offset:21504
    ds_read_b64_tr_b16 a[92:93], v11 offset:6144
    v_mul_f32 v150, v30, v150
    v_mul_f32 v151, v30, v151
    v_mfma_f32_32x32x16_bf16 v[112:127], a[28:31], v[196:199], v[112:127]
    ds_read_b64_tr_b16 a[12:13], v10 offset:20480
    ds_read_b64_tr_b16 a[14:15], v10 offset:21504
    ds_read_b64_tr_b16 a[94:95], v11 offset:7168
    v_cvt_pk_bf16_f32 v40, v144, v145
    v_cvt_pk_bf16_f32 v41, v146, v147
    s_waitcnt lgkmcnt(7)
    v_mfma_f32_32x32x16_bf16 v[64:79], a[0:3], v[200:203], v[64:79]
    ds_read_b64_tr_b16 a[16:17], v7 offset:6144
    ds_read_b64_tr_b16 a[18:19], v7 offset:7168
    s_waitcnt lgkmcnt(2)
    s_add_u32 m0, s48, 4096
    s_add_u32 s76, s76, 32768
    v_cvt_pk_bf16_f32 v42, v148, v149
    v_cvt_pk_bf16_f32 v43, v150, v151
    v_mfma_f32_32x32x16_bf16 v[80:95], a[4:7], v[200:203], v[80:95]
    buffer_load_dwordx4 v56, s[56:59], s76 offen offset:0 lds
    ds_read_b64_tr_b16 a[20:21], v10 offset:6144
    ds_read_b64_tr_b16 a[22:23], v10 offset:7168
    s_add_u32 s63, s62, 0x920000
    v_mfma_f32_32x32x16_bf16 v[96:111], a[8:11], v[200:203], v[96:111]
    buffer_store_dwordx4 v[40:43], v2, s[20:23], s63 offen offset:0 sc1
    ds_read_b64_tr_b16 a[24:25], v7 offset:22528
    ds_read_b64_tr_b16 a[26:27], v7 offset:23552
    v_mul_f32 v152, v30, v152
    v_mul_f32 v153, v30, v153
    v_mfma_f32_32x32x16_bf16 v[112:127], a[12:15], v[200:203], v[112:127]
    buffer_load_dwordx4 v57, s[56:59], s76 offen offset:1024 lds
    ds_read_b64_tr_b16 a[28:29], v10 offset:22528
    ds_read_b64_tr_b16 a[30:31], v10 offset:23552
    v_mul_f32 v154, v30, v154
    v_mul_f32 v155, v30, v155
    s_waitcnt lgkmcnt(4)
    v_mfma_f32_32x32x16_bf16 v[64:79], a[16:19], v[204:207], v[64:79]
    buffer_load_dwordx4 v58, s[56:59], s76 offen offset:2048 lds
    ds_read_b64_tr_b16 a[0:1], v7 offset:8192
    ds_read_b64_tr_b16 a[2:3], v7 offset:9216
    v_mul_f32 v156, v30, v156
    v_mul_f32 v157, v30, v157
    v_mfma_f32_32x32x16_bf16 v[80:95], a[20:23], v[204:207], v[80:95]
    buffer_load_dwordx4 v59, s[56:59], s76 offen offset:3072 lds
    ds_read_b64_tr_b16 a[4:5], v10 offset:8192
    ds_read_b64_tr_b16 a[6:7], v10 offset:9216
    s_waitcnt vmcnt(6)
    s_lshl_b32 s3, s26, 15
    s_lshl_b32 s4, s25, 11
    s_add_u32 s3, s3, s4
    s_lshl_b32 s4, s24, 7
    s_add_u32 s3, s3, s4
    s_add_u32 s3, s3, 0xf01000
    s_mov_b64 exec, 0xffff
    buffer_store_dwordx2 v[4:5], v3, s[20:23], s3 offen sc1
    s_mov_b64 exec, -1
    v_mul_f32 v158, v30, v158
    v_mul_f32 v159, v30, v159
    s_waitcnt lgkmcnt(4)
    v_mfma_f32_32x32x16_bf16 v[96:111], a[24:27], v[204:207], v[96:111]
    ds_read_b64_tr_b16 a[8:9], v7 offset:24576
    ds_read_b64_tr_b16 a[10:11], v7 offset:25600
    s_add_u32 m0, s33, 0
    s_add_u32 s34, s38, s70
    v_cvt_pk_bf16_f32 v44, v152, v153
    v_cvt_pk_bf16_f32 v45, v154, v155
    v_mfma_f32_32x32x16_bf16 v[112:127], a[28:31], v[204:207], v[112:127]
    buffer_load_dwordx4 v20, s[16:19], s34 offen offset:0 lds
    ds_read_b64_tr_b16 a[12:13], v10 offset:24576
    ds_read_b64_tr_b16 a[14:15], v10 offset:25600
    v_cvt_pk_bf16_f32 v46, v156, v157
    v_cvt_pk_bf16_f32 v47, v158, v159
    s_waitcnt lgkmcnt(4)
    v_mfma_f32_32x32x16_bf16 v[64:79], a[0:3], v[208:211], v[64:79]
    buffer_load_dwordx4 v21, s[16:19], s34 offen offset:1024 lds
    ds_read_b64_tr_b16 a[16:17], v7 offset:10240
    ds_read_b64_tr_b16 a[18:19], v7 offset:11264
    s_add_u32 s63, s62, 0x930000
    v_mfma_f32_32x32x16_bf16 v[80:95], a[4:7], v[208:211], v[80:95]
    buffer_store_dwordx4 v[44:47], v2, s[20:23], s63 offen offset:0 sc1
    ds_read_b64_tr_b16 a[20:21], v10 offset:10240
    ds_read_b64_tr_b16 a[22:23], v10 offset:11264
    v_mul_f32 v128, v30, v128
    v_mul_f32 v129, v30, v129
    s_waitcnt lgkmcnt(4)
    v_mfma_f32_32x32x16_bf16 v[96:111], a[8:11], v[208:211], v[96:111]
    buffer_load_dwordx4 v22, s[16:19], s34 offen offset:2048 lds
    ds_read_b64_tr_b16 a[24:25], v7 offset:26624
    ds_read_b64_tr_b16 a[26:27], v7 offset:27648
    v_mul_f32 v130, v30, v130
    v_mul_f32 v131, v30, v131
    v_mfma_f32_32x32x16_bf16 v[112:127], a[12:15], v[208:211], v[112:127]
    buffer_load_dwordx4 v23, s[16:19], s34 offen offset:3072 lds
    ds_read_b64_tr_b16 a[28:29], v10 offset:26624
    ds_read_b64_tr_b16 a[30:31], v10 offset:27648
    s_add_u32 m0, s33, 4096
    s_add_u32 s34, s34, 114688
    v_mul_f32 v132, v30, v132
    v_mul_f32 v133, v30, v133
    s_waitcnt lgkmcnt(4)
    v_mfma_f32_32x32x16_bf16 v[64:79], a[16:19], v[212:215], v[64:79]
    buffer_load_dwordx4 v20, s[16:19], s34 offen offset:0 lds
    ds_read_b64_tr_b16 a[0:1], v7 offset:12288
    ds_read_b64_tr_b16 a[2:3], v7 offset:13312
    v_mul_f32 v134, v30, v134
    v_mul_f32 v135, v30, v135
    v_mfma_f32_32x32x16_bf16 v[80:95], a[20:23], v[212:215], v[80:95]
    buffer_load_dwordx4 v21, s[16:19], s34 offen offset:1024 lds
    ds_read_b64_tr_b16 a[4:5], v10 offset:12288
    ds_read_b64_tr_b16 a[6:7], v10 offset:13312
    v_cvt_pk_bf16_f32 v144, v128, v129
    v_cvt_pk_bf16_f32 v145, v130, v131
    s_waitcnt lgkmcnt(4)
    v_mfma_f32_32x32x16_bf16 v[96:111], a[24:27], v[212:215], v[96:111]
    buffer_load_dwordx4 v22, s[16:19], s34 offen offset:2048 lds
    ds_read_b64_tr_b16 a[8:9], v7 offset:28672
    ds_read_b64_tr_b16 a[10:11], v7 offset:29696
    v_cvt_pk_bf16_f32 v146, v132, v133
    v_cvt_pk_bf16_f32 v147, v134, v135
    v_mfma_f32_32x32x16_bf16 v[112:127], a[28:31], v[212:215], v[112:127]
    buffer_load_dwordx4 v23, s[16:19], s34 offen offset:3072 lds
    ds_read_b64_tr_b16 a[12:13], v10 offset:28672
    ds_read_b64_tr_b16 a[14:15], v10 offset:29696
    ds_read_b64_tr_b16 a[96:97], v8 offset:0
    ds_read_b64_tr_b16 a[98:99], v8 offset:1024
    v_mul_f32 v136, v30, v136
    s_waitcnt lgkmcnt(6)
    v_mfma_f32_32x32x16_bf16 v[64:79], a[0:3], v[216:219], v[64:79]
    ds_read_b64_tr_b16 a[16:17], v7 offset:14336
    ds_read_b64_tr_b16 a[18:19], v7 offset:15360
    ds_read_b64_tr_b16 a[100:101], v11 offset:0
    v_mul_f32 v137, v30, v137
    v_mul_f32 v138, v30, v138
    v_mul_f32 v139, v30, v139
    v_mfma_f32_32x32x16_bf16 v[80:95], a[4:7], v[216:219], v[80:95]
    ds_read_b64_tr_b16 a[20:21], v10 offset:14336
    ds_read_b64_tr_b16 a[22:23], v10 offset:15360
    ds_read_b64_tr_b16 a[102:103], v11 offset:1024
    ds_read_b64_tr_b16 a[104:105], v8 offset:2048
    v_mul_f32 v140, v30, v140
    v_mul_f32 v141, v30, v141
    s_waitcnt lgkmcnt(9)
    v_mfma_f32_32x32x16_bf16 v[96:111], a[8:11], v[216:219], v[96:111]
    ds_read_b64_tr_b16 a[24:25], v7 offset:30720
    ds_read_b64_tr_b16 a[26:27], v7 offset:31744
    ds_read_b64_tr_b16 a[106:107], v8 offset:3072
    v_mul_f32 v142, v30, v142
    v_mul_f32 v143, v30, v143
    v_mfma_f32_32x32x16_bf16 v[112:127], a[12:15], v[216:219], v[112:127]
    ds_read_b64_tr_b16 a[28:29], v10 offset:30720
    ds_read_b64_tr_b16 a[30:31], v10 offset:31744
    ds_read_b64_tr_b16 a[108:109], v11 offset:2048
    v_cvt_pk_bf16_f32 v148, v136, v137
    v_cvt_pk_bf16_f32 v149, v138, v139
    s_waitcnt vmcnt(14)
    s_barrier
    s_waitcnt lgkmcnt(8)
    v_mfma_f32_32x32x16_bf16 v[64:79], a[16:19], v[220:223], v[64:79]
    ds_read_b64_tr_b16 a[0:1], v7 offset:32768
    ds_read_b64_tr_b16 a[2:3], v7 offset:33792
    ds_read_b64_tr_b16 a[110:111], v11 offset:3072
    s_waitcnt lgkmcnt(0)
    s_add_u32 m0, s48, 0
    s_bfe_u32 s76, s75, 0x80018
    s_lshl_b32 s76, s76, 14
    s_add_u32 s76, s76, s74
    v_cvt_pk_bf16_f32 v150, v140, v141
    v_cvt_pk_bf16_f32 v151, v142, v143
    v_mfma_f32_32x32x16_bf16 v[80:95], a[20:23], v[220:223], v[80:95]
    buffer_load_dwordx4 v56, s[56:59], s76 offen offset:0 lds
    ds_read_b64_tr_b16 a[4:5], v10 offset:32768
    ds_read_b64_tr_b16 a[6:7], v10 offset:33792
    v_mfma_f32_32x32x16_bf16 v[96:111], a[24:27], v[220:223], v[96:111]
    buffer_load_dwordx4 v57, s[56:59], s76 offen offset:1024 lds
    ds_read_b64_tr_b16 a[8:9], v7 offset:49152
    ds_read_b64_tr_b16 a[10:11], v7 offset:50176
    v_mfma_f32_32x32x16_bf16 v[112:127], a[28:31], v[220:223], v[112:127]
    buffer_load_dwordx4 v58, s[56:59], s76 offen offset:2048 lds
    ds_read_b64_tr_b16 a[12:13], v10 offset:49152
    ds_read_b64_tr_b16 a[14:15], v10 offset:50176
    s_waitcnt lgkmcnt(4)
    v_mfma_f32_32x32x16_bf16 v[64:79], a[0:3], v[224:227], v[64:79]
    buffer_load_dwordx4 v59, s[56:59], s76 offen offset:3072 lds
    ds_read_b64_tr_b16 a[16:17], v7 offset:34816
    ds_read_b64_tr_b16 a[18:19], v7 offset:35840
    s_waitcnt vmcnt(13)
    ds_read_b64_tr_b16 a[112:113], v8 offset:4096
    v_mfma_f32_32x32x16_bf16 v[80:95], a[4:7], v[224:227], v[80:95]
    ds_read_b64_tr_b16 a[20:21], v10 offset:34816
    ds_read_b64_tr_b16 a[22:23], v10 offset:35840
    ds_read_b64_tr_b16 a[114:115], v8 offset:5120
    s_waitcnt lgkmcnt(6)
    v_mfma_f32_32x32x16_bf16 v[96:111], a[8:11], v[224:227], v[96:111]
    ds_read_b64_tr_b16 a[24:25], v7 offset:51200
    ds_read_b64_tr_b16 a[26:27], v7 offset:52224
    ds_read_b64_tr_b16 a[116:117], v11 offset:4096
    v_mfma_f32_32x32x16_bf16 v[112:127], a[12:15], v[224:227], v[112:127]
    ds_read_b64_tr_b16 a[28:29], v10 offset:51200
    ds_read_b64_tr_b16 a[30:31], v10 offset:52224
    ds_read_b64_tr_b16 a[118:119], v11 offset:5120
    s_waitcnt lgkmcnt(7)
    v_mfma_f32_32x32x16_bf16 v[64:79], a[16:19], v[228:231], v[64:79]
    ds_read_b64_tr_b16 a[0:1], v7 offset:36864
    ds_read_b64_tr_b16 a[2:3], v7 offset:37888
    ds_read_b64_tr_b16 a[120:121], v8 offset:6144
    v_mfma_f32_32x32x16_bf16 v[80:95], a[20:23], v[228:231], v[80:95]
    ds_read_b64_tr_b16 a[4:5], v10 offset:36864
    ds_read_b64_tr_b16 a[6:7], v10 offset:37888
    ds_read_b64_tr_b16 a[122:123], v8 offset:7168
    s_waitcnt lgkmcnt(7)
    v_mfma_f32_32x32x16_bf16 v[96:111], a[24:27], v[228:231], v[96:111]
    ds_read_b64_tr_b16 a[8:9], v7 offset:53248
    ds_read_b64_tr_b16 a[10:11], v7 offset:54272
    ds_read_b64_tr_b16 a[124:125], v11 offset:6144
    v_mfma_f32_32x32x16_bf16 v[112:127], a[28:31], v[228:231], v[112:127]
    ds_read_b64_tr_b16 a[12:13], v10 offset:53248
    ds_read_b64_tr_b16 a[14:15], v10 offset:54272
    ds_read_b64_tr_b16 a[126:127], v11 offset:7168
    s_waitcnt lgkmcnt(7)
    v_mfma_f32_32x32x16_bf16 v[64:79], a[0:3], v[232:235], v[64:79]
    ds_read_b64_tr_b16 a[16:17], v7 offset:38912
    ds_read_b64_tr_b16 a[18:19], v7 offset:39936
    s_waitcnt lgkmcnt(2)
    s_add_u32 m0, s48, 4096
    s_add_u32 s76, s76, 32768
    v_mfma_f32_32x32x16_bf16 v[80:95], a[4:7], v[232:235], v[80:95]
    buffer_load_dwordx4 v56, s[56:59], s76 offen offset:0 lds
    ds_read_b64_tr_b16 a[20:21], v10 offset:38912
    ds_read_b64_tr_b16 a[22:23], v10 offset:39936
    v_mfma_f32_32x32x16_bf16 v[96:111], a[8:11], v[232:235], v[96:111]
    buffer_load_dwordx4 v57, s[56:59], s76 offen offset:1024 lds
    ds_read_b64_tr_b16 a[24:25], v7 offset:55296
    ds_read_b64_tr_b16 a[26:27], v7 offset:56320
    v_mfma_f32_32x32x16_bf16 v[112:127], a[12:15], v[232:235], v[112:127]
    buffer_load_dwordx4 v58, s[56:59], s76 offen offset:2048 lds
    ds_read_b64_tr_b16 a[28:29], v10 offset:55296
    ds_read_b64_tr_b16 a[30:31], v10 offset:56320
    s_waitcnt lgkmcnt(4)
    v_mfma_f32_32x32x16_bf16 v[64:79], a[16:19], v[236:239], v[64:79]
    buffer_load_dwordx4 v59, s[56:59], s76 offen offset:3072 lds
    ds_read_b64_tr_b16 a[0:1], v7 offset:40960
    ds_read_b64_tr_b16 a[2:3], v7 offset:41984
    s_add_u32 m0, s33, 32768
    s_add_u32 s34, s38, s71
    v_mfma_f32_32x32x16_bf16 v[80:95], a[20:23], v[236:239], v[80:95]
    buffer_load_dwordx4 v20, s[16:19], s34 offen offset:0 lds
    ds_read_b64_tr_b16 a[4:5], v10 offset:40960
    ds_read_b64_tr_b16 a[6:7], v10 offset:41984
    s_waitcnt lgkmcnt(4)
    v_mfma_f32_32x32x16_bf16 v[96:111], a[24:27], v[236:239], v[96:111]
    buffer_load_dwordx4 v21, s[16:19], s34 offen offset:1024 lds
    ds_read_b64_tr_b16 a[8:9], v7 offset:57344
    ds_read_b64_tr_b16 a[10:11], v7 offset:58368
    v_mfma_f32_32x32x16_bf16 v[112:127], a[28:31], v[236:239], v[112:127]
    buffer_load_dwordx4 v22, s[16:19], s34 offen offset:2048 lds
    ds_read_b64_tr_b16 a[12:13], v10 offset:57344
    ds_read_b64_tr_b16 a[14:15], v10 offset:58368
    s_waitcnt lgkmcnt(4)
    v_mfma_f32_32x32x16_bf16 v[64:79], a[0:3], v[240:243], v[64:79]
    buffer_load_dwordx4 v23, s[16:19], s34 offen offset:3072 lds
    ds_read_b64_tr_b16 a[16:17], v7 offset:43008
    ds_read_b64_tr_b16 a[18:19], v7 offset:44032
    s_add_u32 m0, s33, 36864
    s_add_u32 s34, s34, 114688
    v_mfma_f32_32x32x16_bf16 v[80:95], a[4:7], v[240:243], v[80:95]
    buffer_load_dwordx4 v20, s[16:19], s34 offen offset:0 lds
    ds_read_b64_tr_b16 a[20:21], v10 offset:43008
    ds_read_b64_tr_b16 a[22:23], v10 offset:44032
    s_waitcnt lgkmcnt(4)
    v_mfma_f32_32x32x16_bf16 v[96:111], a[8:11], v[240:243], v[96:111]
    buffer_load_dwordx4 v21, s[16:19], s34 offen offset:1024 lds
    ds_read_b64_tr_b16 a[24:25], v7 offset:59392
    ds_read_b64_tr_b16 a[26:27], v7 offset:60416
    v_mfma_f32_32x32x16_bf16 v[112:127], a[12:15], v[240:243], v[112:127]
    buffer_load_dwordx4 v22, s[16:19], s34 offen offset:2048 lds
    ds_read_b64_tr_b16 a[28:29], v10 offset:59392
    ds_read_b64_tr_b16 a[30:31], v10 offset:60416
    s_waitcnt lgkmcnt(4)
    v_mfma_f32_32x32x16_bf16 v[64:79], a[16:19], v[244:247], v[64:79]
    buffer_load_dwordx4 v23, s[16:19], s34 offen offset:3072 lds
    ds_read_b64_tr_b16 a[0:1], v7 offset:45056
    ds_read_b64_tr_b16 a[2:3], v7 offset:46080
    s_waitcnt vmcnt(12)
    ds_read_b64_tr_b16 a[128:129], v8 offset:0
    v_mfma_f32_32x32x16_bf16 v[80:95], a[20:23], v[244:247], v[80:95]
    ds_read_b64_tr_b16 a[4:5], v10 offset:45056
    ds_read_b64_tr_b16 a[6:7], v10 offset:46080
    ds_read_b64_tr_b16 a[130:131], v8 offset:1024
    s_waitcnt lgkmcnt(6)
    v_mfma_f32_32x32x16_bf16 v[96:111], a[24:27], v[244:247], v[96:111]
    ds_read_b64_tr_b16 a[8:9], v7 offset:61440
    ds_read_b64_tr_b16 a[10:11], v7 offset:62464
    ds_read_b64_tr_b16 a[132:133], v11 offset:0
    v_mfma_f32_32x32x16_bf16 v[112:127], a[28:31], v[244:247], v[112:127]
    ds_read_b64_tr_b16 a[12:13], v10 offset:61440
    ds_read_b64_tr_b16 a[14:15], v10 offset:62464
    ds_read_b64_tr_b16 a[134:135], v11 offset:1024
    s_waitcnt lgkmcnt(7)
    v_mfma_f32_32x32x16_bf16 v[64:79], a[0:3], v[248:251], v[64:79]
    ds_read_b64_tr_b16 a[16:17], v7 offset:47104
    ds_read_b64_tr_b16 a[18:19], v7 offset:48128
    ds_read_b64_tr_b16 a[136:137], v8 offset:2048
    v_mfma_f32_32x32x16_bf16 v[80:95], a[4:7], v[248:251], v[80:95]
    ds_read_b64_tr_b16 a[20:21], v10 offset:47104
    ds_read_b64_tr_b16 a[22:23], v10 offset:48128
    ds_read_b64_tr_b16 a[138:139], v8 offset:3072
    s_waitcnt lgkmcnt(7)
    v_mfma_f32_32x32x16_bf16 v[96:111], a[8:11], v[248:251], v[96:111]
    ds_read_b64_tr_b16 a[24:25], v7 offset:63488
    ds_read_b64_tr_b16 a[26:27], v7 offset:64512
    ds_read_b64_tr_b16 a[140:141], v11 offset:2048
    v_mfma_f32_32x32x16_bf16 v[112:127], a[12:15], v[248:251], v[112:127]
    ds_read_b64_tr_b16 a[28:29], v10 offset:63488
    ds_read_b64_tr_b16 a[30:31], v10 offset:64512
    ds_read_b64_tr_b16 a[142:143], v11 offset:3072
    s_waitcnt lgkmcnt(0)
    s_add_u32 m0, s48, 0
    s_bfe_u32 s76, s49, 0x80000
    s_lshl_b32 s76, s76, 14
    s_add_u32 s76, s76, s74
    s_barrier
    v_mfma_f32_32x32x16_bf16 v[64:79], a[16:19], v[252:255], v[64:79]
    buffer_load_dwordx4 v56, s[56:59], s76 offen offset:0 lds
    ds_read_b64_tr_b16 a[0:1], v6 offset:0
    ds_read_b64_tr_b16 a[2:3], v6 offset:1024
    v_mfma_f32_32x32x16_bf16 v[80:95], a[20:23], v[252:255], v[80:95]
    buffer_load_dwordx4 v57, s[56:59], s76 offen offset:1024 lds
    ds_read_b64_tr_b16 a[4:5], v9 offset:0
    ds_read_b64_tr_b16 a[6:7], v9 offset:1024
    v_mfma_f32_32x32x16_bf16 v[96:111], a[24:27], v[252:255], v[96:111]
    buffer_load_dwordx4 v58, s[56:59], s76 offen offset:2048 lds
    ds_read_b64_tr_b16 a[8:9], v6 offset:16384
    ds_read_b64_tr_b16 a[10:11], v6 offset:17408
    v_mfma_f32_32x32x16_bf16 v[112:127], a[28:31], v[252:255], v[112:127]
    buffer_load_dwordx4 v59, s[56:59], s76 offen offset:3072 lds
    ds_read_b64_tr_b16 a[12:13], v9 offset:16384
    ds_read_b64_tr_b16 a[14:15], v9 offset:17408
    s_cmp_lg_u32 s24, 0
    s_cbranch_scc1 L_ct_2
    s_and_b32 s3, s35, 15
    s_mul_i32 s3, s3, 1024
    s_add_u32 s3, s3, 0x9f20
    v_lshlrev_b32 v14, 7, v1
    v_add_u32 v14, s3, v14
    v_min_u32 v14, 0xbde8, v14
    v_mov_b32 v15, s101
    v_add_co_u32 v14, vcc, s100, v14
    s_nop 1
    v_addc_co_u32 v15, vcc, 0, v15, vcc
    s_mov_b64 exec, 255
    global_load_dword v60, v[14:15], off
    s_mov_b64 exec, -1
L_ct_2:
    s_waitcnt lgkmcnt(4)
    v_mfma_f32_32x32x16_bf16 v[64:79], a[0:3], a[192:195], v[64:79]
    ds_read_b64_tr_b16 a[16:17], v6 offset:2048
    ds_read_b64_tr_b16 a[18:19], v6 offset:3072
    s_lshl_b32 s3, s26, 15
    s_lshl_b32 s4, s25, 11
    s_add_u32 s3, s3, s4
    s_lshl_b32 s4, s24, 7
    s_add_u32 s3, s3, s4
    s_add_u32 s3, s3, 0xf01200
    s_mov_b64 exec, 0xffff
    buffer_store_dwordx2 v[4:5], v3, s[20:23], s3 offen sc1
    s_mov_b64 exec, -1
    v_mfma_f32_32x32x16_bf16 v[80:95], a[4:7], a[192:195], v[80:95]
    ds_read_b64_tr_b16 a[20:21], v9 offset:2048
    ds_read_b64_tr_b16 a[22:23], v9 offset:3072
    s_waitcnt lgkmcnt(4)
    v_mfma_f32_32x32x16_bf16 v[96:111], a[8:11], a[192:195], v[96:111]
    ds_read_b64_tr_b16 a[24:25], v6 offset:18432
    ds_read_b64_tr_b16 a[26:27], v6 offset:19456
    s_lshr_b32 s3, s27, 1
    s_lshl_b32 s3, s3, 15
    s_lshl_b32 s4, s25, 11
    s_add_u32 s3, s3, s4
    s_add_u32 s51, s3, 0xf00000
    s_lshl_b32 s4, s25, 2
    s_sub_i32 s4, 8, s4
    s_max_i32 s4, s4, 0
    s_lshl_b32 s86, -1, s4
    s_and_b32 s86, s86, 0xfff
    s_mov_b32 s87, 0
    s_mov_b64 exec, s[86:87]
    buffer_load_dwordx2 v[24:25], v31, s[20:23], s51 offen sc1
    s_mov_b64 exec, -1
    v_mfma_f32_32x32x16_bf16 v[112:127], a[12:15], a[192:195], v[112:127]
    ds_read_b64_tr_b16 a[28:29], v9 offset:18432
    ds_read_b64_tr_b16 a[30:31], v9 offset:19456
    s_waitcnt vmcnt(13)
    ds_read_b64_tr_b16 a[144:145], v8 offset:4096
    v_and_b32 v48, 31, v1
    v_lshrrev_b32 v49, 5, v1
    v_lshlrev_b32 v49, 2, v49
    s_waitcnt lgkmcnt(5)
    v_mfma_f32_32x32x16_bf16 v[64:79], a[16:19], a[196:199], v[64:79]
    ds_read_b64_tr_b16 a[0:1], v6 offset:4096
    ds_read_b64_tr_b16 a[2:3], v6 offset:5120
    ds_read_b64_tr_b16 a[146:147], v8 offset:5120
    v_sub_u32 v48, v48, v49
    v_mov_b32 v49, 0xff800000
    v_mfma_f32_32x32x16_bf16 v[80:95], a[20:23], a[196:199], v[80:95]
    ds_read_b64_tr_b16 a[4:5], v9 offset:4096
    ds_read_b64_tr_b16 a[6:7], v9 offset:5120
    ds_read_b64_tr_b16 a[148:149], v11 offset:4096
    v_cmp_le_i32 s[88:89], 0, v48
    v_cmp_le_i32 s[90:91], 1, v48
    s_waitcnt lgkmcnt(7)
    v_mfma_f32_32x32x16_bf16 v[96:111], a[24:27], a[196:199], v[96:111]
    ds_read_b64_tr_b16 a[8:9], v6 offset:20480
    ds_read_b64_tr_b16 a[10:11], v6 offset:21504
    ds_read_b64_tr_b16 a[150:151], v11 offset:5120
    v_cndmask_b32 v176, 0, v49, s[88:89]
    v_cmp_le_i32 s[88:89], 2, v48
    v_mfma_f32_32x32x16_bf16 v[112:127], a[28:31], a[196:199], v[112:127]
    ds_read_b64_tr_b16 a[12:13], v9 offset:20480
    ds_read_b64_tr_b16 a[14:15], v9 offset:21504
    ds_read_b64_tr_b16 a[152:153], v8 offset:6144
    v_xor_b32 v160, v49, v176
    v_cndmask_b32 v177, 0, v49, s[90:91]
    s_waitcnt lgkmcnt(7)
    v_mfma_f32_32x32x16_bf16 v[64:79], a[0:3], a[200:203], v[64:79]
    ds_read_b64_tr_b16 a[16:17], v6 offset:6144
    ds_read_b64_tr_b16 a[18:19], v6 offset:7168
    ds_read_b64_tr_b16 a[154:155], v8 offset:7168
    v_cmp_le_i32 s[90:91], 3, v48
    v_xor_b32 v161, v49, v177
    v_mfma_f32_32x32x16_bf16 v[80:95], a[4:7], a[200:203], v[80:95]
    ds_read_b64_tr_b16 a[20:21], v9 offset:6144
    ds_read_b64_tr_b16 a[22:23], v9 offset:7168
    ds_read_b64_tr_b16 a[156:157], v11 offset:6144
    v_cndmask_b32 v178, 0, v49, s[88:89]
    v_cmp_le_i32 s[88:89], 8, v48
    s_waitcnt lgkmcnt(7)
    v_mfma_f32_32x32x16_bf16 v[96:111], a[8:11], a[200:203], v[96:111]
    ds_read_b64_tr_b16 a[24:25], v6 offset:22528
    ds_read_b64_tr_b16 a[26:27], v6 offset:23552
    v_xor_b32 v162, v49, v178
    v_cndmask_b32 v179, 0, v49, s[90:91]
    v_mfma_f32_32x32x16_bf16 v[112:127], a[12:15], a[200:203], v[112:127]
    ds_read_b64_tr_b16 a[28:29], v9 offset:22528
    ds_read_b64_tr_b16 a[30:31], v9 offset:23552
    ds_read_b64_tr_b16 a[158:159], v11 offset:7168
    v_cmp_le_i32 s[90:91], 9, v48
    v_xor_b32 v163, v49, v179
    s_waitcnt lgkmcnt(6)
    v_mfma_f32_32x32x16_bf16 v[64:79], a[16:19], a[204:207], v[64:79]
    ds_read_b64_tr_b16 a[0:1], v6 offset:8192
    ds_read_b64_tr_b16 a[2:3], v6 offset:9216
    s_waitcnt lgkmcnt(2)
    s_add_u32 m0, s48, 4096
    s_add_u32 s76, s76, 32768
    v_cndmask_b32 v180, 0, v49, s[88:89]
    v_cmp_le_i32 s[88:89], 10, v48
    v_mfma_f32_32x32x16_bf16 v[80:95], a[20:23], a[204:207], v[80:95]
    buffer_load_dwordx4 v56, s[56:59], s76 offen offset:0 lds
    ds_read_b64_tr_b16 a[4:5], v9 offset:8192
    ds_read_b64_tr_b16 a[6:7], v9 offset:9216
    v_xor_b32 v164, v49, v180
    v_cndmask_b32 v181, 0, v49, s[90:91]
    v_mfma_f32_32x32x16_bf16 v[96:111], a[24:27], a[204:207], v[96:111]
    buffer_load_dwordx4 v57, s[56:59], s76 offen offset:1024 lds
    ds_read_b64_tr_b16 a[8:9], v6 offset:24576
    ds_read_b64_tr_b16 a[10:11], v6 offset:25600
    v_cmp_le_i32 s[90:91], 11, v48
    v_xor_b32 v165, v49, v181
    v_mfma_f32_32x32x16_bf16 v[112:127], a[28:31], a[204:207], v[112:127]
    buffer_load_dwordx4 v58, s[56:59], s76 offen offset:2048 lds
    ds_read_b64_tr_b16 a[12:13], v9 offset:24576
    ds_read_b64_tr_b16 a[14:15], v9 offset:25600
    v_cndmask_b32 v182, 0, v49, s[88:89]
    v_cmp_le_i32 s[88:89], 16, v48
    s_waitcnt lgkmcnt(4)
    v_mfma_f32_32x32x16_bf16 v[64:79], a[0:3], a[208:211], v[64:79]
    buffer_load_dwordx4 v59, s[56:59], s76 offen offset:3072 lds
    ds_read_b64_tr_b16 a[16:17], v6 offset:10240
    ds_read_b64_tr_b16 a[18:19], v6 offset:11264
    s_waitcnt vmcnt(5)
    ds_read_b64_tr_b16 a[160:161], v8 offset:0
    v_xor_b32 v166, v49, v182
    v_cndmask_b32 v183, 0, v49, s[90:91]
    v_mfma_f32_32x32x16_bf16 v[80:95], a[4:7], a[208:211], v[80:95]
    ds_read_b64_tr_b16 a[20:21], v9 offset:10240
    ds_read_b64_tr_b16 a[22:23], v9 offset:11264
    ds_read_b64_tr_b16 a[162:163], v8 offset:1024
    v_cmp_le_i32 s[90:91], 17, v48
    v_xor_b32 v167, v49, v183
    s_waitcnt lgkmcnt(6)
    v_mfma_f32_32x32x16_bf16 v[96:111], a[8:11], a[208:211], v[96:111]
    ds_read_b64_tr_b16 a[24:25], v6 offset:26624
    ds_read_b64_tr_b16 a[26:27], v6 offset:27648
    ds_read_b64_tr_b16 a[164:165], v11 offset:0
    v_cndmask_b32 v184, 0, v49, s[88:89]
    v_cmp_le_i32 s[88:89], 18, v48
    v_mfma_f32_32x32x16_bf16 v[112:127], a[12:15], a[208:211], v[112:127]
    ds_read_b64_tr_b16 a[28:29], v9 offset:26624
    ds_read_b64_tr_b16 a[30:31], v9 offset:27648
    ds_read_b64_tr_b16 a[166:167], v11 offset:1024
    v_xor_b32 v168, v49, v184
    v_cndmask_b32 v185, 0, v49, s[90:91]
    s_waitcnt lgkmcnt(7)
    v_mfma_f32_32x32x16_bf16 v[64:79], a[16:19], a[212:215], v[64:79]
    ds_read_b64_tr_b16 a[0:1], v6 offset:12288
    ds_read_b64_tr_b16 a[2:3], v6 offset:13312
    v_cmp_le_i32 s[90:91], 19, v48
    v_xor_b32 v169, v49, v185
    v_cndmask_b32 v186, 0, v49, s[88:89]
    v_mfma_f32_32x32x16_bf16 v[80:95], a[20:23], a[212:215], v[80:95]
    ds_read_b64_tr_b16 a[4:5], v9 offset:12288
    ds_read_b64_tr_b16 a[6:7], v9 offset:13312
    ds_read_b64_tr_b16 a[168:169], v8 offset:2048
    v_cmp_le_i32 s[88:89], 24, v48
    v_xor_b32 v170, v49, v186
    s_waitcnt lgkmcnt(6)
    v_mfma_f32_32x32x16_bf16 v[96:111], a[24:27], a[212:215], v[96:111]
    ds_read_b64_tr_b16 a[8:9], v6 offset:28672
    ds_read_b64_tr_b16 a[10:11], v6 offset:29696
    ds_read_b64_tr_b16 a[170:171], v8 offset:3072
    v_cndmask_b32 v187, 0, v49, s[90:91]
    v_cmp_le_i32 s[90:91], 25, v48
    v_mfma_f32_32x32x16_bf16 v[112:127], a[28:31], a[212:215], v[112:127]
    ds_read_b64_tr_b16 a[12:13], v9 offset:28672
    ds_read_b64_tr_b16 a[14:15], v9 offset:29696
    ds_read_b64_tr_b16 a[172:173], v11 offset:2048
    v_xor_b32 v171, v49, v187
    v_cndmask_b32 v188, 0, v49, s[88:89]
    s_waitcnt lgkmcnt(7)
    v_mfma_f32_32x32x16_bf16 v[64:79], a[0:3], a[216:219], v[64:79]
    ds_read_b64_tr_b16 a[16:17], v6 offset:14336
    ds_read_b64_tr_b16 a[18:19], v6 offset:15360
    ds_read_b64_tr_b16 a[174:175], v11 offset:3072
    v_cmp_le_i32 s[88:89], 26, v48
    v_xor_b32 v172, v49, v188
    v_mfma_f32_32x32x16_bf16 v[80:95], a[4:7], a[216:219], v[80:95]
    ds_read_b64_tr_b16 a[20:21], v9 offset:14336
    ds_read_b64_tr_b16 a[22:23], v9 offset:15360
    s_waitcnt lgkmcnt(2)
    s_add_u32 m0, s48, 0
    s_bfe_u32 s76, s49, 0x80008
    s_lshl_b32 s76, s76, 14
    s_add_u32 s76, s76, s74
    v_cndmask_b32 v189, 0, v49, s[90:91]
    v_cmp_le_i32 s[90:91], 27, v48
    v_mfma_f32_32x32x16_bf16 v[96:111], a[8:11], a[216:219], v[96:111]
    buffer_load_dwordx4 v56, s[56:59], s76 offen offset:0 lds
    ds_read_b64_tr_b16 a[24:25], v6 offset:30720
    ds_read_b64_tr_b16 a[26:27], v6 offset:31744
    v_xor_b32 v173, v49, v189
    v_cndmask_b32 v190, 0, v49, s[88:89]
    v_mfma_f32_32x32x16_bf16 v[112:127], a[12:15], a[216:219], v[112:127]
    buffer_load_dwordx4 v57, s[56:59], s76 offen offset:1024 lds
    ds_read_b64_tr_b16 a[28:29], v9 offset:30720
    ds_read_b64_tr_b16 a[30:31], v9 offset:31744
    s_nop 0
    v_xor_b32 v174, v49, v190
    s_barrier
    s_waitcnt lgkmcnt(4)
    v_mfma_f32_32x32x16_bf16 v[64:79], a[16:19], a[220:223], v[64:79]
    buffer_load_dwordx4 v58, s[56:59], s76 offen offset:2048 lds
    ds_read_b64_tr_b16 a[0:1], v6 offset:32768
    ds_read_b64_tr_b16 a[2:3], v6 offset:33792
    v_cndmask_b32 v191, 0, v49, s[90:91]
    v_xor_b32 v175, v49, v191
    v_mfma_f32_32x32x16_bf16 v[80:95], a[20:23], a[220:223], v[80:95]
    buffer_load_dwordx4 v59, s[56:59], s76 offen offset:3072 lds
    ds_read_b64_tr_b16 a[4:5], v9 offset:32768
    ds_read_b64_tr_b16 a[6:7], v9 offset:33792
    s_waitcnt lgkmcnt(4)
    v_mfma_f32_32x32x16_bf16 v[96:111], a[24:27], a[220:223], v[96:111]
    ds_read_b64_tr_b16 a[8:9], v6 offset:49152
    ds_read_b64_tr_b16 a[10:11], v6 offset:50176
    v_mfma_f32_32x32x16_bf16 v[112:127], a[28:31], a[220:223], v[112:127]
    ds_read_b64_tr_b16 a[12:13], v9 offset:49152
    ds_read_b64_tr_b16 a[14:15], v9 offset:50176
    s_waitcnt lgkmcnt(4)
    v_mfma_f32_32x32x16_bf16 v[64:79], a[0:3], a[224:227], v[64:79]
    ds_read_b64_tr_b16 a[16:17], v6 offset:34816
    ds_read_b64_tr_b16 a[18:19], v6 offset:35840
    s_waitcnt vmcnt(8)
    v_cmp_eq_u64 vcc, v[24:25], v[4:5]
    s_nop 0
    s_and_b64 vcc, vcc, s[86:87]
    s_cmp_eq_u64 vcc, s[86:87]
    s_cbranch_scc1 L_polld_4
    s_mov_b32 s93, 0x20000
L_poll_3:
    s_mov_b64 exec, s[86:87]
    buffer_load_dwordx2 v[24:25], v31, s[20:23], s51 offen sc1
    s_mov_b64 exec, -1
    s_waitcnt vmcnt(0)
    v_cmp_eq_u64 vcc, v[24:25], v[4:5]
    s_nop 0
    s_and_b64 vcc, vcc, s[86:87]
    s_cmp_eq_u64 vcc, s[86:87]
    s_cbranch_scc1 L_polld_4
    s_sub_u32 s93, s93, 1
    s_cmp_lg_u32 s93, 0
    s_cbranch_scc1 L_poll_3
L_polld_4:
    v_mfma_f32_32x32x16_bf16 v[80:95], a[4:7], a[224:227], v[80:95]
    ds_read_b64_tr_b16 a[20:21], v9 offset:34816
    ds_read_b64_tr_b16 a[22:23], v9 offset:35840
    s_waitcnt lgkmcnt(4)
    v_mfma_f32_32x32x16_bf16 v[96:111], a[8:11], a[224:227], v[96:111]
    ds_read_b64_tr_b16 a[24:25], v6 offset:51200
    ds_read_b64_tr_b16 a[26:27], v6 offset:52224
    s_mul_i32 s5, s27, 131072
    s_lshl_b32 s3, s25, 2
    s_add_u32 s7, s3, s24
    s_sub_i32 s7, s7, 8
    s_max_i32 s7, s7, 0
    s_lshl_b32 s4, s24, 1
    s_add_u32 s4, s4, s3
    s_sub_i32 s4, s4, 4
    s_max_i32 s67, s4, 0
    s_lshl_b32 s3, s24, 10
    s_add_u32 m0, s3, 65536
    s_lshl_b32 s6, s7, 10
    s_add_u32 s6, s6, s5
    s_add_u32 s6, s6, 0xb00000
    v_mfma_f32_32x32x16_bf16 v[112:127], a[12:15], a[224:227], v[112:127]
    buffer_load_dwordx4 v2, s[20:23], s6 offen offset:0 sc1 lds
    ds_read_b64_tr_b16 a[28:29], v9 offset:51200
    ds_read_b64_tr_b16 a[30:31], v9 offset:52224
    s_add_u32 m0, m0, 12288
    s_add_u32 s6, s6, 65536
    s_waitcnt lgkmcnt(4)
    v_mfma_f32_32x32x16_bf16 v[64:79], a[16:19], a[228:231], v[64:79]
    buffer_load_dwordx4 v2, s[20:23], s6 offen offset:0 sc1 lds
    ds_read_b64_tr_b16 a[0:1], v6 offset:36864
    ds_read_b64_tr_b16 a[2:3], v6 offset:37888
    s_lshl_b32 s3, s24, 11
    s_add_u32 m0, s3, 90112
    s_lshl_b32 s6, s7, 11
    s_add_u32 s6, s6, s5
    s_add_u32 s6, s6, 0xd00000
    v_mfma_f32_32x32x16_bf16 v[80:95], a[20:23], a[228:231], v[80:95]
    buffer_load_dwordx4 v2, s[20:23], s6 offen offset:0 sc1 lds
    ds_read_b64_tr_b16 a[4:5], v9 offset:36864
    ds_read_b64_tr_b16 a[6:7], v9 offset:37888
    s_waitcnt lgkmcnt(4)
    v_mfma_f32_32x32x16_bf16 v[96:111], a[24:27], a[228:231], v[96:111]
    buffer_load_dwordx4 v2, s[20:23], s6 offen offset:1024 sc1 lds
    ds_read_b64_tr_b16 a[8:9], v6 offset:53248
    ds_read_b64_tr_b16 a[10:11], v6 offset:54272
    s_lshl_b32 s3, s24, 11
    s_add_u32 m0, s3, 69632
    s_lshl_b32 s6, s67, 10
    s_add_u32 s6, s6, s5
    s_add_u32 s6, s6, 0xb00000
    v_mfma_f32_32x32x16_bf16 v[112:127], a[28:31], a[228:231], v[112:127]
    buffer_load_dwordx4 v2, s[20:23], s6 offen offset:0 sc1 lds
    ds_read_b64_tr_b16 a[12:13], v9 offset:53248
    ds_read_b64_tr_b16 a[14:15], v9 offset:54272
    s_waitcnt lgkmcnt(4)
    v_mfma_f32_32x32x16_bf16 v[64:79], a[0:3], a[232:235], v[64:79]
    buffer_load_dwordx4 v2, s[20:23], s6 offen offset:1024 sc1 lds
    ds_read_b64_tr_b16 a[16:17], v6 offset:38912
    ds_read_b64_tr_b16 a[18:19], v6 offset:39936
    v_mfma_f32_32x32x16_bf16 v[80:95], a[4:7], a[232:235], v[80:95]
    ds_read_b64_tr_b16 a[20:21], v9 offset:38912
    ds_read_b64_tr_b16 a[22:23], v9 offset:39936
    s_add_u32 m0, m0, 12288
    s_add_u32 s6, s6, 65536
    s_waitcnt lgkmcnt(4)
    v_mfma_f32_32x32x16_bf16 v[96:111], a[8:11], a[232:235], v[96:111]
    buffer_load_dwordx4 v2, s[20:23], s6 offen offset:0 sc1 lds
    ds_read_b64_tr_b16 a[24:25], v6 offset:55296
    ds_read_b64_tr_b16 a[26:27], v6 offset:56320
    v_mfma_f32_32x32x16_bf16 v[112:127], a[12:15], a[232:235], v[112:127]
    buffer_load_dwordx4 v2, s[20:23], s6 offen offset:1024 sc1 lds
    ds_read_b64_tr_b16 a[28:29], v9 offset:55296
    ds_read_b64_tr_b16 a[30:31], v9 offset:56320
    s_lshl_b32 s3, s24, 12
    s_add_u32 m0, s3, 98304
    s_lshl_b32 s6, s67, 11
    s_add_u32 s6, s6, s5
    s_add_u32 s6, s6, 0xd00000
    s_waitcnt lgkmcnt(4)
    v_mfma_f32_32x32x16_bf16 v[64:79], a[16:19], a[236:239], v[64:79]
    buffer_load_dwordx4 v2, s[20:23], s6 offen offset:0 sc1 lds
    ds_read_b64_tr_b16 a[0:1], v6 offset:40960
    ds_read_b64_tr_b16 a[2:3], v6 offset:41984
    v_mfma_f32_32x32x16_bf16 v[80:95], a[20:23], a[236:239], v[80:95]
    buffer_load_dwordx4 v2, s[20:23], s6 offen offset:1024 sc1 lds
    ds_read_b64_tr_b16 a[4:5], v9 offset:40960
    ds_read_b64_tr_b16 a[6:7], v9 offset:41984
    s_waitcnt lgkmcnt(4)
    v_mfma_f32_32x32x16_bf16 v[96:111], a[24:27], a[236:239], v[96:111]
    buffer_load_dwordx4 v2, s[20:23], s6 offen offset:2048 sc1 lds
    ds_read_b64_tr_b16 a[8:9], v6 offset:57344
    ds_read_b64_tr_b16 a[10:11], v6 offset:58368
    v_mfma_f32_32x32x16_bf16 v[112:127], a[28:31], a[236:239], v[112:127]
    buffer_load_dwordx4 v2, s[20:23], s6 offen offset:3072 sc1 lds
    ds_read_b64_tr_b16 a[12:13], v9 offset:57344
    ds_read_b64_tr_b16 a[14:15], v9 offset:58368
    s_waitcnt lgkmcnt(4)
    v_mfma_f32_32x32x16_bf16 v[64:79], a[0:3], a[240:243], v[64:79]
    ds_read_b64_tr_b16 a[16:17], v6 offset:43008
    ds_read_b64_tr_b16 a[18:19], v6 offset:44032
    s_waitcnt vmcnt(16)
    ds_read_b64_tr_b16 a[176:177], v8 offset:4096
    v_mfma_f32_32x32x16_bf16 v[80:95], a[4:7], a[240:243], v[80:95]
    ds_read_b64_tr_b16 a[20:21], v9 offset:43008
    ds_read_b64_tr_b16 a[22:23], v9 offset:44032
    ds_read_b64_tr_b16 a[178:179], v8 offset:5120
    s_waitcnt lgkmcnt(6)
    v_mfma_f32_32x32x16_bf16 v[96:111], a[8:11], a[240:243], v[96:111]
    ds_read_b64_tr_b16 a[24:25], v6 offset:59392
    ds_read_b64_tr_b16 a[26:27], v6 offset:60416
    ds_read_b64_tr_b16 a[180:181], v11 offset:4096
    v_mfma_f32_32x32x16_bf16 v[112:127], a[12:15], a[240:243], v[112:127]
    ds_read_b64_tr_b16 a[28:29], v9 offset:59392
    ds_read_b64_tr_b16 a[30:31], v9 offset:60416
    ds_read_b64_tr_b16 a[182:183], v11 offset:5120
    s_waitcnt lgkmcnt(7)
    v_mfma_f32_32x32x16_bf16 v[64:79], a[16:19], a[244:247], v[64:79]
    ds_read_b64_tr_b16 a[0:1], v6 offset:45056
    ds_read_b64_tr_b16 a[2:3], v6 offset:46080
    ds_read_b64_tr_b16 a[184:185], v8 offset:6144
    v_mfma_f32_32x32x16_bf16 v[80:95], a[20:23], a[244:247], v[80:95]
    ds_read_b64_tr_b16 a[4:5], v9 offset:45056
    ds_read_b64_tr_b16 a[6:7], v9 offset:46080
    ds_read_b64_tr_b16 a[186:187], v8 offset:7168
    s_waitcnt lgkmcnt(7)
    v_mfma_f32_32x32x16_bf16 v[96:111], a[24:27], a[244:247], v[96:111]
    ds_read_b64_tr_b16 a[8:9], v6 offset:61440
    ds_read_b64_tr_b16 a[10:11], v6 offset:62464
    v_mfma_f32_32x32x16_bf16 v[112:127], a[28:31], a[244:247], v[112:127]
    ds_read_b64_tr_b16 a[12:13], v9 offset:61440
    ds_read_b64_tr_b16 a[14:15], v9 offset:62464
    ds_read_b64_tr_b16 a[188:189], v11 offset:6144
    s_waitcnt lgkmcnt(6)
    v_mfma_f32_32x32x16_bf16 v[64:79], a[0:3], a[248:251], v[64:79]
    ds_read_b64_tr_b16 a[16:17], v6 offset:47104
    ds_read_b64_tr_b16 a[18:19], v6 offset:48128
    ds_read_b64_tr_b16 a[190:191], v11 offset:7168
    v_mfma_f32_32x32x16_bf16 v[80:95], a[4:7], a[248:251], v[80:95]
    ds_read_b64_tr_b16 a[20:21], v9 offset:47104
    ds_read_b64_tr_b16 a[22:23], v9 offset:48128
    s_waitcnt lgkmcnt(2)
    s_add_u32 m0, s48, 4096
    s_add_u32 s76, s76, 32768
    v_mfma_f32_32x32x16_bf16 v[96:111], a[8:11], a[248:251], v[96:111]
    buffer_load_dwordx4 v56, s[56:59], s76 offen offset:0 lds
    ds_read_b64_tr_b16 a[24:25], v6 offset:63488
    ds_read_b64_tr_b16 a[26:27], v6 offset:64512
    v_mfma_f32_32x32x16_bf16 v[112:127], a[12:15], a[248:251], v[112:127]
    buffer_load_dwordx4 v57, s[56:59], s76 offen offset:1024 lds
    ds_read_b64_tr_b16 a[28:29], v9 offset:63488
    ds_read_b64_tr_b16 a[30:31], v9 offset:64512
    s_waitcnt lgkmcnt(4)
    v_mfma_f32_32x32x16_bf16 v[64:79], a[16:19], a[252:255], v[64:79]
    buffer_load_dwordx4 v58, s[56:59], s76 offen offset:2048 lds
    v_mfma_f32_32x32x16_bf16 v[80:95], a[20:23], a[252:255], v[80:95]
    buffer_load_dwordx4 v59, s[56:59], s76 offen offset:3072 lds
    s_waitcnt lgkmcnt(0)
    v_mfma_f32_32x32x16_bf16 v[96:111], a[24:27], a[252:255], v[96:111]
    v_mfma_f32_32x32x16_bf16 v[112:127], a[28:31], a[252:255], v[112:127]
    v_mov_b32 v192, v144
    v_mov_b32 v193, v145
    v_mov_b32 v194, v146
    v_mov_b32 v195, v147
    v_mov_b32 v196, v148
    v_mov_b32 v197, v149
    v_mov_b32 v198, v150
    v_mov_b32 v199, v151
    s_lshl_b32 s92, s31, 12
    s_lshl_b32 s3, s24, 9
    s_add_u32 s92, s92, s3
    s_add_u32 s92, s92, 0xf90000
    s_mov_b64 exec, 0xaa
    buffer_load_dwordx2 v[14:15], v31, s[20:23], s92 offen sc1
    s_mov_b64 exec, -1
    s_waitcnt vmcnt(17)
    ds_read_b64_tr_b16 a[192:193], v8 offset:0
    ds_read_b64_tr_b16 a[194:195], v8 offset:1024
    ds_read_b64_tr_b16 a[196:197], v11 offset:0
    ds_read_b64_tr_b16 a[198:199], v11 offset:1024
    ds_read_b64_tr_b16 a[200:201], v8 offset:2048
    ds_read_b64_tr_b16 a[202:203], v8 offset:3072
    ds_read_b64_tr_b16 a[204:205], v11 offset:2048
    ds_read_b64_tr_b16 a[206:207], v11 offset:3072
    v_pk_mul_f32 v[32:33], v[28:29], v[64:65] op_sel_hi:[0,1]
    v_pk_mul_f32 v[34:35], v[28:29], v[66:67] op_sel_hi:[0,1]
    v_pk_mul_f32 v[36:37], v[28:29], v[68:69] op_sel_hi:[0,1]
    v_pk_mul_f32 v[38:39], v[28:29], v[70:71] op_sel_hi:[0,1]
    v_exp_f32 v32, v32
    v_exp_f32 v33, v33
    v_pk_mul_f32 v[96:97], v[64:65], v[96:97]
    v_exp_f32 v34, v34
    v_exp_f32 v35, v35
    v_pk_mul_f32 v[98:99], v[66:67], v[98:99]
    v_exp_f32 v36, v36
    v_exp_f32 v37, v37
    v_pk_mul_f32 v[100:101], v[68:69], v[100:101]
    v_exp_f32 v38, v38
    v_exp_f32 v39, v39
    v_pk_mul_f32 v[102:103], v[70:71], v[102:103]
    v_pk_fma_f32 v[32:33], v[32:33], v[28:29], v[28:29] op_sel:[0,1,1] op_sel_hi:[1,1,1]
    v_pk_fma_f32 v[34:35], v[34:35], v[28:29], v[28:29] op_sel:[0,1,1] op_sel_hi:[1,1,1]
    v_pk_fma_f32 v[36:37], v[36:37], v[28:29], v[28:29] op_sel:[0,1,1] op_sel_hi:[1,1,1]
    v_pk_fma_f32 v[38:39], v[38:39], v[28:29], v[28:29] op_sel:[0,1,1] op_sel_hi:[1,1,1]
    v_rcp_f32 v32, v32
    v_rcp_f32 v33, v33
    v_rcp_f32 v34, v34
    v_rcp_f32 v35, v35
    v_rcp_f32 v36, v36
    v_rcp_f32 v37, v37
    v_rcp_f32 v38, v38
    v_rcp_f32 v39, v39
    v_pk_mul_f32 v[96:97], v[32:33], v[96:97]
    v_pk_mul_f32 v[98:99], v[34:35], v[98:99]
    v_pk_mul_f32 v[100:101], v[36:37], v[100:101]
    v_pk_mul_f32 v[102:103], v[38:39], v[102:103]
    v_cvt_pk_bf16_f32 v40, v96, v97
    v_cvt_pk_bf16_f32 v41, v98, v99
    v_cvt_pk_bf16_f32 v42, v100, v101
    v_cvt_pk_bf16_f32 v43, v102, v103
    buffer_store_dwordx4 v[40:43], v2, s[20:23], s41 offen offset:0 sc1
    v_pk_mul_f32 v[48:49], v[28:29], v[72:73] op_sel_hi:[0,1]
    v_pk_mul_f32 v[50:51], v[28:29], v[74:75] op_sel_hi:[0,1]
    v_pk_mul_f32 v[52:53], v[28:29], v[76:77] op_sel_hi:[0,1]
    v_pk_mul_f32 v[54:55], v[28:29], v[78:79] op_sel_hi:[0,1]
    v_exp_f32 v48, v48
    v_exp_f32 v49, v49
    v_pk_mul_f32 v[104:105], v[72:73], v[104:105]
    v_exp_f32 v50, v50
    v_exp_f32 v51, v51
    v_pk_mul_f32 v[106:107], v[74:75], v[106:107]
    v_exp_f32 v52, v52
    v_exp_f32 v53, v53
    v_pk_mul_f32 v[108:109], v[76:77], v[108:109]
    v_exp_f32 v54, v54
    v_exp_f32 v55, v55
    v_pk_mul_f32 v[110:111], v[78:79], v[110:111]
    v_pk_fma_f32 v[48:49], v[48:49], v[28:29], v[28:29] op_sel:[0,1,1] op_sel_hi:[1,1,1]
    v_pk_fma_f32 v[50:51], v[50:51], v[28:29], v[28:29] op_sel:[0,1,1] op_sel_hi:[1,1,1]
    v_pk_fma_f32 v[52:53], v[52:53], v[28:29], v[28:29] op_sel:[0,1,1] op_sel_hi:[1,1,1]
    v_pk_fma_f32 v[54:55], v[54:55], v[28:29], v[28:29] op_sel:[0,1,1] op_sel_hi:[1,1,1]
    v_rcp_f32 v48, v48
    v_rcp_f32 v49, v49
    v_rcp_f32 v50, v50
    v_rcp_f32 v51, v51
    v_rcp_f32 v52, v52
    v_rcp_f32 v53, v53
    v_rcp_f32 v54, v54
    v_rcp_f32 v55, v55
    v_pk_mul_f32 v[104:105], v[48:49], v[104:105]
    v_pk_mul_f32 v[106:107], v[50:51], v[106:107]
    v_pk_mul_f32 v[108:109], v[52:53], v[108:109]
    v_pk_mul_f32 v[110:111], v[54:55], v[110:111]
    v_cvt_pk_bf16_f32 v44, v104, v105
    v_cvt_pk_bf16_f32 v45, v106, v107
    v_cvt_pk_bf16_f32 v46, v108, v109
    v_cvt_pk_bf16_f32 v47, v110, v111
    buffer_store_dwordx4 v[44:47], v2, s[20:23], s41 offen offset:1024 sc1
    v_pk_mul_f32 v[32:33], v[28:29], v[80:81] op_sel_hi:[0,1]
    v_pk_mul_f32 v[34:35], v[28:29], v[82:83] op_sel_hi:[0,1]
    v_pk_mul_f32 v[36:37], v[28:29], v[84:85] op_sel_hi:[0,1]
    v_pk_mul_f32 v[38:39], v[28:29], v[86:87] op_sel_hi:[0,1]
    v_exp_f32 v32, v32
    v_exp_f32 v33, v33
    v_pk_mul_f32 v[112:113], v[80:81], v[112:113]
    v_exp_f32 v34, v34
    v_exp_f32 v35, v35
    v_pk_mul_f32 v[114:115], v[82:83], v[114:115]
    v_exp_f32 v36, v36
    v_exp_f32 v37, v37
    v_pk_mul_f32 v[116:117], v[84:85], v[116:117]
    v_exp_f32 v38, v38
    v_exp_f32 v39, v39
    v_pk_mul_f32 v[118:119], v[86:87], v[118:119]
    v_pk_fma_f32 v[32:33], v[32:33], v[28:29], v[28:29] op_sel:[0,1,1] op_sel_hi:[1,1,1]
    v_pk_fma_f32 v[34:35], v[34:35], v[28:29], v[28:29] op_sel:[0,1,1] op_sel_hi:[1,1,1]
    v_pk_fma_f32 v[36:37], v[36:37], v[28:29], v[28:29] op_sel:[0,1,1] op_sel_hi:[1,1,1]
    v_pk_fma_f32 v[38:39], v[38:39], v[28:29], v[28:29] op_sel:[0,1,1] op_sel_hi:[1,1,1]
    v_rcp_f32 v32, v32
    v_rcp_f32 v33, v33
    v_rcp_f32 v34, v34
    v_rcp_f32 v35, v35
    v_rcp_f32 v36, v36
    v_rcp_f32 v37, v37
    v_rcp_f32 v38, v38
    v_rcp_f32 v39, v39
    v_pk_mul_f32 v[112:113], v[32:33], v[112:113]
    v_pk_mul_f32 v[114:115], v[34:35], v[114:115]
    v_pk_mul_f32 v[116:117], v[36:37], v[116:117]
    v_pk_mul_f32 v[118:119], v[38:39], v[118:119]
    v_cvt_pk_bf16_f32 v40, v112, v113
    v_cvt_pk_bf16_f32 v41, v114, v115
    v_cvt_pk_bf16_f32 v42, v116, v117
    v_cvt_pk_bf16_f32 v43, v118, v119
    buffer_store_dwordx4 v[40:43], v2, s[20:23], s41 offen offset:2048 sc1
    v_pk_mul_f32 v[48:49], v[28:29], v[88:89] op_sel_hi:[0,1]
    v_pk_mul_f32 v[50:51], v[28:29], v[90:91] op_sel_hi:[0,1]
    v_pk_mul_f32 v[52:53], v[28:29], v[92:93] op_sel_hi:[0,1]
    v_pk_mul_f32 v[54:55], v[28:29], v[94:95] op_sel_hi:[0,1]
    v_exp_f32 v48, v48
    v_exp_f32 v49, v49
    v_pk_mul_f32 v[120:121], v[88:89], v[120:121]
    v_exp_f32 v50, v50
    v_exp_f32 v51, v51
    v_pk_mul_f32 v[122:123], v[90:91], v[122:123]
    v_exp_f32 v52, v52
    v_exp_f32 v53, v53
    v_pk_mul_f32 v[124:125], v[92:93], v[124:125]
    v_exp_f32 v54, v54
    v_exp_f32 v55, v55
    v_pk_mul_f32 v[126:127], v[94:95], v[126:127]
    v_pk_fma_f32 v[48:49], v[48:49], v[28:29], v[28:29] op_sel:[0,1,1] op_sel_hi:[1,1,1]
    v_pk_fma_f32 v[50:51], v[50:51], v[28:29], v[28:29] op_sel:[0,1,1] op_sel_hi:[1,1,1]
    v_pk_fma_f32 v[52:53], v[52:53], v[28:29], v[28:29] op_sel:[0,1,1] op_sel_hi:[1,1,1]
    v_pk_fma_f32 v[54:55], v[54:55], v[28:29], v[28:29] op_sel:[0,1,1] op_sel_hi:[1,1,1]
    v_rcp_f32 v48, v48
    v_rcp_f32 v49, v49
    v_rcp_f32 v50, v50
    v_rcp_f32 v51, v51
    v_rcp_f32 v52, v52
    v_rcp_f32 v53, v53
    v_rcp_f32 v54, v54
    v_rcp_f32 v55, v55
    v_pk_mul_f32 v[120:121], v[48:49], v[120:121]
    v_pk_mul_f32 v[122:123], v[50:51], v[122:123]
    v_pk_mul_f32 v[124:125], v[52:53], v[124:125]
    v_pk_mul_f32 v[126:127], v[54:55], v[126:127]
    v_cvt_pk_bf16_f32 v44, v120, v121
    v_cvt_pk_bf16_f32 v45, v122, v123
    v_cvt_pk_bf16_f32 v46, v124, v125
    v_cvt_pk_bf16_f32 v47, v126, v127
    buffer_store_dwordx4 v[44:47], v2, s[20:23], s41 offen offset:3072 sc1
    s_branch L_ATT
L_HH:
    s_lshr_b32 s90, s25, 2
    s_and_b32 s90, s90, 1
    s_xor_b32 s90, s90, 0
    s_lshl_b32 s91, s90, 12
    s_add_u32 m0, s33, s91
    s_mul_i32 s90, s90, 114688
    s_add_u32 s34, s38, s68
    s_add_u32 s34, s34, s90
    buffer_load_dwordx4 v20, s[16:19], s34 offen offset:0 lds
    buffer_load_dwordx4 v21, s[16:19], s34 offen offset:1024 lds
    buffer_load_dwordx4 v22, s[16:19], s34 offen offset:2048 lds
    buffer_load_dwordx4 v23, s[16:19], s34 offen offset:3072 lds
    s_mov_b32 s4, 0xfb0000
    buffer_load_dwordx2 v[4:5], off, s[20:23], s4 sc1
    v_and_b32 v40, 31, v1
    v_lshrrev_b32 v41, 5, v1
    v_bfe_u32 v42, v40, 1, 3
    v_xor_b32 v42, v42, v41
    v_lshlrev_b32 v42, 4, v42
    v_lshl_add_u32 v42, v40, 7, v42
    v_add_u32 v44, s77, v42
    v_xor_b32 v45, 32, v44
    v_xor_b32 v46, 64, v44
    v_xor_b32 v47, 96, v44
    v_lshlrev_b32 v2, 4, v1
    v_lshlrev_b32 v3, 3, v1
    s_nop 0
    s_cmp_eq_u32 s29, 0
    s_cselect_b32 s3, s6, s5
    s_mov_b32 s7, 393216
    s_cselect_b32 s7, s7, 458752
    s_add_u32 s3, s3, s30
    s_add_u32 s4, s3, 0
    s_and_b32 s4, s4, 3
    s_mul_i32 s72, s4, s7
    s_add_u32 s4, s3, 2
    s_and_b32 s4, s4, 3
    s_mul_i32 s73, s4, s7
    v_lshrrev_b32 v40, 5, v1
    v_bfe_u32 v41, v1, 2, 2
    v_lshl_add_u32 v42, v40, 3, v41
    v_lshl_add_u32 v39, v40, 2, v41
    v_bfe_u32 v43, v1, 4, 1
    v_lshlrev_b32 v43, 5, v43
    v_and_b32 v38, 3, v1
    v_lshl_add_u32 v43, v38, 3, v43
    v_lshl_add_u32 v12, v39, 6, v43
    v_bfe_u32 v38, v41, 1, 1
    v_lshl_add_u32 v43, v38, 6, v43
    v_lshl_add_u32 v6, v39, 7, v43
    v_xor_b32 v9, 64, v6
    v_add_u32 v7, 0x10000, v6
    v_add_u32 v10, 0x10000, v9
    v_add_u32 v13, 0x10000, v12
    s_add_u32 s48, s33, 131072
    v_lshl_add_u32 v8, v39, 7, v43
    v_add_u32 v8, s48, v8
    v_xor_b32 v11, 64, v8
    s_mul_i32 s3, s28, 147456
    s_lshl_b32 s41, s41, 5
    s_add_u32 s41, s41, s3
    s_lshl_b32 s42, s42, 5
    s_add_u32 s42, s42, s3
    s_lshl_b32 s43, s43, 5
    s_add_u32 s43, s43, s3
    s_lshl_b32 s74, s32, 7
    s_lshl_b32 s99, s24, 17
    s_add_u32 s99, s99, s74
    s_add_u32 s3, s32, s31
    s_and_b32 s4, s3, 1
    s_mul_i32 s4, s4, 12
    s_mul_i32 s7, s24, 20
    s_add_u32 s7, s7, 32
    s_add_u32 s75, s7, s4
    s_sub_u32 s4, 12, s4
    s_add_u32 s4, s4, s7
    s_lshl_b32 s4, s4, 8
    s_or_b32 s75, s75, s4
    s_mul_i32 s88, s7, 0x101
    s_add_u32 s88, s88, 0x1004
    s_mul_i32 s4, s24, 0x808
    s_add_u32 s4, s4, 0x400
    s_lshl_b32 s4, s4, 16
    s_or_b32 s88, s88, s4
    s_add_u32 s89, s7, 8
    s_mul_i32 s4, s3, 205
    s_lshr_b32 s4, s4, 10
    s_mul_i32 s4, s4, 5
    s_sub_u32 s3, s3, s4
    s_lshl_b32 s3, s3, 3
    s_lshr_b64 s[90:91], s[88:89], s3
    s_sub_u32 s3, 40, s3
    s_lshl_b64 s[88:89], s[88:89], s3
    s_or_b64 s[88:89], s[88:89], s[90:91]
    s_lshl_b32 s4, s88, 16
    s_or_b32 s75, s75, s4
    s_lshr_b64 s[88:89], s[88:89], 16
    s_mov_b32 s49, s88
    v_and_b32 v32, 31, v1
    v_lshrrev_b32 v33, 5, v1
    v_lshlrev_b32 v33, 3, v33
    v_sub_u32 v32, v32, v33
    v_and_b32 v33, 1, v32
    v_lshlrev_b32 v33, 4, v33
    v_mov_b32 v34, 0x3f80
    v_lshlrev_b32 v33, v33, v34
    v_ashrrev_i32 v32, 1, v32
    v_cmp_eq_u32 s[88:89], 0, v32
    v_cmp_eq_u32 s[90:91], 1, v32
    s_nop 0
    v_cndmask_b32 v34, 0, v33, s[88:89]
    v_accvgpr_write_b32 a184, v34
    v_cmp_eq_u32 s[88:89], 2, v32
    v_cndmask_b32 v34, 0, v33, s[90:91]
    v_accvgpr_write_b32 a185, v34
    v_cmp_eq_u32 s[90:91], 3, v32
    v_cndmask_b32 v34, 0, v33, s[88:89]
    v_accvgpr_write_b32 a186, v34
    v_cmp_eq_u32 s[88:89], 8, v32
    v_cndmask_b32 v34, 0, v33, s[90:91]
    v_accvgpr_write_b32 a187, v34
    v_cmp_eq_u32 s[90:91], 9, v32
    v_cndmask_b32 v34, 0, v33, s[88:89]
    v_accvgpr_write_b32 a188, v34
    v_cmp_eq_u32 s[88:89], 10, v32
    v_cndmask_b32 v34, 0, v33, s[90:91]
    v_accvgpr_write_b32 a189, v34
    v_cmp_eq_u32 s[90:91], 11, v32
    v_cndmask_b32 v34, 0, v33, s[88:89]
    v_accvgpr_write_b32 a190, v34
    s_nop 0
    v_cndmask_b32 v34, 0, v33, s[90:91]
    v_accvgpr_write_b32 a191, v34
    s_add_u32 m0, s77, 8192
    s_add_u32 s79, s78, 256
    s_and_b32 s79, s79, 1023
    s_add_u32 s79, s79, s76
    buffer_load_dwordx4 v56, s[8:11], s79 offen offset:0 lds
    buffer_load_dwordx4 v57, s[8:11], s79 offen offset:1024 lds
    buffer_load_dwordx4 v58, s[8:11], s79 offen offset:2048 lds
    buffer_load_dwordx4 v59, s[8:11], s79 offen offset:3072 lds
    s_add_u32 m0, s77, 12288
    s_add_u32 s79, s78, 384
    s_and_b32 s79, s79, 1023
    s_add_u32 s79, s79, s76
    buffer_load_dwordx4 v56, s[8:11], s79 offen offset:0 lds
    buffer_load_dwordx4 v57, s[8:11], s79 offen offset:1024 lds
    buffer_load_dwordx4 v58, s[8:11], s79 offen offset:2048 lds
    buffer_load_dwordx4 v59, s[8:11], s79 offen offset:3072 lds
    s_waitcnt vmcnt(17)
    ds_read_b128 v[192:195], v44 offset:0
    ds_read_b128 v[196:199], v45 offset:0
    ds_read_b128 v[200:203], v46 offset:0
    ds_read_b128 v[204:207], v47 offset:0
    s_add_u32 m0, s77, 16384
    s_add_u32 s79, s78, 512
    s_and_b32 s79, s79, 1023
    s_add_u32 s79, s79, s76
    buffer_load_dwordx4 v56, s[8:11], s79 offen offset:0 lds
    buffer_load_dwordx4 v57, s[8:11], s79 offen offset:1024 lds
    buffer_load_dwordx4 v58, s[8:11], s79 offen offset:2048 lds
    buffer_load_dwordx4 v59, s[8:11], s79 offen offset:3072 lds
    s_waitcnt vmcnt(17)
    ds_read_b128 v[208:211], v44 offset:4096
    ds_read_b128 v[212:215], v45 offset:4096
    ds_read_b128 v[216:219], v46 offset:4096
    ds_read_b128 v[220:223], v47 offset:4096
    s_waitcnt lgkmcnt(4)
    v_dot2_f32_bf16 v48, v192, s98, v48
    v_dot2_f32_bf16 v52, v192, v192, v52
    v_dot2_f32_bf16 v49, v193, s98, v49
    v_dot2_f32_bf16 v53, v193, v193, v53
    v_dot2_f32_bf16 v50, v194, s98, v50
    v_dot2_f32_bf16 v54, v194, v194, v54
    v_dot2_f32_bf16 v51, v195, s98, v51
    v_dot2_f32_bf16 v55, v195, v195, v55
    v_dot2_f32_bf16 v48, v196, s98, v48
    v_dot2_f32_bf16 v52, v196, v196, v52
    v_dot2_f32_bf16 v49, v197, s98, v49
    v_dot2_f32_bf16 v53, v197, v197, v53
    v_dot2_f32_bf16 v50, v198, s98, v50
    v_dot2_f32_bf16 v54, v198, v198, v54
    v_dot2_f32_bf16 v51, v199, s98, v51
    v_dot2_f32_bf16 v55, v199, v199, v55
    v_dot2_f32_bf16 v48, v200, s98, v48
    v_dot2_f32_bf16 v52, v200, v200, v52
    v_dot2_f32_bf16 v49, v201, s98, v49
    v_dot2_f32_bf16 v53, v201, v201, v53
    v_dot2_f32_bf16 v50, v202, s98, v50
    v_dot2_f32_bf16 v54, v202, v202, v54
    v_dot2_f32_bf16 v51, v203, s98, v51
    v_dot2_f32_bf16 v55, v203, v203, v55
    v_dot2_f32_bf16 v48, v204, s98, v48
    v_dot2_f32_bf16 v52, v204, v204, v52
    v_dot2_f32_bf16 v49, v205, s98, v49
    v_dot2_f32_bf16 v53, v205, v205, v53
    v_dot2_f32_bf16 v50, v206, s98, v50
    v_dot2_f32_bf16 v54, v206, v206, v54
    v_dot2_f32_bf16 v51, v207, s98, v51
    v_dot2_f32_bf16 v55, v207, v207, v55
    s_add_u32 m0, s77, 20480
    s_add_u32 s79, s78, 640
    s_and_b32 s79, s79, 1023
    s_add_u32 s79, s79, s76
    buffer_load_dwordx4 v56, s[8:11], s79 offen offset:0 lds
    buffer_load_dwordx4 v57, s[8:11], s79 offen offset:1024 lds
    buffer_load_dwordx4 v58, s[8:11], s79 offen offset:2048 lds
    buffer_load_dwordx4 v59, s[8:11], s79 offen offset:3072 lds
    s_waitcnt vmcnt(12)
    ds_read_b128 v[224:227], v44 offset:8192
    ds_read_b128 v[228:231], v45 offset:8192
    ds_read_b128 v[232:235], v46 offset:8192
    ds_read_b128 v[236:239], v47 offset:8192
    s_waitcnt lgkmcnt(4)
    v_dot2_f32_bf16 v48, v208, s98, v48
    v_dot2_f32_bf16 v52, v208, v208, v52
    v_dot2_f32_bf16 v49, v209, s98, v49
    v_dot2_f32_bf16 v53, v209, v209, v53
    v_dot2_f32_bf16 v50, v210, s98, v50
    v_dot2_f32_bf16 v54, v210, v210, v54
    v_dot2_f32_bf16 v51, v211, s98, v51
    v_dot2_f32_bf16 v55, v211, v211, v55
    v_dot2_f32_bf16 v48, v212, s98, v48
    v_dot2_f32_bf16 v52, v212, v212, v52
    v_dot2_f32_bf16 v49, v213, s98, v49
    v_dot2_f32_bf16 v53, v213, v213, v53
    v_dot2_f32_bf16 v50, v214, s98, v50
    v_dot2_f32_bf16 v54, v214, v214, v54
    v_dot2_f32_bf16 v51, v215, s98, v51
    v_dot2_f32_bf16 v55, v215, v215, v55
    v_dot2_f32_bf16 v48, v216, s98, v48
    v_dot2_f32_bf16 v52, v216, v216, v52
    v_dot2_f32_bf16 v49, v217, s98, v49
    v_dot2_f32_bf16 v53, v217, v217, v53
    v_dot2_f32_bf16 v50, v218, s98, v50
    v_dot2_f32_bf16 v54, v218, v218, v54
    v_dot2_f32_bf16 v51, v219, s98, v51
    v_dot2_f32_bf16 v55, v219, v219, v55
    v_dot2_f32_bf16 v48, v220, s98, v48
    v_dot2_f32_bf16 v52, v220, v220, v52
    v_dot2_f32_bf16 v49, v221, s98, v49
    v_dot2_f32_bf16 v53, v221, v221, v53
    v_dot2_f32_bf16 v50, v222, s98, v50
    v_dot2_f32_bf16 v54, v222, v222, v54
    v_dot2_f32_bf16 v51, v223, s98, v51
    v_dot2_f32_bf16 v55, v223, v223, v55
    s_add_u32 m0, s77, 24576
    s_add_u32 s79, s78, 768
    s_and_b32 s79, s79, 1023
    s_add_u32 s79, s79, s76
    buffer_load_dwordx4 v56, s[8:11], s79 offen offset:0 lds
    buffer_load_dwordx4 v57, s[8:11], s79 offen offset:1024 lds
    buffer_load_dwordx4 v58, s[8:11], s79 offen offset:2048 lds
    buffer_load_dwordx4 v59, s[8:11], s79 offen offset:3072 lds
    s_waitcnt vmcnt(12)
    ds_read_b128 v[240:243], v44 offset:12288
    ds_read_b128 v[244:247], v45 offset:12288
    ds_read_b128 v[248:251], v46 offset:12288
    ds_read_b128 v[252:255], v47 offset:12288
    s_waitcnt lgkmcnt(4)
    v_dot2_f32_bf16 v48, v224, s98, v48
    v_dot2_f32_bf16 v52, v224, v224, v52
    v_dot2_f32_bf16 v49, v225, s98, v49
    v_dot2_f32_bf16 v53, v225, v225, v53
    v_dot2_f32_bf16 v50, v226, s98, v50
    v_dot2_f32_bf16 v54, v226, v226, v54
    v_dot2_f32_bf16 v51, v227, s98, v51
    v_dot2_f32_bf16 v55, v227, v227, v55
    v_dot2_f32_bf16 v48, v228, s98, v48
    v_dot2_f32_bf16 v52, v228, v228, v52
    v_dot2_f32_bf16 v49, v229, s98, v49
    v_dot2_f32_bf16 v53, v229, v229, v53
    v_dot2_f32_bf16 v50, v230, s98, v50
    v_dot2_f32_bf16 v54, v230, v230, v54
    v_dot2_f32_bf16 v51, v231, s98, v51
    v_dot2_f32_bf16 v55, v231, v231, v55
    v_dot2_f32_bf16 v48, v232, s98, v48
    v_dot2_f32_bf16 v52, v232, v232, v52
    v_dot2_f32_bf16 v49, v233, s98, v49
    v_dot2_f32_bf16 v53, v233, v233, v53
    v_dot2_f32_bf16 v50, v234, s98, v50
    v_dot2_f32_bf16 v54, v234, v234, v54
    v_dot2_f32_bf16 v51, v235, s98, v51
    v_dot2_f32_bf16 v55, v235, v235, v55
    v_dot2_f32_bf16 v48, v236, s98, v48
    v_dot2_f32_bf16 v52, v236, v236, v52
    v_dot2_f32_bf16 v49, v237, s98, v49
    v_dot2_f32_bf16 v53, v237, v237, v53
    v_dot2_f32_bf16 v50, v238, s98, v50
    v_dot2_f32_bf16 v54, v238, v238, v54
    v_dot2_f32_bf16 v51, v239, s98, v51
    v_dot2_f32_bf16 v55, v239, v239, v55
    s_add_u32 m0, s77, 28672
    s_add_u32 s79, s78, 896
    s_and_b32 s79, s79, 1023
    s_add_u32 s79, s79, s76
    buffer_load_dwordx4 v56, s[8:11], s79 offen offset:0 lds
    buffer_load_dwordx4 v57, s[8:11], s79 offen offset:1024 lds
    buffer_load_dwordx4 v58, s[8:11], s79 offen offset:2048 lds
    buffer_load_dwordx4 v59, s[8:11], s79 offen offset:3072 lds
    s_waitcnt vmcnt(12)
    ds_read_b128 v[128:131], v44 offset:16384
    ds_read_b128 v[132:135], v45 offset:16384
    ds_read_b128 v[136:139], v46 offset:16384
    ds_read_b128 v[140:143], v47 offset:16384
    s_waitcnt lgkmcnt(4)
    v_dot2_f32_bf16 v48, v240, s98, v48
    v_dot2_f32_bf16 v52, v240, v240, v52
    v_dot2_f32_bf16 v49, v241, s98, v49
    v_dot2_f32_bf16 v53, v241, v241, v53
    v_dot2_f32_bf16 v50, v242, s98, v50
    v_dot2_f32_bf16 v54, v242, v242, v54
    v_dot2_f32_bf16 v51, v243, s98, v51
    v_dot2_f32_bf16 v55, v243, v243, v55
    v_dot2_f32_bf16 v48, v244, s98, v48
    v_dot2_f32_bf16 v52, v244, v244, v52
    v_dot2_f32_bf16 v49, v245, s98, v49
    v_dot2_f32_bf16 v53, v245, v245, v53
    v_dot2_f32_bf16 v50, v246, s98, v50
    v_dot2_f32_bf16 v54, v246, v246, v54
    v_dot2_f32_bf16 v51, v247, s98, v51
    v_dot2_f32_bf16 v55, v247, v247, v55
    v_dot2_f32_bf16 v48, v248, s98, v48
    v_dot2_f32_bf16 v52, v248, v248, v52
    v_dot2_f32_bf16 v49, v249, s98, v49
    v_dot2_f32_bf16 v53, v249, v249, v53
    v_dot2_f32_bf16 v50, v250, s98, v50
    v_dot2_f32_bf16 v54, v250, v250, v54
    v_dot2_f32_bf16 v51, v251, s98, v51
    v_dot2_f32_bf16 v55, v251, v251, v55
    v_dot2_f32_bf16 v48, v252, s98, v48
    v_dot2_f32_bf16 v52, v252, v252, v52
    v_dot2_f32_bf16 v49, v253, s98, v49
    v_dot2_f32_bf16 v53, v253, v253, v53
    v_dot2_f32_bf16 v50, v254, s98, v50
    v_dot2_f32_bf16 v54, v254, v254, v54
    v_dot2_f32_bf16 v51, v255, s98, v51
    v_dot2_f32_bf16 v55, v255, v255, v55
    s_lshr_b32 s90, s25, 2
    s_and_b32 s90, s90, 1
    s_xor_b32 s90, s90, 1
    s_lshl_b32 s91, s90, 12
    s_add_u32 m0, s33, s91
    s_mul_i32 s90, s90, 114688
    s_add_u32 s34, s38, s68
    s_add_u32 s34, s34, s90
    buffer_load_dwordx4 v20, s[16:19], s34 offen offset:0 lds
    buffer_load_dwordx4 v21, s[16:19], s34 offen offset:1024 lds
    s_waitcnt vmcnt(10)
    ds_read_b128 v[144:147], v44 offset:20480
    ds_read_b128 v[148:151], v45 offset:20480
    ds_read_b128 v[152:155], v46 offset:20480
    ds_read_b128 v[156:159], v47 offset:20480
    s_waitcnt lgkmcnt(4)
    v_dot2_f32_bf16 v48, v128, s98, v48
    v_dot2_f32_bf16 v52, v128, v128, v52
    v_dot2_f32_bf16 v49, v129, s98, v49
    v_dot2_f32_bf16 v53, v129, v129, v53
    v_dot2_f32_bf16 v50, v130, s98, v50
    v_dot2_f32_bf16 v54, v130, v130, v54
    v_dot2_f32_bf16 v51, v131, s98, v51
    v_dot2_f32_bf16 v55, v131, v131, v55
    v_dot2_f32_bf16 v48, v132, s98, v48
    v_dot2_f32_bf16 v52, v132, v132, v52
    v_dot2_f32_bf16 v49, v133, s98, v49
    v_dot2_f32_bf16 v53, v133, v133, v53
    v_dot2_f32_bf16 v50, v134, s98, v50
    v_dot2_f32_bf16 v54, v134, v134, v54
    v_dot2_f32_bf16 v51, v135, s98, v51
    v_dot2_f32_bf16 v55, v135, v135, v55
    buffer_load_dwordx4 v22, s[16:19], s34 offen offset:2048 lds
    buffer_load_dwordx4 v23, s[16:19], s34 offen offset:3072 lds
    v_dot2_f32_bf16 v48, v136, s98, v48
    v_dot2_f32_bf16 v52, v136, v136, v52
    v_dot2_f32_bf16 v49, v137, s98, v49
    v_dot2_f32_bf16 v53, v137, v137, v53
    v_dot2_f32_bf16 v50, v138, s98, v50
    v_dot2_f32_bf16 v54, v138, v138, v54
    v_dot2_f32_bf16 v51, v139, s98, v51
    v_dot2_f32_bf16 v55, v139, v139, v55
    v_dot2_f32_bf16 v48, v140, s98, v48
    v_dot2_f32_bf16 v52, v140, v140, v52
    v_dot2_f32_bf16 v49, v141, s98, v49
    v_dot2_f32_bf16 v53, v141, v141, v53
    v_dot2_f32_bf16 v50, v142, s98, v50
    v_dot2_f32_bf16 v54, v142, v142, v54
    v_dot2_f32_bf16 v51, v143, s98, v51
    v_dot2_f32_bf16 v55, v143, v143, v55
    s_waitcnt vmcnt(8)
    ds_read_b128 v[160:163], v44 offset:24576
    ds_read_b128 v[164:167], v45 offset:24576
    ds_read_b128 v[168:171], v46 offset:24576
    ds_read_b128 v[172:175], v47 offset:24576
    s_waitcnt lgkmcnt(4)
    v_dot2_f32_bf16 v48, v144, s98, v48
    v_dot2_f32_bf16 v52, v144, v144, v52
    v_dot2_f32_bf16 v49, v145, s98, v49
    v_dot2_f32_bf16 v53, v145, v145, v53
    v_dot2_f32_bf16 v50, v146, s98, v50
    v_dot2_f32_bf16 v54, v146, v146, v54
    v_dot2_f32_bf16 v51, v147, s98, v51
    v_dot2_f32_bf16 v55, v147, v147, v55
    v_dot2_f32_bf16 v48, v148, s98, v48
    v_dot2_f32_bf16 v52, v148, v148, v52
    v_dot2_f32_bf16 v49, v149, s98, v49
    v_dot2_f32_bf16 v53, v149, v149, v53
    v_dot2_f32_bf16 v50, v150, s98, v50
    v_dot2_f32_bf16 v54, v150, v150, v54
    v_dot2_f32_bf16 v51, v151, s98, v51
    v_dot2_f32_bf16 v55, v151, v151, v55
    v_dot2_f32_bf16 v48, v152, s98, v48
    v_dot2_f32_bf16 v52, v152, v152, v52
    v_dot2_f32_bf16 v49, v153, s98, v49
    v_dot2_f32_bf16 v53, v153, v153, v53
    v_dot2_f32_bf16 v50, v154, s98, v50
    v_dot2_f32_bf16 v54, v154, v154, v54
    v_dot2_f32_bf16 v51, v155, s98, v51
    v_dot2_f32_bf16 v55, v155, v155, v55
    v_dot2_f32_bf16 v48, v156, s98, v48
    v_dot2_f32_bf16 v52, v156, v156, v52
    v_dot2_f32_bf16 v49, v157, s98, v49
    v_dot2_f32_bf16 v53, v157, v157, v53
    v_dot2_f32_bf16 v50, v158, s98, v50
    v_dot2_f32_bf16 v54, v158, v158, v54
    v_dot2_f32_bf16 v51, v159, s98, v51
    v_dot2_f32_bf16 v55, v159, v159, v55
    s_and_b32 s88, s24, 1
    s_lshl_b32 s88, s88, 6
    v_xor_b32 v8, s88, v8
    v_xor_b32 v11, s88, v11
    v_add_u32 v57, 7168, v61
    v_add_u32 v58, 14336, v61
    v_add_u32 v59, 21504, v61
    v_mov_b32 v56, v61
    s_waitcnt vmcnt(4)
    ds_read_b128 v[176:179], v44 offset:28672
    ds_read_b128 v[180:183], v45 offset:28672
    ds_read_b128 v[184:187], v46 offset:28672
    ds_read_b128 v[188:191], v47 offset:28672
    s_waitcnt lgkmcnt(4)
    v_dot2_f32_bf16 v48, v160, s98, v48
    v_dot2_f32_bf16 v52, v160, v160, v52
    v_dot2_f32_bf16 v49, v161, s98, v49
    v_dot2_f32_bf16 v53, v161, v161, v53
    v_dot2_f32_bf16 v50, v162, s98, v50
    v_dot2_f32_bf16 v54, v162, v162, v54
    v_dot2_f32_bf16 v51, v163, s98, v51
    v_dot2_f32_bf16 v55, v163, v163, v55
    v_dot2_f32_bf16 v48, v164, s98, v48
    v_dot2_f32_bf16 v52, v164, v164, v52
    v_dot2_f32_bf16 v49, v165, s98, v49
    v_dot2_f32_bf16 v53, v165, v165, v53
    v_dot2_f32_bf16 v50, v166, s98, v50
    v_dot2_f32_bf16 v54, v166, v166, v54
    v_dot2_f32_bf16 v51, v167, s98, v51
    v_dot2_f32_bf16 v55, v167, v167, v55
    v_dot2_f32_bf16 v48, v168, s98, v48
    v_dot2_f32_bf16 v52, v168, v168, v52
    v_dot2_f32_bf16 v49, v169, s98, v49
    v_dot2_f32_bf16 v53, v169, v169, v53
    v_dot2_f32_bf16 v50, v170, s98, v50
    v_dot2_f32_bf16 v54, v170, v170, v54
    v_dot2_f32_bf16 v51, v171, s98, v51
    v_dot2_f32_bf16 v55, v171, v171, v55
    v_dot2_f32_bf16 v48, v172, s98, v48
    v_dot2_f32_bf16 v52, v172, v172, v52
    v_dot2_f32_bf16 v49, v173, s98, v49
    v_dot2_f32_bf16 v53, v173, v173, v53
    v_dot2_f32_bf16 v50, v174, s98, v50
    v_dot2_f32_bf16 v54, v174, v174, v54
    v_dot2_f32_bf16 v51, v175, s98, v51
    v_dot2_f32_bf16 v55, v175, v175, v55
    s_waitcnt lgkmcnt(0)
    v_dot2_f32_bf16 v48, v176, s98, v48
    v_dot2_f32_bf16 v52, v176, v176, v52
    v_dot2_f32_bf16 v49, v177, s98, v49
    v_dot2_f32_bf16 v53, v177, v177, v53
    v_dot2_f32_bf16 v50, v178, s98, v50
    v_dot2_f32_bf16 v54, v178, v178, v54
    v_dot2_f32_bf16 v51, v179, s98, v51
    v_dot2_f32_bf16 v55, v179, v179, v55
    v_dot2_f32_bf16 v48, v180, s98, v48
    v_dot2_f32_bf16 v52, v180, v180, v52
    v_dot2_f32_bf16 v49, v181, s98, v49
    v_dot2_f32_bf16 v53, v181, v181, v53
    v_dot2_f32_bf16 v50, v182, s98, v50
    v_dot2_f32_bf16 v54, v182, v182, v54
    v_dot2_f32_bf16 v51, v183, s98, v51
    v_dot2_f32_bf16 v55, v183, v183, v55
    v_dot2_f32_bf16 v48, v184, s98, v48
    v_dot2_f32_bf16 v52, v184, v184, v52
    v_dot2_f32_bf16 v49, v185, s98, v49
    v_dot2_f32_bf16 v53, v185, v185, v53
    v_dot2_f32_bf16 v50, v186, s98, v50
    v_dot2_f32_bf16 v54, v186, v186, v54
    v_dot2_f32_bf16 v51, v187, s98, v51
    v_dot2_f32_bf16 v55, v187, v187, v55
    v_dot2_f32_bf16 v48, v188, s98, v48
    v_dot2_f32_bf16 v52, v188, v188, v52
    v_dot2_f32_bf16 v49, v189, s98, v49
    v_dot2_f32_bf16 v53, v189, v189, v53
    v_dot2_f32_bf16 v50, v190, s98, v50
    v_dot2_f32_bf16 v54, v190, v190, v54
    v_dot2_f32_bf16 v51, v191, s98, v51
    v_dot2_f32_bf16 v55, v191, v191, v55
    s_nop 0
    v_add_f32 v48, v48, v49
    v_add_f32 v50, v50, v51
    v_add_f32 v52, v52, v53
    v_add_f32 v48, v48, v50
    v_add_f32 v54, v54, v55
    v_mov_b32 v49, v48
    v_add_f32 v61, v52, v54
    v_mov_b32 v15, v61
    v_permlane32_swap_b32 v48, v49
    s_nop 0
    v_permlane32_swap_b32 v61, v15
    v_add_f32 v48, v48, v49
    v_mul_f32 v14, 0x3b000000, v48
    v_cvt_pk_bf16_f32 v48, v14, v14
    v_and_b32 v48, 0xffff0000, v48
    v_xor_b32 v24, 0x80000000, v48
    v_mov_b32 v25, v24
    v_mov_b32 v26, v24
    v_mov_b32 v27, v24
    v_mov_b32 v28, v24
    v_mov_b32 v29, v24
    v_mov_b32 v30, v24
    v_mov_b32 v31, v24
    v_mov_b32 v32, v24
    v_mov_b32 v33, v24
    v_mov_b32 v34, v24
    v_mov_b32 v35, v24
    v_mov_b32 v36, v24
    v_mov_b32 v37, v24
    v_mov_b32 v38, v24
    v_mov_b32 v39, v24
    s_nop 1
    v_mfma_f32_32x32x16_bf16 v[40:55], a[184:187], v[192:195], v[24:39]
    v_mfma_f32_32x32x16_bf16 v[40:55], a[188:191], v[196:199], v[40:55]
    s_waitcnt vmcnt(0)
    s_barrier
    ds_read_b64_tr_b16 a[0:1], v6 offset:0
    ds_read_b64_tr_b16 a[2:3], v6 offset:1024
    ds_read_b64_tr_b16 a[4:5], v9 offset:0
    ds_read_b64_tr_b16 a[6:7], v9 offset:1024
    ds_read_b64_tr_b16 a[8:9], v6 offset:16384
    ds_read_b64_tr_b16 a[10:11], v6 offset:17408
    ds_read_b64_tr_b16 a[12:13], v9 offset:16384
    ds_read_b64_tr_b16 a[14:15], v9 offset:17408
    s_add_u32 m0, s33, 32768
    s_add_u32 s34, s38, s69
    buffer_load_dwordx4 v20, s[16:19], s34 offen offset:0 lds
    buffer_load_dwordx4 v21, s[16:19], s34 offen offset:1024 lds
    v_cvt_pk_bf16_f32 v192, v40, v41
    v_cvt_pk_bf16_f32 v193, v42, v43
    v_cvt_pk_bf16_f32 v194, v44, v45
    v_cvt_pk_bf16_f32 v195, v46, v47
    v_cvt_pk_bf16_f32 v196, v48, v49
    v_cvt_pk_bf16_f32 v197, v50, v51
    v_cvt_pk_bf16_f32 v198, v52, v53
    v_cvt_pk_bf16_f32 v199, v54, v55
    s_waitcnt lgkmcnt(4)
    v_mfma_f32_32x32x16_bf16 v[64:79], a[0:3], v[192:195], 0
    ds_read_b64_tr_b16 a[16:17], v6 offset:2048
    ds_read_b64_tr_b16 a[18:19], v6 offset:3072
    v_mfma_f32_32x32x16_bf16 v[40:55], a[184:187], v[200:203], v[24:39]
    buffer_load_dwordx4 v22, s[16:19], s34 offen offset:2048 lds
    v_mfma_f32_32x32x16_bf16 v[80:95], a[4:7], v[192:195], 0
    buffer_load_dwordx4 v23, s[16:19], s34 offen offset:3072 lds
    ds_read_b64_tr_b16 a[20:21], v9 offset:2048
    ds_read_b64_tr_b16 a[22:23], v9 offset:3072
    v_mfma_f32_32x32x16_bf16 v[40:55], a[188:191], v[204:207], v[40:55]
    s_add_u32 m0, s33, 36864
    s_add_u32 s34, s34, 114688
    s_waitcnt lgkmcnt(4)
    v_mfma_f32_32x32x16_bf16 v[96:111], a[8:11], v[192:195], 0
    buffer_load_dwordx4 v20, s[16:19], s34 offen offset:0 lds
    ds_read_b64_tr_b16 a[24:25], v6 offset:18432
    ds_read_b64_tr_b16 a[26:27], v6 offset:19456
    v_mfma_f32_32x32x16_bf16 v[112:127], a[12:15], v[192:195], 0
    ds_read_b64_tr_b16 a[28:29], v9 offset:18432
    ds_read_b64_tr_b16 a[30:31], v9 offset:19456
    v_add_f32 v61, v61, v15
    s_waitcnt lgkmcnt(4)
    v_mfma_f32_32x32x16_bf16 v[64:79], a[16:19], v[196:199], v[64:79]
    ds_read_b64_tr_b16 a[0:1], v6 offset:4096
    ds_read_b64_tr_b16 a[2:3], v6 offset:5120
    v_cvt_pk_bf16_f32 v200, v40, v41
    v_cvt_pk_bf16_f32 v201, v42, v43
    v_mul_f32 v61, 0x3b000000, v61
    v_mfma_f32_32x32x16_bf16 v[80:95], a[20:23], v[196:199], v[80:95]
    buffer_load_dwordx4 v21, s[16:19], s34 offen offset:1024 lds
    ds_read_b64_tr_b16 a[4:5], v9 offset:4096
    ds_read_b64_tr_b16 a[6:7], v9 offset:5120
    v_cvt_pk_bf16_f32 v202, v44, v45
    v_cvt_pk_bf16_f32 v203, v46, v47
    s_waitcnt lgkmcnt(4)
    v_mfma_f32_32x32x16_bf16 v[96:111], a[24:27], v[196:199], v[96:111]
    ds_read_b64_tr_b16 a[8:9], v6 offset:20480
    ds_read_b64_tr_b16 a[10:11], v6 offset:21504
    v_cvt_pk_bf16_f32 v204, v48, v49
    v_cvt_pk_bf16_f32 v205, v50, v51
    v_fma_f32 v61, -v14, v14, v61
    v_mfma_f32_32x32x16_bf16 v[112:127], a[28:31], v[196:199], v[112:127]
    buffer_load_dwordx4 v22, s[16:19], s34 offen offset:2048 lds
    ds_read_b64_tr_b16 a[12:13], v9 offset:20480
    ds_read_b64_tr_b16 a[14:15], v9 offset:21504
    v_cvt_pk_bf16_f32 v206, v52, v53
    v_cvt_pk_bf16_f32 v207, v54, v55
    v_max_f32 v61, 0, v61
    s_waitcnt lgkmcnt(4)
    v_mfma_f32_32x32x16_bf16 v[64:79], a[0:3], v[200:203], v[64:79]
    buffer_load_dwordx4 v23, s[16:19], s34 offen offset:3072 lds
    ds_read_b64_tr_b16 a[16:17], v6 offset:6144
    ds_read_b64_tr_b16 a[18:19], v6 offset:7168
    s_add_u32 m0, s33, 65536
    s_add_u32 s34, s38, s70
    v_mfma_f32_32x32x16_bf16 v[40:55], a[184:187], v[208:211], v[24:39]
    buffer_load_dwordx4 v20, s[16:19], s34 offen offset:0 lds
    v_mfma_f32_32x32x16_bf16 v[80:95], a[4:7], v[200:203], v[80:95]
    buffer_load_dwordx4 v21, s[16:19], s34 offen offset:1024 lds
    ds_read_b64_tr_b16 a[20:21], v9 offset:6144
    ds_read_b64_tr_b16 a[22:23], v9 offset:7168
    v_mfma_f32_32x32x16_bf16 v[40:55], a[188:191], v[212:215], v[40:55]
    v_cvt_pk_bf16_f32 v61, v61, v61
    s_waitcnt lgkmcnt(4)
    v_mfma_f32_32x32x16_bf16 v[96:111], a[8:11], v[200:203], v[96:111]
    buffer_load_dwordx4 v22, s[16:19], s34 offen offset:2048 lds
    ds_read_b64_tr_b16 a[24:25], v6 offset:22528
    ds_read_b64_tr_b16 a[26:27], v6 offset:23552
    v_mfma_f32_32x32x16_bf16 v[112:127], a[12:15], v[200:203], v[112:127]
    ds_read_b64_tr_b16 a[28:29], v9 offset:22528
    ds_read_b64_tr_b16 a[30:31], v9 offset:23552
    v_and_b32 v61, 0xffff0000, v61
    s_waitcnt lgkmcnt(4)
    v_mfma_f32_32x32x16_bf16 v[64:79], a[16:19], v[204:207], v[64:79]
    ds_read_b64_tr_b16 a[0:1], v6 offset:8192
    ds_read_b64_tr_b16 a[2:3], v6 offset:9216
    v_cvt_pk_bf16_f32 v208, v40, v41
    v_cvt_pk_bf16_f32 v209, v42, v43
    v_add_f32 v61, 0x3727c5ac, v61
    v_mfma_f32_32x32x16_bf16 v[80:95], a[20:23], v[204:207], v[80:95]
    buffer_load_dwordx4 v23, s[16:19], s34 offen offset:3072 lds
    ds_read_b64_tr_b16 a[4:5], v9 offset:8192
    ds_read_b64_tr_b16 a[6:7], v9 offset:9216
    v_cvt_pk_bf16_f32 v210, v44, v45
    v_cvt_pk_bf16_f32 v211, v46, v47
    s_waitcnt lgkmcnt(4)
    v_mfma_f32_32x32x16_bf16 v[96:111], a[24:27], v[204:207], v[96:111]
    ds_read_b64_tr_b16 a[8:9], v6 offset:24576
    ds_read_b64_tr_b16 a[10:11], v6 offset:25600
    s_add_u32 m0, s33, 69632
    s_add_u32 s34, s34, 114688
    v_cvt_pk_bf16_f32 v212, v48, v49
    v_cvt_pk_bf16_f32 v213, v50, v51
    v_cvt_pk_bf16_f32 v61, v61, v61
    v_mfma_f32_32x32x16_bf16 v[112:127], a[28:31], v[204:207], v[112:127]
    buffer_load_dwordx4 v20, s[16:19], s34 offen offset:0 lds
    ds_read_b64_tr_b16 a[12:13], v9 offset:24576
    ds_read_b64_tr_b16 a[14:15], v9 offset:25600
    v_cvt_pk_bf16_f32 v214, v52, v53
    v_cvt_pk_bf16_f32 v215, v54, v55
    s_waitcnt lgkmcnt(4)
    v_mfma_f32_32x32x16_bf16 v[64:79], a[0:3], v[208:211], v[64:79]
    buffer_load_dwordx4 v21, s[16:19], s34 offen offset:1024 lds
    ds_read_b64_tr_b16 a[16:17], v6 offset:10240
    ds_read_b64_tr_b16 a[18:19], v6 offset:11264
    v_mfma_f32_32x32x16_bf16 v[40:55], a[184:187], v[216:219], v[24:39]
    buffer_load_dwordx4 v22, s[16:19], s34 offen offset:2048 lds
    v_and_b32 v61, 0xffff0000, v61
    v_mfma_f32_32x32x16_bf16 v[80:95], a[4:7], v[208:211], v[80:95]
    buffer_load_dwordx4 v23, s[16:19], s34 offen offset:3072 lds
    ds_read_b64_tr_b16 a[20:21], v9 offset:10240
    ds_read_b64_tr_b16 a[22:23], v9 offset:11264
    v_mfma_f32_32x32x16_bf16 v[40:55], a[188:191], v[220:223], v[40:55]
    s_add_u32 m0, s33, 98304
    s_add_u32 s34, s38, s71
    v_sqrt_f32 v61, v61
    s_waitcnt lgkmcnt(4)
    v_mfma_f32_32x32x16_bf16 v[96:111], a[8:11], v[208:211], v[96:111]
    buffer_load_dwordx4 v20, s[16:19], s34 offen offset:0 lds
    ds_read_b64_tr_b16 a[24:25], v6 offset:26624
    ds_read_b64_tr_b16 a[26:27], v6 offset:27648
    v_mfma_f32_32x32x16_bf16 v[112:127], a[12:15], v[208:211], v[112:127]
    ds_read_b64_tr_b16 a[28:29], v9 offset:26624
    ds_read_b64_tr_b16 a[30:31], v9 offset:27648
    v_mov_b32 v14, 0x9e3779b9
    s_waitcnt lgkmcnt(4)
    v_mfma_f32_32x32x16_bf16 v[64:79], a[16:19], v[212:215], v[64:79]
    ds_read_b64_tr_b16 a[0:1], v6 offset:12288
    ds_read_b64_tr_b16 a[2:3], v6 offset:13312
    v_cvt_pk_bf16_f32 v216, v40, v41
    v_cvt_pk_bf16_f32 v217, v42, v43
    v_cvt_pk_bf16_f32 v61, v61, v61
    v_mfma_f32_32x32x16_bf16 v[80:95], a[20:23], v[212:215], v[80:95]
    buffer_load_dwordx4 v21, s[16:19], s34 offen offset:1024 lds
    ds_read_b64_tr_b16 a[4:5], v9 offset:12288
    ds_read_b64_tr_b16 a[6:7], v9 offset:13312
    v_cvt_pk_bf16_f32 v218, v44, v45
    v_cvt_pk_bf16_f32 v219, v46, v47
    s_waitcnt lgkmcnt(4)
    v_mfma_f32_32x32x16_bf16 v[96:111], a[24:27], v[212:215], v[96:111]
    ds_read_b64_tr_b16 a[8:9], v6 offset:28672
    ds_read_b64_tr_b16 a[10:11], v6 offset:29696
    v_cvt_pk_bf16_f32 v220, v48, v49
    v_cvt_pk_bf16_f32 v221, v50, v51
    v_and_b32 v61, 0xffff0000, v61
    v_mfma_f32_32x32x16_bf16 v[112:127], a[28:31], v[212:215], v[112:127]
    buffer_load_dwordx4 v22, s[16:19], s34 offen offset:2048 lds
    ds_read_b64_tr_b16 a[12:13], v9 offset:28672
    ds_read_b64_tr_b16 a[14:15], v9 offset:29696
    v_cvt_pk_bf16_f32 v222, v52, v53
    v_cvt_pk_bf16_f32 v223, v54, v55
    s_waitcnt lgkmcnt(4)
    v_mfma_f32_32x32x16_bf16 v[64:79], a[0:3], v[216:219], v[64:79]
    buffer_load_dwordx4 v23, s[16:19], s34 offen offset:3072 lds
    ds_read_b64_tr_b16 a[16:17], v6 offset:14336
    ds_read_b64_tr_b16 a[18:19], v6 offset:15360
    s_add_u32 m0, s33, 102400
    s_add_u32 s34, s34, 114688
    v_mfma_f32_32x32x16_bf16 v[40:55], a[184:187], v[224:227], v[24:39]
    buffer_load_dwordx4 v20, s[16:19], s34 offen offset:0 lds
    v_rcp_f32 v0, v61
    v_mfma_f32_32x32x16_bf16 v[80:95], a[4:7], v[216:219], v[80:95]
    buffer_load_dwordx4 v21, s[16:19], s34 offen offset:1024 lds
    ds_read_b64_tr_b16 a[20:21], v9 offset:14336
    ds_read_b64_tr_b16 a[22:23], v9 offset:15360
    v_mfma_f32_32x32x16_bf16 v[40:55], a[188:191], v[228:231], v[40:55]
    v_add_co_u32 v4, vcc, 0x7f4a7c15, v4
    s_nop 1
    v_addc_co_u32 v5, vcc, v14, v5, vcc
    s_waitcnt lgkmcnt(4)
    v_mfma_f32_32x32x16_bf16 v[96:111], a[8:11], v[216:219], v[96:111]
    buffer_load_dwordx4 v22, s[16:19], s34 offen offset:2048 lds
    ds_read_b64_tr_b16 a[24:25], v6 offset:30720
    ds_read_b64_tr_b16 a[26:27], v6 offset:31744
    v_mfma_f32_32x32x16_bf16 v[112:127], a[12:15], v[216:219], v[112:127]
    ds_read_b64_tr_b16 a[28:29], v9 offset:30720
    ds_read_b64_tr_b16 a[30:31], v9 offset:31744
    s_waitcnt vmcnt(15)
    s_barrier
    s_waitcnt lgkmcnt(4)
    v_mfma_f32_32x32x16_bf16 v[64:79], a[16:19], v[220:223], v[64:79]
    ds_read_b64_tr_b16 a[0:1], v6 offset:32768
    ds_read_b64_tr_b16 a[2:3], v6 offset:33792
    v_cvt_pk_bf16_f32 v224, v40, v41
    v_cvt_pk_bf16_f32 v225, v42, v43
    v_mfma_f32_32x32x16_bf16 v[80:95], a[20:23], v[220:223], v[80:95]
    buffer_load_dwordx4 v23, s[16:19], s34 offen offset:3072 lds
    ds_read_b64_tr_b16 a[4:5], v9 offset:32768
    ds_read_b64_tr_b16 a[6:7], v9 offset:33792
    v_cvt_pk_bf16_f32 v226, v44, v45
    v_cvt_pk_bf16_f32 v227, v46, v47
    s_waitcnt lgkmcnt(4)
    v_mfma_f32_32x32x16_bf16 v[96:111], a[24:27], v[220:223], v[96:111]
    ds_read_b64_tr_b16 a[8:9], v6 offset:49152
    ds_read_b64_tr_b16 a[10:11], v6 offset:50176
    v_cvt_pk_bf16_f32 v228, v48, v49
    v_cvt_pk_bf16_f32 v229, v50, v51
    v_mfma_f32_32x32x16_bf16 v[112:127], a[28:31], v[220:223], v[112:127]
    ds_read_b64_tr_b16 a[12:13], v9 offset:49152
    ds_read_b64_tr_b16 a[14:15], v9 offset:50176
    v_cvt_pk_bf16_f32 v230, v52, v53
    v_cvt_pk_bf16_f32 v231, v54, v55
    s_waitcnt lgkmcnt(4)
    v_mfma_f32_32x32x16_bf16 v[64:79], a[0:3], v[224:227], v[64:79]
    ds_read_b64_tr_b16 a[16:17], v6 offset:34816
    ds_read_b64_tr_b16 a[18:19], v6 offset:35840
    s_add_u32 m0, s48, 0
    s_bfe_u32 s76, s75, 0x80000
    s_lshl_b32 s76, s76, 14
    s_add_u32 s76, s76, s74
    v_mfma_f32_32x32x16_bf16 v[40:55], a[184:187], v[232:235], v[24:39]
    buffer_load_dwordx4 v56, s[56:59], s76 offen offset:0 lds
    v_mfma_f32_32x32x16_bf16 v[80:95], a[4:7], v[224:227], v[80:95]
    buffer_load_dwordx4 v57, s[56:59], s76 offen offset:1024 lds
    ds_read_b64_tr_b16 a[20:21], v9 offset:34816
    ds_read_b64_tr_b16 a[22:23], v9 offset:35840
    v_mfma_f32_32x32x16_bf16 v[40:55], a[188:191], v[236:239], v[40:55]
    s_waitcnt lgkmcnt(4)
    v_mfma_f32_32x32x16_bf16 v[96:111], a[8:11], v[224:227], v[96:111]
    buffer_load_dwordx4 v58, s[56:59], s76 offen offset:2048 lds
    ds_read_b64_tr_b16 a[24:25], v6 offset:51200
    ds_read_b64_tr_b16 a[26:27], v6 offset:52224
    v_mfma_f32_32x32x16_bf16 v[112:127], a[12:15], v[224:227], v[112:127]
    ds_read_b64_tr_b16 a[28:29], v9 offset:51200
    ds_read_b64_tr_b16 a[30:31], v9 offset:52224
    s_waitcnt lgkmcnt(4)
    v_mfma_f32_32x32x16_bf16 v[64:79], a[16:19], v[228:231], v[64:79]
    ds_read_b64_tr_b16 a[0:1], v6 offset:36864
    ds_read_b64_tr_b16 a[2:3], v6 offset:37888
    v_cvt_pk_bf16_f32 v232, v40, v41
    v_cvt_pk_bf16_f32 v233, v42, v43
    v_mfma_f32_32x32x16_bf16 v[80:95], a[20:23], v[228:231], v[80:95]
    ds_read_b64_tr_b16 a[4:5], v9 offset:36864
    ds_read_b64_tr_b16 a[6:7], v9 offset:37888
    v_cvt_pk_bf16_f32 v234, v44, v45
    v_cvt_pk_bf16_f32 v235, v46, v47
    s_waitcnt lgkmcnt(4)
    v_mfma_f32_32x32x16_bf16 v[96:111], a[24:27], v[228:231], v[96:111]
    ds_read_b64_tr_b16 a[8:9], v6 offset:53248
    ds_read_b64_tr_b16 a[10:11], v6 offset:54272
    v_cvt_pk_bf16_f32 v236, v48, v49
    v_cvt_pk_bf16_f32 v237, v50, v51
    v_mfma_f32_32x32x16_bf16 v[112:127], a[28:31], v[228:231], v[112:127]
    ds_read_b64_tr_b16 a[12:13], v9 offset:53248
    ds_read_b64_tr_b16 a[14:15], v9 offset:54272
    v_cvt_pk_bf16_f32 v238, v52, v53
    v_cvt_pk_bf16_f32 v239, v54, v55
    s_waitcnt lgkmcnt(4)
    v_mfma_f32_32x32x16_bf16 v[64:79], a[0:3], v[232:235], v[64:79]
    buffer_load_dwordx4 v59, s[56:59], s76 offen offset:3072 lds
    ds_read_b64_tr_b16 a[16:17], v6 offset:38912
    ds_read_b64_tr_b16 a[18:19], v6 offset:39936
    v_mfma_f32_32x32x16_bf16 v[40:55], a[184:187], v[240:243], v[24:39]
    s_add_u32 m0, s48, 4096
    s_add_u32 s76, s76, 32768
    v_mfma_f32_32x32x16_bf16 v[80:95], a[4:7], v[232:235], v[80:95]
    buffer_load_dwordx4 v56, s[56:59], s76 offen offset:0 lds
    ds_read_b64_tr_b16 a[20:21], v9 offset:38912
    ds_read_b64_tr_b16 a[22:23], v9 offset:39936
    v_mfma_f32_32x32x16_bf16 v[40:55], a[188:191], v[244:247], v[40:55]
    s_waitcnt lgkmcnt(4)
    v_mfma_f32_32x32x16_bf16 v[96:111], a[8:11], v[232:235], v[96:111]
    buffer_load_dwordx4 v57, s[56:59], s76 offen offset:1024 lds
    ds_read_b64_tr_b16 a[24:25], v6 offset:55296
    ds_read_b64_tr_b16 a[26:27], v6 offset:56320
    v_mfma_f32_32x32x16_bf16 v[112:127], a[12:15], v[232:235], v[112:127]
    ds_read_b64_tr_b16 a[28:29], v9 offset:55296
    ds_read_b64_tr_b16 a[30:31], v9 offset:56320
    s_waitcnt lgkmcnt(4)
    v_mfma_f32_32x32x16_bf16 v[64:79], a[16:19], v[236:239], v[64:79]
    ds_read_b64_tr_b16 a[0:1], v6 offset:40960
    ds_read_b64_tr_b16 a[2:3], v6 offset:41984
    v_cvt_pk_bf16_f32 v240, v40, v41
    v_cvt_pk_bf16_f32 v241, v42, v43
    v_mfma_f32_32x32x16_bf16 v[80:95], a[20:23], v[236:239], v[80:95]
    ds_read_b64_tr_b16 a[4:5], v9 offset:40960
    ds_read_b64_tr_b16 a[6:7], v9 offset:41984
    v_cvt_pk_bf16_f32 v242, v44, v45
    v_cvt_pk_bf16_f32 v243, v46, v47
    s_waitcnt lgkmcnt(4)
    v_mfma_f32_32x32x16_bf16 v[96:111], a[24:27], v[236:239], v[96:111]
    buffer_load_dwordx4 v58, s[56:59], s76 offen offset:2048 lds
    ds_read_b64_tr_b16 a[8:9], v6 offset:57344
    ds_read_b64_tr_b16 a[10:11], v6 offset:58368
    v_cvt_pk_bf16_f32 v244, v48, v49
    v_cvt_pk_bf16_f32 v245, v50, v51
    v_mfma_f32_32x32x16_bf16 v[112:127], a[28:31], v[236:239], v[112:127]
    ds_read_b64_tr_b16 a[12:13], v9 offset:57344
    ds_read_b64_tr_b16 a[14:15], v9 offset:58368
    v_cvt_pk_bf16_f32 v246, v52, v53
    v_cvt_pk_bf16_f32 v247, v54, v55
    s_waitcnt lgkmcnt(4)
    v_mfma_f32_32x32x16_bf16 v[64:79], a[0:3], v[240:243], v[64:79]
    buffer_load_dwordx4 v59, s[56:59], s76 offen offset:3072 lds
    ds_read_b64_tr_b16 a[16:17], v6 offset:43008
    ds_read_b64_tr_b16 a[18:19], v6 offset:44032
    v_mfma_f32_32x32x16_bf16 v[40:55], a[184:187], v[248:251], v[24:39]
    s_lshl_b32 s3, s2, 2
    s_add_u32 s3, s3, s24
    s_mul_i32 s4, s3, 1536
    s_and_b32 s5, s24, 1
    s_lshl_b32 s6, s2, 1
    s_add_u32 s6, s6, s5
    s_mul_i32 s6, s6, 3584
    v_mfma_f32_32x32x16_bf16 v[80:95], a[4:7], v[240:243], v[80:95]
    buffer_load_dword v60, v2, s[12:15], s4 offen
    ds_read_b64_tr_b16 a[20:21], v9 offset:43008
    ds_read_b64_tr_b16 a[22:23], v9 offset:44032
    v_mfma_f32_32x32x16_bf16 v[40:55], a[188:191], v[252:255], v[40:55]
    s_mov_b32 exec_hi, 0
    buffer_load_dword v60, v2, s[12:15], s4 offen offset:1024
    s_mov_b32 exec_hi, -1
    s_waitcnt lgkmcnt(4)
    v_mfma_f32_32x32x16_bf16 v[96:111], a[8:11], v[240:243], v[96:111]
    ds_read_b64_tr_b16 a[24:25], v6 offset:59392
    ds_read_b64_tr_b16 a[26:27], v6 offset:60416
    v_mfma_f32_32x32x16_bf16 v[112:127], a[12:15], v[240:243], v[112:127]
    ds_read_b64_tr_b16 a[28:29], v9 offset:59392
    ds_read_b64_tr_b16 a[30:31], v9 offset:60416
    s_waitcnt lgkmcnt(4)
    v_mfma_f32_32x32x16_bf16 v[64:79], a[16:19], v[244:247], v[64:79]
    ds_read_b64_tr_b16 a[0:1], v6 offset:45056
    ds_read_b64_tr_b16 a[2:3], v6 offset:46080
    v_cvt_pk_bf16_f32 v248, v40, v41
    v_cvt_pk_bf16_f32 v249, v42, v43
    v_mfma_f32_32x32x16_bf16 v[80:95], a[20:23], v[244:247], v[80:95]
    ds_read_b64_tr_b16 a[4:5], v9 offset:45056
    ds_read_b64_tr_b16 a[6:7], v9 offset:46080
    v_cvt_pk_bf16_f32 v250, v44, v45
    v_cvt_pk_bf16_f32 v251, v46, v47
    s_waitcnt lgkmcnt(4)
    v_mfma_f32_32x32x16_bf16 v[96:111], a[24:27], v[244:247], v[96:111]
    buffer_load_dword v60, v2, s[16:19], s6 offen offset:0
    ds_read_b64_tr_b16 a[8:9], v6 offset:61440
    ds_read_b64_tr_b16 a[10:11], v6 offset:62464
    v_cvt_pk_bf16_f32 v252, v48, v49
    v_cvt_pk_bf16_f32 v253, v50, v51
    v_mfma_f32_32x32x16_bf16 v[112:127], a[28:31], v[244:247], v[112:127]
    ds_read_b64_tr_b16 a[12:13], v9 offset:61440
    ds_read_b64_tr_b16 a[14:15], v9 offset:62464
    v_cvt_pk_bf16_f32 v254, v52, v53
    v_cvt_pk_bf16_f32 v255, v54, v55
    s_waitcnt lgkmcnt(4)
    v_mfma_f32_32x32x16_bf16 v[64:79], a[0:3], v[248:251], v[64:79]
    buffer_load_dword v60, v2, s[16:19], s6 offen offset:1024
    ds_read_b64_tr_b16 a[16:17], v6 offset:47104
    ds_read_b64_tr_b16 a[18:19], v6 offset:48128
    v_mfma_f32_32x32x16_bf16 v[40:55], a[184:187], v[128:131], v[24:39]
    v_mfma_f32_32x32x16_bf16 v[80:95], a[4:7], v[248:251], v[80:95]
    buffer_load_dword v60, v2, s[16:19], s6 offen offset:2048
    ds_read_b64_tr_b16 a[20:21], v9 offset:47104
    ds_read_b64_tr_b16 a[22:23], v9 offset:48128
    v_mfma_f32_32x32x16_bf16 v[40:55], a[188:191], v[132:135], v[40:55]
    s_mov_b32 exec_hi, 0
    buffer_load_dword v60, v2, s[16:19], s6 offen offset:3072
    s_mov_b32 exec_hi, -1
    s_waitcnt lgkmcnt(4)
    v_mfma_f32_32x32x16_bf16 v[96:111], a[8:11], v[248:251], v[96:111]
    ds_read_b64_tr_b16 a[24:25], v6 offset:63488
    ds_read_b64_tr_b16 a[26:27], v6 offset:64512
    v_mfma_f32_32x32x16_bf16 v[112:127], a[12:15], v[248:251], v[112:127]
    ds_read_b64_tr_b16 a[28:29], v9 offset:63488
    ds_read_b64_tr_b16 a[30:31], v9 offset:64512
    s_waitcnt vmcnt(22)
    s_barrier
    s_waitcnt lgkmcnt(4)
    v_mfma_f32_32x32x16_bf16 v[64:79], a[16:19], v[252:255], v[64:79]
    ds_read_b64_tr_b16 a[0:1], v7 offset:0
    ds_read_b64_tr_b16 a[2:3], v7 offset:1024
    v_cvt_pk_bf16_f32 v128, v40, v41
    v_cvt_pk_bf16_f32 v129, v42, v43
    v_cvt_pk_bf16_f32 v130, v44, v45
    v_mfma_f32_32x32x16_bf16 v[80:95], a[20:23], v[252:255], v[80:95]
    ds_read_b64_tr_b16 a[4:5], v10 offset:0
    ds_read_b64_tr_b16 a[6:7], v10 offset:1024
    v_cvt_pk_bf16_f32 v131, v46, v47
    v_accvgpr_write_b32 a192, v128
    v_cvt_pk_bf16_f32 v132, v48, v49
    s_waitcnt lgkmcnt(4)
    v_mfma_f32_32x32x16_bf16 v[96:111], a[24:27], v[252:255], v[96:111]
    ds_read_b64_tr_b16 a[8:9], v7 offset:16384
    ds_read_b64_tr_b16 a[10:11], v7 offset:17408
    v_accvgpr_write_b32 a193, v129
    v_cvt_pk_bf16_f32 v133, v50, v51
    v_accvgpr_write_b32 a194, v130
    v_mfma_f32_32x32x16_bf16 v[112:127], a[28:31], v[252:255], v[112:127]
    ds_read_b64_tr_b16 a[12:13], v10 offset:16384
    ds_read_b64_tr_b16 a[14:15], v10 offset:17408
    v_cvt_pk_bf16_f32 v134, v52, v53
    v_accvgpr_write_b32 a195, v131
    v_cvt_pk_bf16_f32 v135, v54, v55
    s_waitcnt lgkmcnt(4)
    v_mfma_f32_32x32x16_bf16 v[64:79], a[0:3], a[192:195], v[64:79]
    ds_read_b64_tr_b16 a[16:17], v7 offset:2048
    ds_read_b64_tr_b16 a[18:19], v7 offset:3072
    s_waitcnt vmcnt(10)
    ds_read_b64_tr_b16 a[32:33], v8 offset:0
    v_accvgpr_write_b32 a196, v132
    v_mfma_f32_32x32x16_bf16 v[40:55], a[184:187], v[136:139], v[24:39]
    ds_read_b64_tr_b16 a[34:35], v8 offset:1024
    ds_read_b64_tr_b16 a[36:37], v11 offset:0
    ds_read_b64_tr_b16 a[38:39], v11 offset:1024
    v_mfma_f32_32x32x16_bf16 v[80:95], a[4:7], a[192:195], v[80:95]
    ds_read_b64_tr_b16 a[20:21], v10 offset:2048
    ds_read_b64_tr_b16 a[22:23], v10 offset:3072
    v_accvgpr_write_b32 a197, v133
    v_mfma_f32_32x32x16_bf16 v[40:55], a[188:191], v[140:143], v[40:55]
    ds_read_b64_tr_b16 a[40:41], v8 offset:2048
    s_waitcnt lgkmcnt(9)
    v_mfma_f32_32x32x16_bf16 v[96:111], a[8:11], a[192:195], v[96:111]
    ds_read_b64_tr_b16 a[24:25], v7 offset:18432
    ds_read_b64_tr_b16 a[26:27], v7 offset:19456
    v_accvgpr_write_b32 a198, v134
    v_mfma_f32_32x32x16_bf16 v[112:127], a[12:15], a[192:195], v[112:127]
    ds_read_b64_tr_b16 a[28:29], v10 offset:18432
    ds_read_b64_tr_b16 a[30:31], v10 offset:19456
    v_accvgpr_write_b32 a199, v135
    s_waitcnt lgkmcnt(5)
    s_nop 0
    v_mfma_f32_32x32x16_bf16 v[64:79], a[16:19], a[196:199], v[64:79]
    ds_read_b64_tr_b16 a[0:1], v7 offset:4096
    ds_read_b64_tr_b16 a[2:3], v7 offset:5120
    v_cvt_pk_bf16_f32 v136, v40, v41
    v_cvt_pk_bf16_f32 v137, v42, v43
    v_cvt_pk_bf16_f32 v138, v44, v45
    v_mfma_f32_32x32x16_bf16 v[80:95], a[20:23], a[196:199], v[80:95]
    ds_read_b64_tr_b16 a[4:5], v10 offset:4096
    ds_read_b64_tr_b16 a[6:7], v10 offset:5120
    v_cvt_pk_bf16_f32 v139, v46, v47
    v_accvgpr_write_b32 a200, v136
    v_cvt_pk_bf16_f32 v140, v48, v49
    s_waitcnt lgkmcnt(4)
    v_mfma_f32_32x32x16_bf16 v[96:111], a[24:27], a[196:199], v[96:111]
    ds_read_b64_tr_b16 a[8:9], v7 offset:20480
    ds_read_b64_tr_b16 a[10:11], v7 offset:21504
    v_accvgpr_write_b32 a201, v137
    v_cvt_pk_bf16_f32 v141, v50, v51
    v_accvgpr_write_b32 a202, v138
    v_mfma_f32_32x32x16_bf16 v[112:127], a[28:31], a[196:199], v[112:127]
    ds_read_b64_tr_b16 a[12:13], v10 offset:20480
    ds_read_b64_tr_b16 a[14:15], v10 offset:21504
    v_cvt_pk_bf16_f32 v142, v52, v53
    v_accvgpr_write_b32 a203, v139
    v_cvt_pk_bf16_f32 v143, v54, v55
    s_waitcnt lgkmcnt(4)
    v_mfma_f32_32x32x16_bf16 v[64:79], a[0:3], a[200:203], v[64:79]
    ds_read_b64_tr_b16 a[16:17], v7 offset:6144
    ds_read_b64_tr_b16 a[18:19], v7 offset:7168
    ds_read_b64_tr_b16 a[42:43], v8 offset:3072
    v_accvgpr_write_b32 a204, v140
    v_mfma_f32_32x32x16_bf16 v[40:55], a[184:187], v[144:147], v[24:39]
    ds_read_b64_tr_b16 a[44:45], v11 offset:2048
    ds_read_b64_tr_b16 a[46:47], v11 offset:3072
    s_waitcnt lgkmcnt(0)
    s_add_u32 m0, s48, 0
    s_bfe_u32 s76, s75, 0x80008
    s_lshl_b32 s76, s76, 14
    s_add_u32 s76, s76, s74
    v_mfma_f32_32x32x16_bf16 v[80:95], a[4:7], a[200:203], v[80:95]
    buffer_load_dwordx4 v56, s[56:59], s76 offen offset:0 lds
    ds_read_b64_tr_b16 a[20:21], v10 offset:6144
    ds_read_b64_tr_b16 a[22:23], v10 offset:7168
    v_accvgpr_write_b32 a205, v141
    v_mfma_f32_32x32x16_bf16 v[40:55], a[188:191], v[148:151], v[40:55]
    v_mfma_f32_32x32x16_bf16 v[96:111], a[8:11], a[200:203], v[96:111]
    buffer_load_dwordx4 v57, s[56:59], s76 offen offset:1024 lds
    ds_read_b64_tr_b16 a[24:25], v7 offset:22528
    ds_read_b64_tr_b16 a[26:27], v7 offset:23552
    v_accvgpr_write_b32 a206, v142
    v_mfma_f32_32x32x16_bf16 v[112:127], a[12:15], a[200:203], v[112:127]
    ds_read_b64_tr_b16 a[28:29], v10 offset:22528
    ds_read_b64_tr_b16 a[30:31], v10 offset:23552
    v_accvgpr_write_b32 a207, v143
    s_waitcnt lgkmcnt(4)
    s_nop 0
    v_mfma_f32_32x32x16_bf16 v[64:79], a[16:19], a[204:207], v[64:79]
    ds_read_b64_tr_b16 a[0:1], v7 offset:8192
    ds_read_b64_tr_b16 a[2:3], v7 offset:9216
    v_cvt_pk_bf16_f32 v144, v40, v41
    v_cvt_pk_bf16_f32 v145, v42, v43
    v_cvt_pk_bf16_f32 v146, v44, v45
    v_mfma_f32_32x32x16_bf16 v[80:95], a[20:23], a[204:207], v[80:95]
    ds_read_b64_tr_b16 a[4:5], v10 offset:8192
    ds_read_b64_tr_b16 a[6:7], v10 offset:9216
    v_cvt_pk_bf16_f32 v147, v46, v47
    v_accvgpr_write_b32 a208, v144
    v_cvt_pk_bf16_f32 v148, v48, v49
    s_waitcnt lgkmcnt(4)
    v_mfma_f32_32x32x16_bf16 v[96:111], a[24:27], a[204:207], v[96:111]
    ds_read_b64_tr_b16 a[8:9], v7 offset:24576
    ds_read_b64_tr_b16 a[10:11], v7 offset:25600
    v_accvgpr_write_b32 a209, v145
    v_cvt_pk_bf16_f32 v149, v50, v51
    v_accvgpr_write_b32 a210, v146
    v_mfma_f32_32x32x16_bf16 v[112:127], a[28:31], a[204:207], v[112:127]
    ds_read_b64_tr_b16 a[12:13], v10 offset:24576
    ds_read_b64_tr_b16 a[14:15], v10 offset:25600
    v_cvt_pk_bf16_f32 v150, v52, v53
    v_accvgpr_write_b32 a211, v147
    v_cvt_pk_bf16_f32 v151, v54, v55
    s_waitcnt lgkmcnt(4)
    v_mfma_f32_32x32x16_bf16 v[64:79], a[0:3], a[208:211], v[64:79]
    ds_read_b64_tr_b16 a[16:17], v7 offset:10240
    ds_read_b64_tr_b16 a[18:19], v7 offset:11264
    v_accvgpr_write_b32 a212, v148
    v_mfma_f32_32x32x16_bf16 v[40:55], a[184:187], v[152:155], v[24:39]
    buffer_load_dwordx4 v58, s[56:59], s76 offen offset:2048 lds
    v_mfma_f32_32x32x16_bf16 v[80:95], a[4:7], a[208:211], v[80:95]
    buffer_load_dwordx4 v59, s[56:59], s76 offen offset:3072 lds
    ds_read_b64_tr_b16 a[20:21], v10 offset:10240
    ds_read_b64_tr_b16 a[22:23], v10 offset:11264
    s_add_u32 m0, s33, 0
    s_add_u32 s34, s39, s68
    v_accvgpr_write_b32 a213, v149
    v_mfma_f32_32x32x16_bf16 v[40:55], a[188:191], v[156:159], v[40:55]
    buffer_load_dwordx4 v20, s[16:19], s34 offen offset:0 lds
    s_waitcnt lgkmcnt(4)
    v_mfma_f32_32x32x16_bf16 v[96:111], a[8:11], a[208:211], v[96:111]
    buffer_load_dwordx4 v21, s[16:19], s34 offen offset:1024 lds
    ds_read_b64_tr_b16 a[24:25], v7 offset:26624
    ds_read_b64_tr_b16 a[26:27], v7 offset:27648
    v_accvgpr_write_b32 a214, v150
    v_mfma_f32_32x32x16_bf16 v[112:127], a[12:15], a[208:211], v[112:127]
    buffer_load_dwordx4 v22, s[16:19], s34 offen offset:2048 lds
    ds_read_b64_tr_b16 a[28:29], v10 offset:26624
    ds_read_b64_tr_b16 a[30:31], v10 offset:27648
    v_accvgpr_write_b32 a215, v151
    s_waitcnt lgkmcnt(4)
    s_nop 0
    v_mfma_f32_32x32x16_bf16 v[64:79], a[16:19], a[212:215], v[64:79]
    buffer_load_dwordx4 v23, s[16:19], s34 offen offset:3072 lds
    ds_read_b64_tr_b16 a[0:1], v7 offset:12288
    ds_read_b64_tr_b16 a[2:3], v7 offset:13312
    v_cvt_pk_bf16_f32 v152, v40, v41
    v_cvt_pk_bf16_f32 v153, v42, v43
    v_cvt_pk_bf16_f32 v154, v44, v45
    v_mfma_f32_32x32x16_bf16 v[80:95], a[20:23], a[212:215], v[80:95]
    ds_read_b64_tr_b16 a[4:5], v10 offset:12288
    ds_read_b64_tr_b16 a[6:7], v10 offset:13312
    v_cvt_pk_bf16_f32 v155, v46, v47
    v_accvgpr_write_b32 a216, v152
    v_cvt_pk_bf16_f32 v156, v48, v49
    s_waitcnt lgkmcnt(4)
    v_mfma_f32_32x32x16_bf16 v[96:111], a[24:27], a[212:215], v[96:111]
    ds_read_b64_tr_b16 a[8:9], v7 offset:28672
    ds_read_b64_tr_b16 a[10:11], v7 offset:29696
    v_accvgpr_write_b32 a217, v153
    v_cvt_pk_bf16_f32 v157, v50, v51
    v_accvgpr_write_b32 a218, v154
    v_mfma_f32_32x32x16_bf16 v[112:127], a[28:31], a[212:215], v[112:127]
    ds_read_b64_tr_b16 a[12:13], v10 offset:28672
    ds_read_b64_tr_b16 a[14:15], v10 offset:29696
    v_cvt_pk_bf16_f32 v158, v52, v53
    v_accvgpr_write_b32 a219, v155
    v_cvt_pk_bf16_f32 v159, v54, v55
    s_waitcnt lgkmcnt(4)
    v_mfma_f32_32x32x16_bf16 v[64:79], a[0:3], a[216:219], v[64:79]
    ds_read_b64_tr_b16 a[16:17], v7 offset:14336
    ds_read_b64_tr_b16 a[18:19], v7 offset:15360
    s_add_u32 m0, s33, 4096
    s_add_u32 s34, s34, 114688
    v_accvgpr_write_b32 a220, v156
    v_mfma_f32_32x32x16_bf16 v[40:55], a[184:187], v[160:163], v[24:39]
    buffer_load_dwordx4 v20, s[16:19], s34 offen offset:0 lds
    v_mfma_f32_32x32x16_bf16 v[80:95], a[4:7], a[216:219], v[80:95]
    buffer_load_dwordx4 v21, s[16:19], s34 offen offset:1024 lds
    ds_read_b64_tr_b16 a[20:21], v10 offset:14336
    ds_read_b64_tr_b16 a[22:23], v10 offset:15360
    v_accvgpr_write_b32 a221, v157
    v_mfma_f32_32x32x16_bf16 v[40:55], a[188:191], v[164:167], v[40:55]
    buffer_load_dwordx4 v22, s[16:19], s34 offen offset:2048 lds
    s_waitcnt lgkmcnt(4)
    v_mfma_f32_32x32x16_bf16 v[96:111], a[8:11], a[216:219], v[96:111]
    buffer_load_dwordx4 v23, s[16:19], s34 offen offset:3072 lds
    ds_read_b64_tr_b16 a[24:25], v7 offset:30720
    ds_read_b64_tr_b16 a[26:27], v7 offset:31744
    s_lshl_b32 s3, s2, 2
    s_add_u32 s3, s3, s24
    s_mul_i32 s4, s3, 1792
    s_lshl_b32 s5, s3, 9
    v_accvgpr_write_b32 a222, v158
    v_mfma_f32_32x32x16_bf16 v[112:127], a[12:15], a[216:219], v[112:127]
    buffer_load_dword v60, v2, s[56:59], s4 offen
    ds_read_b64_tr_b16 a[28:29], v10 offset:30720
    ds_read_b64_tr_b16 a[30:31], v10 offset:31744
    v_accvgpr_write_b32 a223, v159
    s_barrier
    s_waitcnt lgkmcnt(4)
    v_mfma_f32_32x32x16_bf16 v[64:79], a[16:19], a[220:223], v[64:79]
    buffer_load_dword v60, v2, s[56:59], s4 offen offset:768
    ds_read_b64_tr_b16 a[0:1], v7 offset:32768
    ds_read_b64_tr_b16 a[2:3], v7 offset:33792
    v_cvt_pk_bf16_f32 v160, v40, v41
    v_cvt_pk_bf16_f32 v161, v42, v43
    v_cvt_pk_bf16_f32 v162, v44, v45
    v_mfma_f32_32x32x16_bf16 v[80:95], a[20:23], a[220:223], v[80:95]
    ds_read_b64_tr_b16 a[4:5], v10 offset:32768
    ds_read_b64_tr_b16 a[6:7], v10 offset:33792
    v_cvt_pk_bf16_f32 v163, v46, v47
    v_accvgpr_write_b32 a224, v160
    v_cvt_pk_bf16_f32 v164, v48, v49
    s_waitcnt lgkmcnt(4)
    v_mfma_f32_32x32x16_bf16 v[96:111], a[24:27], a[220:223], v[96:111]
    ds_read_b64_tr_b16 a[8:9], v7 offset:49152
    ds_read_b64_tr_b16 a[10:11], v7 offset:50176
    v_accvgpr_write_b32 a225, v161
    v_cvt_pk_bf16_f32 v165, v50, v51
    v_accvgpr_write_b32 a226, v162
    v_mfma_f32_32x32x16_bf16 v[112:127], a[28:31], a[220:223], v[112:127]
    ds_read_b64_tr_b16 a[12:13], v10 offset:49152
    ds_read_b64_tr_b16 a[14:15], v10 offset:50176
    v_cvt_pk_bf16_f32 v166, v52, v53
    v_accvgpr_write_b32 a227, v163
    v_cvt_pk_bf16_f32 v167, v54, v55
    s_mov_b32 exec_hi, 0
    buffer_load_dword v60, v2, s[80:83], s5 offen
    s_mov_b32 exec_hi, -1
    s_cmp_lg_u32 s24, 0
    s_cbranch_scc1 L_ct_5
    s_and_b32 s3, s35, 15
    s_mul_i32 s3, s3, 768
    s_add_u32 s3, s3, 0x7864
    v_lshlrev_b32 v14, 7, v1
    v_add_u32 v14, s3, v14
    v_min_u32 v14, 0xbde8, v14
    v_mov_b32 v15, s101
    v_add_co_u32 v14, vcc, s100, v14
    s_nop 1
    v_addc_co_u32 v15, vcc, 0, v15, vcc
    s_mov_b64 exec, 63
    global_load_dword v60, v[14:15], off
    s_mov_b64 exec, -1
L_ct_5:
    s_waitcnt lgkmcnt(4)
    v_mfma_f32_32x32x16_bf16 v[64:79], a[0:3], a[224:227], v[64:79]
    ds_read_b64_tr_b16 a[16:17], v7 offset:34816
    ds_read_b64_tr_b16 a[18:19], v7 offset:35840
    s_waitcnt vmcnt(21)
    ds_read_b64_tr_b16 a[48:49], v8 offset:4096
    v_accvgpr_write_b32 a228, v164
    v_mfma_f32_32x32x16_bf16 v[40:55], a[184:187], v[168:171], v[24:39]
    ds_read_b64_tr_b16 a[50:51], v8 offset:5120
    ds_read_b64_tr_b16 a[52:53], v11 offset:4096
    ds_read_b64_tr_b16 a[54:55], v11 offset:5120
    v_mfma_f32_32x32x16_bf16 v[80:95], a[4:7], a[224:227], v[80:95]
    ds_read_b64_tr_b16 a[20:21], v10 offset:34816
    ds_read_b64_tr_b16 a[22:23], v10 offset:35840
    v_accvgpr_write_b32 a229, v165
    v_mfma_f32_32x32x16_bf16 v[40:55], a[188:191], v[172:175], v[40:55]
    ds_read_b64_tr_b16 a[56:57], v8 offset:6144
    ds_read_b64_tr_b16 a[58:59], v8 offset:7168
    ds_read_b64_tr_b16 a[60:61], v11 offset:6144
    s_waitcnt lgkmcnt(11)
    v_mfma_f32_32x32x16_bf16 v[96:111], a[8:11], a[224:227], v[96:111]
    ds_read_b64_tr_b16 a[24:25], v7 offset:51200
    ds_read_b64_tr_b16 a[26:27], v7 offset:52224
    v_accvgpr_write_b32 a230, v166
    v_mfma_f32_32x32x16_bf16 v[112:127], a[12:15], a[224:227], v[112:127]
    ds_read_b64_tr_b16 a[28:29], v10 offset:51200
    ds_read_b64_tr_b16 a[30:31], v10 offset:52224
    v_accvgpr_write_b32 a231, v167
    s_waitcnt lgkmcnt(7)
    s_nop 0
    v_mfma_f32_32x32x16_bf16 v[64:79], a[16:19], a[228:231], v[64:79]
    ds_read_b64_tr_b16 a[0:1], v7 offset:36864
    ds_read_b64_tr_b16 a[2:3], v7 offset:37888
    v_cvt_pk_bf16_f32 v168, v40, v41
    v_cvt_pk_bf16_f32 v169, v42, v43
    v_cvt_pk_bf16_f32 v170, v44, v45
    v_mfma_f32_32x32x16_bf16 v[80:95], a[20:23], a[228:231], v[80:95]
    ds_read_b64_tr_b16 a[4:5], v10 offset:36864
    ds_read_b64_tr_b16 a[6:7], v10 offset:37888
    v_cvt_pk_bf16_f32 v171, v46, v47
    v_accvgpr_write_b32 a232, v168
    v_cvt_pk_bf16_f32 v172, v48, v49
    s_waitcnt lgkmcnt(4)
    v_mfma_f32_32x32x16_bf16 v[96:111], a[24:27], a[228:231], v[96:111]
    ds_read_b64_tr_b16 a[8:9], v7 offset:53248
    ds_read_b64_tr_b16 a[10:11], v7 offset:54272
    v_accvgpr_write_b32 a233, v169
    v_cvt_pk_bf16_f32 v173, v50, v51
    v_accvgpr_write_b32 a234, v170
    v_mfma_f32_32x32x16_bf16 v[112:127], a[28:31], a[228:231], v[112:127]
    ds_read_b64_tr_b16 a[12:13], v10 offset:53248
    ds_read_b64_tr_b16 a[14:15], v10 offset:54272
    v_cvt_pk_bf16_f32 v174, v52, v53
    v_accvgpr_write_b32 a235, v171
    v_cvt_pk_bf16_f32 v175, v54, v55
    s_waitcnt lgkmcnt(4)
    v_mfma_f32_32x32x16_bf16 v[64:79], a[0:3], a[232:235], v[64:79]
    ds_read_b64_tr_b16 a[16:17], v7 offset:38912
    ds_read_b64_tr_b16 a[18:19], v7 offset:39936
    ds_read_b64_tr_b16 a[62:63], v11 offset:7168
    s_waitcnt lgkmcnt(0)
    s_add_u32 m0, s48, 4096
    s_add_u32 s76, s76, 32768
    v_accvgpr_write_b32 a236, v172
    v_mfma_f32_32x32x16_bf16 v[40:55], a[184:187], v[176:179], v[24:39]
    buffer_load_dwordx4 v56, s[56:59], s76 offen offset:0 lds
    v_mfma_f32_32x32x16_bf16 v[80:95], a[4:7], a[232:235], v[80:95]
    buffer_load_dwordx4 v57, s[56:59], s76 offen offset:1024 lds
    ds_read_b64_tr_b16 a[20:21], v10 offset:38912
    ds_read_b64_tr_b16 a[22:23], v10 offset:39936
    v_accvgpr_write_b32 a237, v173
    v_mfma_f32_32x32x16_bf16 v[40:55], a[188:191], v[180:183], v[40:55]
    v_mfma_f32_32x32x16_bf16 v[96:111], a[8:11], a[232:235], v[96:111]
    buffer_load_dwordx4 v58, s[56:59], s76 offen offset:2048 lds
    ds_read_b64_tr_b16 a[24:25], v7 offset:55296
    ds_read_b64_tr_b16 a[26:27], v7 offset:56320
    v_accvgpr_write_b32 a238, v174
    v_mfma_f32_32x32x16_bf16 v[112:127], a[12:15], a[232:235], v[112:127]
    buffer_load_dwordx4 v59, s[56:59], s76 offen offset:3072 lds
    ds_read_b64_tr_b16 a[28:29], v10 offset:55296
    ds_read_b64_tr_b16 a[30:31], v10 offset:56320
    s_add_u32 m0, s33, 32768
    s_add_u32 s34, s39, s69
    v_accvgpr_write_b32 a239, v175
    s_waitcnt lgkmcnt(4)
    s_nop 0
    v_mfma_f32_32x32x16_bf16 v[64:79], a[16:19], a[236:239], v[64:79]
    buffer_load_dwordx4 v20, s[16:19], s34 offen offset:0 lds
    ds_read_b64_tr_b16 a[0:1], v7 offset:40960
    ds_read_b64_tr_b16 a[2:3], v7 offset:41984
    v_cvt_pk_bf16_f32 v176, v40, v41
    v_cvt_pk_bf16_f32 v177, v42, v43
    v_cvt_pk_bf16_f32 v178, v44, v45
    v_mfma_f32_32x32x16_bf16 v[80:95], a[20:23], a[236:239], v[80:95]
    ds_read_b64_tr_b16 a[4:5], v10 offset:40960
    ds_read_b64_tr_b16 a[6:7], v10 offset:41984
    v_cvt_pk_bf16_f32 v179, v46, v47
    v_accvgpr_write_b32 a240, v176
    v_cvt_pk_bf16_f32 v180, v48, v49
    s_waitcnt lgkmcnt(4)
    v_mfma_f32_32x32x16_bf16 v[96:111], a[24:27], a[236:239], v[96:111]
    ds_read_b64_tr_b16 a[8:9], v7 offset:57344
    ds_read_b64_tr_b16 a[10:11], v7 offset:58368
    v_accvgpr_write_b32 a241, v177
    v_cvt_pk_bf16_f32 v181, v50, v51
    v_accvgpr_write_b32 a242, v178
    v_mfma_f32_32x32x16_bf16 v[112:127], a[28:31], a[236:239], v[112:127]
    ds_read_b64_tr_b16 a[12:13], v10 offset:57344
    ds_read_b64_tr_b16 a[14:15], v10 offset:58368
    v_cvt_pk_bf16_f32 v182, v52, v53
    v_accvgpr_write_b32 a243, v179
    v_cvt_pk_bf16_f32 v183, v54, v55
    s_waitcnt lgkmcnt(4)
    v_mfma_f32_32x32x16_bf16 v[64:79], a[0:3], a[240:243], v[64:79]
    ds_read_b64_tr_b16 a[16:17], v7 offset:43008
    ds_read_b64_tr_b16 a[18:19], v7 offset:44032
    v_accvgpr_write_b32 a244, v180
    v_mfma_f32_32x32x16_bf16 v[40:55], a[184:187], v[184:187], v[24:39]
    buffer_load_dwordx4 v21, s[16:19], s34 offen offset:1024 lds
    v_mfma_f32_32x32x16_bf16 v[80:95], a[4:7], a[240:243], v[80:95]
    buffer_load_dwordx4 v22, s[16:19], s34 offen offset:2048 lds
    ds_read_b64_tr_b16 a[20:21], v10 offset:43008
    ds_read_b64_tr_b16 a[22:23], v10 offset:44032
    v_accvgpr_write_b32 a245, v181
    v_mfma_f32_32x32x16_bf16 v[40:55], a[188:191], v[188:191], v[40:55]
    buffer_load_dwordx4 v23, s[16:19], s34 offen offset:3072 lds
    s_add_u32 m0, s33, 36864
    s_add_u32 s34, s34, 114688
    s_waitcnt lgkmcnt(4)
    v_mfma_f32_32x32x16_bf16 v[96:111], a[8:11], a[240:243], v[96:111]
    buffer_load_dwordx4 v20, s[16:19], s34 offen offset:0 lds
    ds_read_b64_tr_b16 a[24:25], v7 offset:59392
    ds_read_b64_tr_b16 a[26:27], v7 offset:60416
    v_accvgpr_write_b32 a246, v182
    v_mfma_f32_32x32x16_bf16 v[112:127], a[12:15], a[240:243], v[112:127]
    buffer_load_dwordx4 v21, s[16:19], s34 offen offset:1024 lds
    ds_read_b64_tr_b16 a[28:29], v10 offset:59392
    ds_read_b64_tr_b16 a[30:31], v10 offset:60416
    v_accvgpr_write_b32 a247, v183
    s_waitcnt lgkmcnt(4)
    s_nop 0
    v_mfma_f32_32x32x16_bf16 v[64:79], a[16:19], a[244:247], v[64:79]
    buffer_load_dwordx4 v22, s[16:19], s34 offen offset:2048 lds
    ds_read_b64_tr_b16 a[0:1], v7 offset:45056
    ds_read_b64_tr_b16 a[2:3], v7 offset:46080
    v_cvt_pk_bf16_f32 v184, v40, v41
    v_cvt_pk_bf16_f32 v185, v42, v43
    v_cvt_pk_bf16_f32 v186, v44, v45
    v_mfma_f32_32x32x16_bf16 v[80:95], a[20:23], a[244:247], v[80:95]
    ds_read_b64_tr_b16 a[4:5], v10 offset:45056
    ds_read_b64_tr_b16 a[6:7], v10 offset:46080
    v_cvt_pk_bf16_f32 v187, v46, v47
    v_accvgpr_write_b32 a248, v184
    v_cvt_pk_bf16_f32 v188, v48, v49
    s_waitcnt lgkmcnt(4)
    v_mfma_f32_32x32x16_bf16 v[96:111], a[24:27], a[244:247], v[96:111]
    ds_read_b64_tr_b16 a[8:9], v7 offset:61440
    ds_read_b64_tr_b16 a[10:11], v7 offset:62464
    v_accvgpr_write_b32 a249, v185
    v_cvt_pk_bf16_f32 v189, v50, v51
    v_accvgpr_write_b32 a250, v186
    v_mfma_f32_32x32x16_bf16 v[112:127], a[28:31], a[244:247], v[112:127]
    ds_read_b64_tr_b16 a[12:13], v10 offset:61440
    ds_read_b64_tr_b16 a[14:15], v10 offset:62464
    v_cvt_pk_bf16_f32 v190, v52, v53
    v_accvgpr_write_b32 a251, v187
    v_cvt_pk_bf16_f32 v191, v54, v55
    s_waitcnt lgkmcnt(4)
    v_mfma_f32_32x32x16_bf16 v[64:79], a[0:3], a[248:251], v[64:79]
    ds_read_b64_tr_b16 a[16:17], v7 offset:47104
    ds_read_b64_tr_b16 a[18:19], v7 offset:48128
    v_accvgpr_write_b32 a252, v188
    v_mfma_f32_32x32x16_bf16 v[80:95], a[4:7], a[248:251], v[80:95]
    buffer_load_dwordx4 v23, s[16:19], s34 offen offset:3072 lds
    ds_read_b64_tr_b16 a[20:21], v10 offset:47104
    ds_read_b64_tr_b16 a[22:23], v10 offset:48128
    s_waitcnt vmcnt(23)
    ds_read_b64_tr_b16 a[64:65], v8 offset:0
    ds_read_b64_tr_b16 a[66:67], v8 offset:1024
    v_accvgpr_write_b32 a253, v189
    s_waitcnt lgkmcnt(6)
    v_mfma_f32_32x32x16_bf16 v[96:111], a[8:11], a[248:251], v[96:111]
    ds_read_b64_tr_b16 a[24:25], v7 offset:63488
    ds_read_b64_tr_b16 a[26:27], v7 offset:64512
    ds_read_b64_tr_b16 a[68:69], v11 offset:0
    ds_read_b64_tr_b16 a[70:71], v11 offset:1024
    v_accvgpr_write_b32 a254, v190
    v_mfma_f32_32x32x16_bf16 v[112:127], a[12:15], a[248:251], v[112:127]
    ds_read_b64_tr_b16 a[28:29], v10 offset:63488
    ds_read_b64_tr_b16 a[30:31], v10 offset:64512
    ds_read_b64_tr_b16 a[72:73], v8 offset:2048
    ds_read_b64_tr_b16 a[74:75], v8 offset:3072
    v_accvgpr_write_b32 a255, v191
    s_waitcnt vmcnt(15)
    s_barrier
    s_waitcnt lgkmcnt(10)
    v_mfma_f32_32x32x16_bf16 v[64:79], a[16:19], a[252:255], v[64:79]
    ds_read_b64_tr_b16 a[0:1], v6 offset:0
    ds_read_b64_tr_b16 a[2:3], v6 offset:1024
    ds_read_b64_tr_b16 a[76:77], v11 offset:2048
    ds_read_b64_tr_b16 a[78:79], v11 offset:3072
    s_waitcnt lgkmcnt(0)
    s_add_u32 m0, s48, 0
    s_bfe_u32 s76, s75, 0x80010
    s_lshl_b32 s76, s76, 14
    s_add_u32 s76, s76, s74
    v_mul_f32 v28, 0xbfb8aa3b, v0
    v_mul_f32 v29, v61, v61
    v_mul_f32 v30, 0x3eb8aa3b, v0
    v_mfma_f32_32x32x16_bf16 v[80:95], a[20:23], a[252:255], v[80:95]
    buffer_load_dwordx4 v56, s[56:59], s76 offen offset:0 lds
    ds_read_b64_tr_b16 a[4:5], v9 offset:0
    ds_read_b64_tr_b16 a[6:7], v9 offset:1024
    v_lshrrev_b32 v31, 2, v1
    v_and_b32 v27, 3, v1
    v_lshlrev_b32 v27, 7, v27
    v_lshl_add_u32 v31, v31, 11, v27
    v_mfma_f32_32x32x16_bf16 v[96:111], a[24:27], a[252:255], v[96:111]
    buffer_load_dwordx4 v57, s[56:59], s76 offen offset:1024 lds
    ds_read_b64_tr_b16 a[8:9], v6 offset:16384
    ds_read_b64_tr_b16 a[10:11], v6 offset:17408
    v_mfma_f32_32x32x16_bf16 v[112:127], a[28:31], a[252:255], v[112:127]
    buffer_load_dwordx4 v58, s[56:59], s76 offen offset:2048 lds
    ds_read_b64_tr_b16 a[12:13], v9 offset:16384
    ds_read_b64_tr_b16 a[14:15], v9 offset:17408
L_mid1:
    s_waitcnt lgkmcnt(4)
    v_mfma_f32_32x32x16_bf16 v[128:143], a[0:3], v[192:195], 0
    buffer_load_dwordx4 v59, s[56:59], s76 offen offset:3072 lds
    ds_read_b64_tr_b16 a[16:17], v6 offset:2048
    ds_read_b64_tr_b16 a[18:19], v6 offset:3072
    s_waitcnt vmcnt(12)
    ds_read_b64_tr_b16 a[80:81], v8 offset:4096
    v_mfma_f32_32x32x16_bf16 v[144:159], a[4:7], v[192:195], 0
    ds_read_b64_tr_b16 a[20:21], v9 offset:2048
    ds_read_b64_tr_b16 a[22:23], v9 offset:3072
    ds_read_b64_tr_b16 a[82:83], v8 offset:5120
    s_waitcnt lgkmcnt(6)
    v_mfma_f32_32x32x16_bf16 v[160:175], a[8:11], v[192:195], 0
    ds_read_b64_tr_b16 a[24:25], v6 offset:18432
    ds_read_b64_tr_b16 a[26:27], v6 offset:19456
    ds_read_b64_tr_b16 a[84:85], v11 offset:4096
    v_mfma_f32_32x32x16_bf16 v[176:191], a[12:15], v[192:195], 0
    ds_read_b64_tr_b16 a[28:29], v9 offset:18432
    ds_read_b64_tr_b16 a[30:31], v9 offset:19456
    ds_read_b64_tr_b16 a[86:87], v11 offset:5120
    v_mul_f32 v32, v28, v64
    v_exp_f32 v32, v32
    s_waitcnt lgkmcnt(7)
    v_mfma_f32_32x32x16_bf16 v[128:143], a[16:19], v[196:199], v[128:143]
    ds_read_b64_tr_b16 a[0:1], v6 offset:4096
    ds_read_b64_tr_b16 a[2:3], v6 offset:5120
    ds_read_b64_tr_b16 a[88:89], v8 offset:6144
    v_mul_f32 v33, v28, v65
    v_mul_f32 v96, v64, v96
    v_mfma_f32_32x32x16_bf16 v[144:159], a[20:23], v[196:199], v[144:159]
    ds_read_b64_tr_b16 a[4:5], v9 offset:4096
    ds_read_b64_tr_b16 a[6:7], v9 offset:5120
    ds_read_b64_tr_b16 a[90:91], v8 offset:7168
    v_exp_f32 v33, v33
    s_waitcnt lgkmcnt(7)
    v_mfma_f32_32x32x16_bf16 v[160:175], a[24:27], v[196:199], v[160:175]
    ds_read_b64_tr_b16 a[8:9], v6 offset:20480
    ds_read_b64_tr_b16 a[10:11], v6 offset:21504
    ds_read_b64_tr_b16 a[92:93], v11 offset:6144
    v_mul_f32 v34, v28, v66
    v_fma_f32 v32, v32, v29, v29
    v_mul_f32 v97, v65, v97
    v_mfma_f32_32x32x16_bf16 v[176:191], a[28:31], v[196:199], v[176:191]
    ds_read_b64_tr_b16 a[12:13], v9 offset:20480
    ds_read_b64_tr_b16 a[14:15], v9 offset:21504
    ds_read_b64_tr_b16 a[94:95], v11 offset:7168
    v_exp_f32 v34, v34
    s_waitcnt lgkmcnt(7)
    v_mfma_f32_32x32x16_bf16 v[128:143], a[0:3], v[200:203], v[128:143]
    ds_read_b64_tr_b16 a[16:17], v6 offset:6144
    ds_read_b64_tr_b16 a[18:19], v6 offset:7168
    s_waitcnt lgkmcnt(2)
    s_add_u32 m0, s48, 4096
    s_add_u32 s76, s76, 32768
    v_mul_f32 v35, v28, v67
    v_fma_f32 v33, v33, v29, v29
    v_mfma_f32_32x32x16_bf16 v[144:159], a[4:7], v[200:203], v[144:159]
    buffer_load_dwordx4 v56, s[56:59], s76 offen offset:0 lds
    ds_read_b64_tr_b16 a[20:21], v9 offset:6144
    ds_read_b64_tr_b16 a[22:23], v9 offset:7168
    v_rcp_f32 v32, v32
    v_mfma_f32_32x32x16_bf16 v[160:175], a[8:11], v[200:203], v[160:175]
    buffer_load_dwordx4 v57, s[56:59], s76 offen offset:1024 lds
    ds_read_b64_tr_b16 a[24:25], v6 offset:22528
    ds_read_b64_tr_b16 a[26:27], v6 offset:23552
    v_mul_f32 v98, v66, v98
    v_mfma_f32_32x32x16_bf16 v[176:191], a[12:15], v[200:203], v[176:191]
    buffer_load_dwordx4 v58, s[56:59], s76 offen offset:2048 lds
    ds_read_b64_tr_b16 a[28:29], v9 offset:22528
    ds_read_b64_tr_b16 a[30:31], v9 offset:23552
    v_exp_f32 v35, v35
    s_waitcnt lgkmcnt(4)
    v_mfma_f32_32x32x16_bf16 v[128:143], a[16:19], v[204:207], v[128:143]
    buffer_load_dwordx4 v59, s[56:59], s76 offen offset:3072 lds
    ds_read_b64_tr_b16 a[0:1], v6 offset:8192
    ds_read_b64_tr_b16 a[2:3], v6 offset:9216
    s_add_u32 m0, s33, 65536
    s_add_u32 s34, s39, s70
    v_mul_f32 v36, v28, v68
    v_fma_f32 v34, v34, v29, v29
    v_mfma_f32_32x32x16_bf16 v[144:159], a[20:23], v[204:207], v[144:159]
    buffer_load_dwordx4 v20, s[16:19], s34 offen offset:0 lds
    ds_read_b64_tr_b16 a[4:5], v9 offset:8192
    ds_read_b64_tr_b16 a[6:7], v9 offset:9216
    v_rcp_f32 v33, v33
    s_waitcnt lgkmcnt(4)
    v_mfma_f32_32x32x16_bf16 v[160:175], a[24:27], v[204:207], v[160:175]
    buffer_load_dwordx4 v21, s[16:19], s34 offen offset:1024 lds
    ds_read_b64_tr_b16 a[8:9], v6 offset:24576
    ds_read_b64_tr_b16 a[10:11], v6 offset:25600
    v_mul_f32 v99, v67, v99
    v_mul_f32 v96, v32, v96
    v_mfma_f32_32x32x16_bf16 v[176:191], a[28:31], v[204:207], v[176:191]
    buffer_load_dwordx4 v22, s[16:19], s34 offen offset:2048 lds
    ds_read_b64_tr_b16 a[12:13], v9 offset:24576
    ds_read_b64_tr_b16 a[14:15], v9 offset:25600
    v_exp_f32 v36, v36
    s_waitcnt lgkmcnt(4)
    v_mfma_f32_32x32x16_bf16 v[128:143], a[0:3], v[208:211], v[128:143]
    buffer_load_dwordx4 v23, s[16:19], s34 offen offset:3072 lds
    ds_read_b64_tr_b16 a[16:17], v6 offset:10240
    ds_read_b64_tr_b16 a[18:19], v6 offset:11264
    s_add_u32 m0, s33, 69632
    s_add_u32 s34, s34, 114688
    v_mul_f32 v37, v28, v69
    v_fma_f32 v35, v35, v29, v29
    v_mfma_f32_32x32x16_bf16 v[144:159], a[4:7], v[208:211], v[144:159]
    buffer_load_dwordx4 v20, s[16:19], s34 offen offset:0 lds
    ds_read_b64_tr_b16 a[20:21], v9 offset:10240
    ds_read_b64_tr_b16 a[22:23], v9 offset:11264
    v_rcp_f32 v34, v34
    s_waitcnt lgkmcnt(4)
    v_mfma_f32_32x32x16_bf16 v[160:175], a[8:11], v[208:211], v[160:175]
    buffer_load_dwordx4 v21, s[16:19], s34 offen offset:1024 lds
    ds_read_b64_tr_b16 a[24:25], v6 offset:26624
    ds_read_b64_tr_b16 a[26:27], v6 offset:27648
    v_mul_f32 v100, v68, v100
    v_mul_f32 v97, v33, v97
    v_mfma_f32_32x32x16_bf16 v[176:191], a[12:15], v[208:211], v[176:191]
    buffer_load_dwordx4 v22, s[16:19], s34 offen offset:2048 lds
    ds_read_b64_tr_b16 a[28:29], v9 offset:26624
    ds_read_b64_tr_b16 a[30:31], v9 offset:27648
    v_exp_f32 v37, v37
    s_waitcnt lgkmcnt(4)
    v_mfma_f32_32x32x16_bf16 v[128:143], a[16:19], v[212:215], v[128:143]
    buffer_load_dwordx4 v23, s[16:19], s34 offen offset:3072 lds
    ds_read_b64_tr_b16 a[0:1], v6 offset:12288
    ds_read_b64_tr_b16 a[2:3], v6 offset:13312
    s_waitcnt vmcnt(12)
    ds_read_b64_tr_b16 a[96:97], v8 offset:0
    v_mul_f32 v32, v28, v70
    v_fma_f32 v36, v36, v29, v29
    v_mfma_f32_32x32x16_bf16 v[144:159], a[20:23], v[212:215], v[144:159]
    ds_read_b64_tr_b16 a[4:5], v9 offset:12288
    ds_read_b64_tr_b16 a[6:7], v9 offset:13312
    ds_read_b64_tr_b16 a[98:99], v8 offset:1024
    v_rcp_f32 v35, v35
    v_mul_f32 v101, v69, v101
    s_waitcnt lgkmcnt(6)
    v_mfma_f32_32x32x16_bf16 v[160:175], a[24:27], v[212:215], v[160:175]
    ds_read_b64_tr_b16 a[8:9], v6 offset:28672
    ds_read_b64_tr_b16 a[10:11], v6 offset:29696
    ds_read_b64_tr_b16 a[100:101], v11 offset:0
    v_mul_f32 v98, v34, v98
    v_cvt_pk_bf16_f32 v40, v96, v97
    v_mfma_f32_32x32x16_bf16 v[176:191], a[28:31], v[212:215], v[176:191]
    ds_read_b64_tr_b16 a[12:13], v9 offset:28672
    ds_read_b64_tr_b16 a[14:15], v9 offset:29696
    ds_read_b64_tr_b16 a[102:103], v11 offset:1024
    v_exp_f32 v32, v32
    v_mul_f32 v33, v28, v71
    s_waitcnt lgkmcnt(7)
    v_mfma_f32_32x32x16_bf16 v[128:143], a[0:3], v[216:219], v[128:143]
    ds_read_b64_tr_b16 a[16:17], v6 offset:14336
    ds_read_b64_tr_b16 a[18:19], v6 offset:15360
    ds_read_b64_tr_b16 a[104:105], v8 offset:2048
    v_fma_f32 v37, v37, v29, v29
    v_rcp_f32 v36, v36
    v_mfma_f32_32x32x16_bf16 v[144:159], a[4:7], v[216:219], v[144:159]
    ds_read_b64_tr_b16 a[20:21], v9 offset:14336
    ds_read_b64_tr_b16 a[22:23], v9 offset:15360
    ds_read_b64_tr_b16 a[106:107], v8 offset:3072
    v_mul_f32 v102, v70, v102
    v_mul_f32 v99, v35, v99
    s_waitcnt lgkmcnt(7)
    v_mfma_f32_32x32x16_bf16 v[160:175], a[8:11], v[216:219], v[160:175]
    ds_read_b64_tr_b16 a[24:25], v6 offset:30720
    ds_read_b64_tr_b16 a[26:27], v6 offset:31744
    ds_read_b64_tr_b16 a[108:109], v11 offset:2048
    v_exp_f32 v33, v33
    v_mul_f32 v34, v28, v72
    v_mfma_f32_32x32x16_bf16 v[176:191], a[12:15], v[216:219], v[176:191]
    ds_read_b64_tr_b16 a[28:29], v9 offset:30720
    ds_read_b64_tr_b16 a[30:31], v9 offset:31744
    ds_read_b64_tr_b16 a[110:111], v11 offset:3072
    s_waitcnt lgkmcnt(0)
    s_add_u32 m0, s48, 0
    s_bfe_u32 s76, s75, 0x80018
    s_lshl_b32 s76, s76, 14
    s_add_u32 s76, s76, s74
    v_fma_f32 v32, v32, v29, v29
    s_barrier
    v_mfma_f32_32x32x16_bf16 v[128:143], a[16:19], v[220:223], v[128:143]
    buffer_load_dwordx4 v56, s[56:59], s76 offen offset:0 lds
    ds_read_b64_tr_b16 a[0:1], v6 offset:32768
    ds_read_b64_tr_b16 a[2:3], v6 offset:33792
    v_rcp_f32 v37, v37
    v_mfma_f32_32x32x16_bf16 v[144:159], a[20:23], v[220:223], v[144:159]
    buffer_load_dwordx4 v57, s[56:59], s76 offen offset:1024 lds
    ds_read_b64_tr_b16 a[4:5], v9 offset:32768
    ds_read_b64_tr_b16 a[6:7], v9 offset:33792
    v_mul_f32 v103, v71, v103
    v_mul_f32 v100, v36, v100
    v_mfma_f32_32x32x16_bf16 v[160:175], a[24:27], v[220:223], v[160:175]
    buffer_load_dwordx4 v58, s[56:59], s76 offen offset:2048 lds
    ds_read_b64_tr_b16 a[8:9], v6 offset:49152
    ds_read_b64_tr_b16 a[10:11], v6 offset:50176
    v_cvt_pk_bf16_f32 v41, v98, v99
    v_mfma_f32_32x32x16_bf16 v[176:191], a[28:31], v[220:223], v[176:191]
    buffer_load_dwordx4 v59, s[56:59], s76 offen offset:3072 lds
    ds_read_b64_tr_b16 a[12:13], v9 offset:49152
    ds_read_b64_tr_b16 a[14:15], v9 offset:50176
    v_exp_f32 v34, v34
    v_mul_f32 v35, v28, v73
    s_waitcnt lgkmcnt(4)
    v_mfma_f32_32x32x16_bf16 v[128:143], a[0:3], v[224:227], v[128:143]
    ds_read_b64_tr_b16 a[16:17], v6 offset:34816
    ds_read_b64_tr_b16 a[18:19], v6 offset:35840
    s_waitcnt vmcnt(12)
    ds_read_b64_tr_b16 a[112:113], v8 offset:4096
    v_fma_f32 v33, v33, v29, v29
    v_rcp_f32 v32, v32
    v_mfma_f32_32x32x16_bf16 v[144:159], a[4:7], v[224:227], v[144:159]
    ds_read_b64_tr_b16 a[20:21], v9 offset:34816
    ds_read_b64_tr_b16 a[22:23], v9 offset:35840
    ds_read_b64_tr_b16 a[114:115], v8 offset:5120
    v_mul_f32 v104, v72, v104
    v_mul_f32 v101, v37, v101
    s_waitcnt lgkmcnt(6)
    v_mfma_f32_32x32x16_bf16 v[160:175], a[8:11], v[224:227], v[160:175]
    ds_read_b64_tr_b16 a[24:25], v6 offset:51200
    ds_read_b64_tr_b16 a[26:27], v6 offset:52224
    ds_read_b64_tr_b16 a[116:117], v11 offset:4096
    v_exp_f32 v35, v35
    v_mul_f32 v36, v28, v74
    v_mfma_f32_32x32x16_bf16 v[176:191], a[12:15], v[224:227], v[176:191]
    ds_read_b64_tr_b16 a[28:29], v9 offset:51200
    ds_read_b64_tr_b16 a[30:31], v9 offset:52224
    ds_read_b64_tr_b16 a[118:119], v11 offset:5120
    v_fma_f32 v34, v34, v29, v29
    v_rcp_f32 v33, v33
    s_waitcnt lgkmcnt(7)
    v_mfma_f32_32x32x16_bf16 v[128:143], a[16:19], v[228:231], v[128:143]
    ds_read_b64_tr_b16 a[0:1], v6 offset:36864
    ds_read_b64_tr_b16 a[2:3], v6 offset:37888
    ds_read_b64_tr_b16 a[120:121], v8 offset:6144
    v_mul_f32 v105, v73, v105
    v_mul_f32 v102, v32, v102
    v_cvt_pk_bf16_f32 v42, v100, v101
    v_mfma_f32_32x32x16_bf16 v[144:159], a[20:23], v[228:231], v[144:159]
    ds_read_b64_tr_b16 a[4:5], v9 offset:36864
    ds_read_b64_tr_b16 a[6:7], v9 offset:37888
    ds_read_b64_tr_b16 a[122:123], v8 offset:7168
    v_exp_f32 v36, v36
    v_mul_f32 v37, v28, v75
    s_waitcnt lgkmcnt(7)
    v_mfma_f32_32x32x16_bf16 v[160:175], a[24:27], v[228:231], v[160:175]
    ds_read_b64_tr_b16 a[8:9], v6 offset:53248
    ds_read_b64_tr_b16 a[10:11], v6 offset:54272
    ds_read_b64_tr_b16 a[124:125], v11 offset:6144
    v_fma_f32 v35, v35, v29, v29
    v_rcp_f32 v34, v34
    v_mfma_f32_32x32x16_bf16 v[176:191], a[28:31], v[228:231], v[176:191]
    ds_read_b64_tr_b16 a[12:13], v9 offset:53248
    ds_read_b64_tr_b16 a[14:15], v9 offset:54272
    ds_read_b64_tr_b16 a[126:127], v11 offset:7168
    v_mul_f32 v106, v74, v106
    v_mul_f32 v103, v33, v103
    s_waitcnt lgkmcnt(7)
    v_mfma_f32_32x32x16_bf16 v[128:143], a[0:3], v[232:235], v[128:143]
    ds_read_b64_tr_b16 a[16:17], v6 offset:38912
    ds_read_b64_tr_b16 a[18:19], v6 offset:39936
    s_waitcnt lgkmcnt(2)
    s_add_u32 m0, s48, 4096
    s_add_u32 s76, s76, 32768
    v_exp_f32 v37, v37
    v_mul_f32 v32, v28, v76
    v_mfma_f32_32x32x16_bf16 v[144:159], a[4:7], v[232:235], v[144:159]
    buffer_load_dwordx4 v56, s[56:59], s76 offen offset:0 lds
    ds_read_b64_tr_b16 a[20:21], v9 offset:38912
    ds_read_b64_tr_b16 a[22:23], v9 offset:39936
    v_fma_f32 v36, v36, v29, v29
    v_mfma_f32_32x32x16_bf16 v[160:175], a[8:11], v[232:235], v[160:175]
    buffer_load_dwordx4 v57, s[56:59], s76 offen offset:1024 lds
    ds_read_b64_tr_b16 a[24:25], v6 offset:55296
    ds_read_b64_tr_b16 a[26:27], v6 offset:56320
    v_rcp_f32 v35, v35
    v_mfma_f32_32x32x16_bf16 v[176:191], a[12:15], v[232:235], v[176:191]
    buffer_load_dwordx4 v58, s[56:59], s76 offen offset:2048 lds
    ds_read_b64_tr_b16 a[28:29], v9 offset:55296
    ds_read_b64_tr_b16 a[30:31], v9 offset:56320
    v_mul_f32 v107, v75, v107
    v_mul_f32 v104, v34, v104
    s_waitcnt lgkmcnt(4)
    v_mfma_f32_32x32x16_bf16 v[128:143], a[16:19], v[236:239], v[128:143]
    buffer_load_dwordx4 v59, s[56:59], s76 offen offset:3072 lds
    ds_read_b64_tr_b16 a[0:1], v6 offset:40960
    ds_read_b64_tr_b16 a[2:3], v6 offset:41984
    s_add_u32 m0, s33, 98304
    s_add_u32 s34, s39, s71
    v_cvt_pk_bf16_f32 v43, v102, v103
    v_mfma_f32_32x32x16_bf16 v[144:159], a[20:23], v[236:239], v[144:159]
    buffer_load_dwordx4 v20, s[16:19], s34 offen offset:0 lds
    ds_read_b64_tr_b16 a[4:5], v9 offset:40960
    ds_read_b64_tr_b16 a[6:7], v9 offset:41984
    v_exp_f32 v32, v32
    v_mul_f32 v33, v28, v77
    s_waitcnt lgkmcnt(4)
    v_mfma_f32_32x32x16_bf16 v[160:175], a[24:27], v[236:239], v[160:175]
    buffer_store_dwordx4 v[40:43], v2, s[20:23], s41 offen offset:0 sc1
    ds_read_b64_tr_b16 a[8:9], v6 offset:57344
    ds_read_b64_tr_b16 a[10:11], v6 offset:58368
    v_fma_f32 v37, v37, v29, v29
    v_mfma_f32_32x32x16_bf16 v[176:191], a[28:31], v[236:239], v[176:191]
    buffer_load_dwordx4 v21, s[16:19], s34 offen offset:1024 lds
    ds_read_b64_tr_b16 a[12:13], v9 offset:57344
    ds_read_b64_tr_b16 a[14:15], v9 offset:58368
    v_rcp_f32 v36, v36
    s_waitcnt lgkmcnt(4)
    v_mfma_f32_32x32x16_bf16 v[128:143], a[0:3], v[240:243], v[128:143]
    buffer_load_dwordx4 v22, s[16:19], s34 offen offset:2048 lds
    ds_read_b64_tr_b16 a[16:17], v6 offset:43008
    ds_read_b64_tr_b16 a[18:19], v6 offset:44032
    v_mul_f32 v108, v76, v108
    v_mul_f32 v105, v35, v105
    v_mfma_f32_32x32x16_bf16 v[144:159], a[4:7], v[240:243], v[144:159]
    buffer_load_dwordx4 v23, s[16:19], s34 offen offset:3072 lds
    ds_read_b64_tr_b16 a[20:21], v9 offset:43008
    ds_read_b64_tr_b16 a[22:23], v9 offset:44032
    s_add_u32 m0, s33, 102400
    s_add_u32 s34, s34, 114688
    v_exp_f32 v33, v33
    s_waitcnt lgkmcnt(4)
    v_mfma_f32_32x32x16_bf16 v[160:175], a[8:11], v[240:243], v[160:175]
    buffer_load_dwordx4 v20, s[16:19], s34 offen offset:0 lds
    ds_read_b64_tr_b16 a[24:25], v6 offset:59392
    ds_read_b64_tr_b16 a[26:27], v6 offset:60416
    v_mul_f32 v34, v28, v78
    v_fma_f32 v32, v32, v29, v29
    v_mfma_f32_32x32x16_bf16 v[176:191], a[12:15], v[240:243], v[176:191]
    buffer_load_dwordx4 v21, s[16:19], s34 offen offset:1024 lds
    ds_read_b64_tr_b16 a[28:29], v9 offset:59392
    ds_read_b64_tr_b16 a[30:31], v9 offset:60416
    v_rcp_f32 v37, v37
    s_waitcnt lgkmcnt(4)
    v_mfma_f32_32x32x16_bf16 v[128:143], a[16:19], v[244:247], v[128:143]
    buffer_load_dwordx4 v22, s[16:19], s34 offen offset:2048 lds
    ds_read_b64_tr_b16 a[0:1], v6 offset:45056
    ds_read_b64_tr_b16 a[2:3], v6 offset:46080
    v_mul_f32 v109, v77, v109
    v_mul_f32 v106, v36, v106
    v_mfma_f32_32x32x16_bf16 v[144:159], a[20:23], v[244:247], v[144:159]
    buffer_load_dwordx4 v23, s[16:19], s34 offen offset:3072 lds
    ds_read_b64_tr_b16 a[4:5], v9 offset:45056
    ds_read_b64_tr_b16 a[6:7], v9 offset:46080
    s_waitcnt vmcnt(13)
    ds_read_b64_tr_b16 a[128:129], v8 offset:0
    v_cvt_pk_bf16_f32 v44, v104, v105
    s_waitcnt lgkmcnt(5)
    v_mfma_f32_32x32x16_bf16 v[160:175], a[24:27], v[244:247], v[160:175]
    ds_read_b64_tr_b16 a[8:9], v6 offset:61440
    ds_read_b64_tr_b16 a[10:11], v6 offset:62464
    ds_read_b64_tr_b16 a[130:131], v8 offset:1024
    v_exp_f32 v34, v34
    v_mul_f32 v35, v28, v79
    v_mfma_f32_32x32x16_bf16 v[176:191], a[28:31], v[244:247], v[176:191]
    ds_read_b64_tr_b16 a[12:13], v9 offset:61440
    ds_read_b64_tr_b16 a[14:15], v9 offset:62464
    ds_read_b64_tr_b16 a[132:133], v11 offset:0
    v_fma_f32 v33, v33, v29, v29
    v_rcp_f32 v32, v32
    s_waitcnt lgkmcnt(7)
    v_mfma_f32_32x32x16_bf16 v[128:143], a[0:3], v[248:251], v[128:143]
    ds_read_b64_tr_b16 a[16:17], v6 offset:47104
    ds_read_b64_tr_b16 a[18:19], v6 offset:48128
    ds_read_b64_tr_b16 a[134:135], v11 offset:1024
    v_mul_f32 v110, v78, v110
    v_mul_f32 v107, v37, v107
    v_mfma_f32_32x32x16_bf16 v[144:159], a[4:7], v[248:251], v[144:159]
    ds_read_b64_tr_b16 a[20:21], v9 offset:47104
    ds_read_b64_tr_b16 a[22:23], v9 offset:48128
    ds_read_b64_tr_b16 a[136:137], v8 offset:2048
    v_exp_f32 v35, v35
    v_mul_f32 v36, v28, v80
    s_waitcnt lgkmcnt(7)
    v_mfma_f32_32x32x16_bf16 v[160:175], a[8:11], v[248:251], v[160:175]
    ds_read_b64_tr_b16 a[24:25], v6 offset:63488
    ds_read_b64_tr_b16 a[26:27], v6 offset:64512
    ds_read_b64_tr_b16 a[138:139], v8 offset:3072
    v_fma_f32 v34, v34, v29, v29
    v_rcp_f32 v33, v33
    v_mfma_f32_32x32x16_bf16 v[176:191], a[12:15], v[248:251], v[176:191]
    ds_read_b64_tr_b16 a[28:29], v9 offset:63488
    ds_read_b64_tr_b16 a[30:31], v9 offset:64512
    ds_read_b64_tr_b16 a[140:141], v11 offset:2048
    v_mul_f32 v111, v79, v111
    v_mul_f32 v108, v32, v108
    v_cvt_pk_bf16_f32 v45, v106, v107
    s_barrier
    s_waitcnt lgkmcnt(7)
    v_mfma_f32_32x32x16_bf16 v[128:143], a[16:19], v[252:255], v[128:143]
    ds_read_b64_tr_b16 a[0:1], v7 offset:0
    ds_read_b64_tr_b16 a[2:3], v7 offset:1024
    ds_read_b64_tr_b16 a[142:143], v11 offset:3072
    s_waitcnt lgkmcnt(0)
    s_add_u32 m0, s48, 0
    s_bfe_u32 s76, s49, 0x80000
    s_lshl_b32 s76, s76, 14
    s_add_u32 s76, s76, s74
    v_exp_f32 v36, v36
    v_mfma_f32_32x32x16_bf16 v[144:159], a[20:23], v[252:255], v[144:159]
    buffer_load_dwordx4 v56, s[56:59], s76 offen offset:0 lds
    ds_read_b64_tr_b16 a[4:5], v10 offset:0
    ds_read_b64_tr_b16 a[6:7], v10 offset:1024
    v_mul_f32 v37, v28, v81
    v_fma_f32 v35, v35, v29, v29
    v_mfma_f32_32x32x16_bf16 v[160:175], a[24:27], v[252:255], v[160:175]
    buffer_load_dwordx4 v57, s[56:59], s76 offen offset:1024 lds
    ds_read_b64_tr_b16 a[8:9], v7 offset:16384
    ds_read_b64_tr_b16 a[10:11], v7 offset:17408
    v_rcp_f32 v34, v34
    v_mfma_f32_32x32x16_bf16 v[176:191], a[28:31], v[252:255], v[176:191]
    buffer_load_dwordx4 v58, s[56:59], s76 offen offset:2048 lds
    ds_read_b64_tr_b16 a[12:13], v10 offset:16384
    ds_read_b64_tr_b16 a[14:15], v10 offset:17408
    v_mul_f32 v112, v80, v112
    v_mul_f32 v109, v33, v109
    s_waitcnt lgkmcnt(4)
    v_mfma_f32_32x32x16_bf16 v[128:143], a[0:3], a[192:195], v[128:143]
    buffer_load_dwordx4 v59, s[56:59], s76 offen offset:3072 lds
    ds_read_b64_tr_b16 a[16:17], v7 offset:2048
    ds_read_b64_tr_b16 a[18:19], v7 offset:3072
    s_waitcnt vmcnt(13)
    ds_read_b64_tr_b16 a[144:145], v8 offset:4096
    v_exp_f32 v37, v37
    v_mfma_f32_32x32x16_bf16 v[144:159], a[4:7], a[192:195], v[144:159]
    ds_read_b64_tr_b16 a[20:21], v10 offset:2048
    ds_read_b64_tr_b16 a[22:23], v10 offset:3072
    v_mul_f32 v32, v28, v82
    v_fma_f32 v36, v36, v29, v29
    v_rcp_f32 v35, v35
    s_waitcnt lgkmcnt(5)
    v_mfma_f32_32x32x16_bf16 v[160:175], a[8:11], a[192:195], v[160:175]
    ds_read_b64_tr_b16 a[24:25], v7 offset:18432
    ds_read_b64_tr_b16 a[26:27], v7 offset:19456
    ds_read_b64_tr_b16 a[146:147], v8 offset:5120
    v_mul_f32 v113, v81, v113
    v_mul_f32 v110, v34, v110
    v_cvt_pk_bf16_f32 v46, v108, v109
    v_mfma_f32_32x32x16_bf16 v[176:191], a[12:15], a[192:195], v[176:191]
    ds_read_b64_tr_b16 a[28:29], v10 offset:18432
    ds_read_b64_tr_b16 a[30:31], v10 offset:19456
    ds_read_b64_tr_b16 a[148:149], v11 offset:4096
    v_exp_f32 v32, v32
    v_mul_f32 v33, v28, v83
    s_waitcnt lgkmcnt(6)
    v_mfma_f32_32x32x16_bf16 v[128:143], a[16:19], a[196:199], v[128:143]
    ds_read_b64_tr_b16 a[0:1], v7 offset:4096
    ds_read_b64_tr_b16 a[2:3], v7 offset:5120
    v_fma_f32 v37, v37, v29, v29
    v_rcp_f32 v36, v36
    v_mfma_f32_32x32x16_bf16 v[144:159], a[20:23], a[196:199], v[144:159]
    ds_read_b64_tr_b16 a[4:5], v10 offset:4096
    ds_read_b64_tr_b16 a[6:7], v10 offset:5120
    ds_read_b64_tr_b16 a[150:151], v11 offset:5120
    v_mul_f32 v114, v82, v114
    v_mul_f32 v111, v35, v111
    s_waitcnt lgkmcnt(6)
    v_mfma_f32_32x32x16_bf16 v[160:175], a[24:27], a[196:199], v[160:175]
    ds_read_b64_tr_b16 a[8:9], v7 offset:20480
    ds_read_b64_tr_b16 a[10:11], v7 offset:21504
    ds_read_b64_tr_b16 a[152:153], v8 offset:6144
    v_exp_f32 v33, v33
    v_mul_f32 v34, v28, v84
    v_mfma_f32_32x32x16_bf16 v[176:191], a[28:31], a[196:199], v[176:191]
    ds_read_b64_tr_b16 a[12:13], v10 offset:20480
    ds_read_b64_tr_b16 a[14:15], v10 offset:21504
    v_fma_f32 v32, v32, v29, v29
    v_rcp_f32 v37, v37
    s_waitcnt lgkmcnt(6)
    v_mfma_f32_32x32x16_bf16 v[128:143], a[0:3], a[200:203], v[128:143]
    ds_read_b64_tr_b16 a[16:17], v7 offset:6144
    ds_read_b64_tr_b16 a[18:19], v7 offset:7168
    ds_read_b64_tr_b16 a[154:155], v8 offset:7168
    v_mul_f32 v115, v83, v115
    v_mfma_f32_32x32x16_bf16 v[144:159], a[4:7], a[200:203], v[144:159]
    ds_read_b64_tr_b16 a[20:21], v10 offset:6144
    ds_read_b64_tr_b16 a[22:23], v10 offset:7168
    ds_read_b64_tr_b16 a[156:157], v11 offset:6144
    v_mul_f32 v112, v36, v112
    v_cvt_pk_bf16_f32 v47, v110, v111
    s_waitcnt lgkmcnt(6)
    v_mfma_f32_32x32x16_bf16 v[160:175], a[8:11], a[200:203], v[160:175]
    ds_read_b64_tr_b16 a[24:25], v7 offset:22528
    ds_read_b64_tr_b16 a[26:27], v7 offset:23552
    v_exp_f32 v34, v34
    v_mfma_f32_32x32x16_bf16 v[176:191], a[12:15], a[200:203], v[176:191]
    buffer_store_dwordx4 v[44:47], v2, s[20:23], s41 offen offset:1024 sc1
    ds_read_b64_tr_b16 a[28:29], v10 offset:22528
    ds_read_b64_tr_b16 a[30:31], v10 offset:23552
    ds_read_b64_tr_b16 a[158:159], v11 offset:7168
    v_mul_f32 v35, v28, v85
    s_waitcnt lgkmcnt(6)
    v_mfma_f32_32x32x16_bf16 v[128:143], a[16:19], a[204:207], v[128:143]
    ds_read_b64_tr_b16 a[0:1], v7 offset:8192
    ds_read_b64_tr_b16 a[2:3], v7 offset:9216
    s_waitcnt lgkmcnt(2)
    s_add_u32 m0, s48, 4096
    s_add_u32 s76, s76, 32768
    v_fma_f32 v33, v33, v29, v29
    v_rcp_f32 v32, v32
    v_mfma_f32_32x32x16_bf16 v[144:159], a[20:23], a[204:207], v[144:159]
    buffer_load_dwordx4 v56, s[56:59], s76 offen offset:0 lds
    ds_read_b64_tr_b16 a[4:5], v10 offset:8192
    ds_read_b64_tr_b16 a[6:7], v10 offset:9216
    v_mul_f32 v116, v84, v116
    v_mul_f32 v113, v37, v113
    v_mfma_f32_32x32x16_bf16 v[160:175], a[24:27], a[204:207], v[160:175]
    ds_read_b64_tr_b16 a[8:9], v7 offset:24576
    ds_read_b64_tr_b16 a[10:11], v7 offset:25600
    v_exp_f32 v35, v35
    v_mfma_f32_32x32x16_bf16 v[176:191], a[28:31], a[204:207], v[176:191]
    buffer_load_dwordx4 v57, s[56:59], s76 offen offset:1024 lds
    ds_read_b64_tr_b16 a[12:13], v10 offset:24576
    ds_read_b64_tr_b16 a[14:15], v10 offset:25600
    v_mul_f32 v36, v28, v86
    v_fma_f32 v34, v34, v29, v29
    s_waitcnt lgkmcnt(4)
    v_mfma_f32_32x32x16_bf16 v[128:143], a[0:3], a[208:211], v[128:143]
    buffer_load_dwordx4 v58, s[56:59], s76 offen offset:2048 lds
    ds_read_b64_tr_b16 a[16:17], v7 offset:10240
    ds_read_b64_tr_b16 a[18:19], v7 offset:11264
    v_rcp_f32 v33, v33
    v_mfma_f32_32x32x16_bf16 v[144:159], a[4:7], a[208:211], v[144:159]
    buffer_load_dwordx4 v59, s[56:59], s76 offen offset:3072 lds
    ds_read_b64_tr_b16 a[20:21], v10 offset:10240
    ds_read_b64_tr_b16 a[22:23], v10 offset:11264
    v_mul_f32 v117, v85, v117
    v_mul_f32 v114, v32, v114
    v_cvt_pk_bf16_f32 v40, v112, v113
    s_waitcnt lgkmcnt(4)
    v_mfma_f32_32x32x16_bf16 v[160:175], a[8:11], a[208:211], v[160:175]
    ds_read_b64_tr_b16 a[24:25], v7 offset:26624
    ds_read_b64_tr_b16 a[26:27], v7 offset:27648
    s_add_u32 m0, s33, 0
    s_add_u32 s34, s40, s72
    v_exp_f32 v36, v36
    v_mfma_f32_32x32x16_bf16 v[176:191], a[12:15], a[208:211], v[176:191]
    buffer_load_dwordx4 v16, s[16:19], s34 offen offset:0 lds
    ds_read_b64_tr_b16 a[28:29], v10 offset:26624
    ds_read_b64_tr_b16 a[30:31], v10 offset:27648
    v_mul_f32 v37, v28, v87
    v_fma_f32 v35, v35, v29, v29
    s_waitcnt lgkmcnt(4)
    v_mfma_f32_32x32x16_bf16 v[128:143], a[16:19], a[212:215], v[128:143]
    buffer_load_dwordx4 v17, s[16:19], s34 offen offset:1024 lds
    ds_read_b64_tr_b16 a[0:1], v7 offset:12288
    ds_read_b64_tr_b16 a[2:3], v7 offset:13312
    v_rcp_f32 v34, v34
    v_mul_f32 v118, v86, v118
    v_mfma_f32_32x32x16_bf16 v[144:159], a[20:23], a[212:215], v[144:159]
    ds_read_b64_tr_b16 a[4:5], v10 offset:12288
    ds_read_b64_tr_b16 a[6:7], v10 offset:13312
    v_mul_f32 v115, v33, v115
    v_exp_f32 v37, v37
    s_waitcnt lgkmcnt(4)
    v_mfma_f32_32x32x16_bf16 v[160:175], a[24:27], a[212:215], v[160:175]
    buffer_load_dwordx4 v18, s[16:19], s34 offen offset:2048 lds
    ds_read_b64_tr_b16 a[8:9], v7 offset:28672
    ds_read_b64_tr_b16 a[10:11], v7 offset:29696
    v_mul_f32 v32, v28, v88
    v_mfma_f32_32x32x16_bf16 v[176:191], a[28:31], a[212:215], v[176:191]
    buffer_load_dwordx4 v19, s[16:19], s34 offen offset:3072 lds
    ds_read_b64_tr_b16 a[12:13], v10 offset:28672
    ds_read_b64_tr_b16 a[14:15], v10 offset:29696
    v_fma_f32 v36, v36, v29, v29
    v_rcp_f32 v35, v35
    s_waitcnt lgkmcnt(4)
    v_mfma_f32_32x32x16_bf16 v[128:143], a[0:3], a[216:219], v[128:143]
    ds_read_b64_tr_b16 a[16:17], v7 offset:14336
    ds_read_b64_tr_b16 a[18:19], v7 offset:15360
    s_add_u32 m0, s33, 4096
    s_add_u32 s34, s34, 229376
    v_mul_f32 v119, v87, v119
    v_mul_f32 v116, v34, v116
    v_mfma_f32_32x32x16_bf16 v[144:159], a[4:7], a[216:219], v[144:159]
    buffer_load_dwordx4 v16, s[16:19], s34 offen offset:0 lds
    ds_read_b64_tr_b16 a[20:21], v10 offset:14336
    ds_read_b64_tr_b16 a[22:23], v10 offset:15360
    v_cvt_pk_bf16_f32 v41, v114, v115
    s_waitcnt lgkmcnt(4)
    v_mfma_f32_32x32x16_bf16 v[160:175], a[8:11], a[216:219], v[160:175]
    buffer_load_dwordx4 v17, s[16:19], s34 offen offset:1024 lds
    ds_read_b64_tr_b16 a[24:25], v7 offset:30720
    ds_read_b64_tr_b16 a[26:27], v7 offset:31744
    v_exp_f32 v32, v32
    v_mul_f32 v33, v28, v89
    v_mfma_f32_32x32x16_bf16 v[176:191], a[12:15], a[216:219], v[176:191]
    ds_read_b64_tr_b16 a[28:29], v10 offset:30720
    ds_read_b64_tr_b16 a[30:31], v10 offset:31744
    v_fma_f32 v37, v37, v29, v29
    v_rcp_f32 v36, v36
    buffer_load_dwordx4 v18, s[16:19], s34 offen offset:2048 lds
    s_waitcnt vmcnt(16)
    s_barrier
    s_waitcnt lgkmcnt(4)
    v_mfma_f32_32x32x16_bf16 v[128:143], a[16:19], a[220:223], v[128:143]
    ds_read_b64_tr_b16 a[0:1], v7 offset:32768
    ds_read_b64_tr_b16 a[2:3], v7 offset:33792
    v_mul_f32 v120, v88, v120
    v_mul_f32 v117, v35, v117
    v_mfma_f32_32x32x16_bf16 v[144:159], a[20:23], a[220:223], v[144:159]
    buffer_load_dwordx4 v19, s[16:19], s34 offen offset:3072 lds
    ds_read_b64_tr_b16 a[4:5], v10 offset:32768
    ds_read_b64_tr_b16 a[6:7], v10 offset:33792
    v_exp_f32 v33, v33
    s_waitcnt lgkmcnt(4)
    v_mfma_f32_32x32x16_bf16 v[160:175], a[24:27], a[220:223], v[160:175]
    ds_read_b64_tr_b16 a[8:9], v7 offset:49152
    ds_read_b64_tr_b16 a[10:11], v7 offset:50176
    v_mul_f32 v34, v28, v90
    v_fma_f32 v32, v32, v29, v29
    v_rcp_f32 v37, v37
    v_mfma_f32_32x32x16_bf16 v[176:191], a[28:31], a[220:223], v[176:191]
    ds_read_b64_tr_b16 a[12:13], v10 offset:49152
    ds_read_b64_tr_b16 a[14:15], v10 offset:50176
    v_mul_f32 v121, v89, v121
    s_waitcnt lgkmcnt(4)
    v_mfma_f32_32x32x16_bf16 v[128:143], a[0:3], a[224:227], v[128:143]
    ds_read_b64_tr_b16 a[16:17], v7 offset:34816
    ds_read_b64_tr_b16 a[18:19], v7 offset:35840
    s_add_u32 m0, s33, 32768
    s_add_u32 s34, s40, s73
    v_mul_f32 v118, v36, v118
    v_cvt_pk_bf16_f32 v42, v116, v117
    v_mfma_f32_32x32x16_bf16 v[144:159], a[4:7], a[224:227], v[144:159]
    buffer_load_dwordx4 v16, s[16:19], s34 offen offset:0 lds
    ds_read_b64_tr_b16 a[20:21], v10 offset:34816
    ds_read_b64_tr_b16 a[22:23], v10 offset:35840
    v_exp_f32 v34, v34
    v_mul_f32 v35, v28, v91
    s_waitcnt lgkmcnt(4)
    v_mfma_f32_32x32x16_bf16 v[160:175], a[8:11], a[224:227], v[160:175]
    ds_read_b64_tr_b16 a[24:25], v7 offset:51200
    ds_read_b64_tr_b16 a[26:27], v7 offset:52224
    v_fma_f32 v33, v33, v29, v29
    v_rcp_f32 v32, v32
    v_mfma_f32_32x32x16_bf16 v[176:191], a[12:15], a[224:227], v[176:191]
    ds_read_b64_tr_b16 a[28:29], v10 offset:51200
    ds_read_b64_tr_b16 a[30:31], v10 offset:52224
    v_mul_f32 v122, v90, v122
    s_waitcnt lgkmcnt(4)
    v_mfma_f32_32x32x16_bf16 v[128:143], a[16:19], a[228:231], v[128:143]
    ds_read_b64_tr_b16 a[0:1], v7 offset:36864
    ds_read_b64_tr_b16 a[2:3], v7 offset:37888
    v_mul_f32 v119, v37, v119
    v_exp_f32 v35, v35
    v_mfma_f32_32x32x16_bf16 v[144:159], a[20:23], a[228:231], v[144:159]
    buffer_load_dwordx4 v17, s[16:19], s34 offen offset:1024 lds
    ds_read_b64_tr_b16 a[4:5], v10 offset:36864
    ds_read_b64_tr_b16 a[6:7], v10 offset:37888
    v_mul_f32 v36, v28, v92
    v_fma_f32 v34, v34, v29, v29
    s_waitcnt lgkmcnt(4)
    v_mfma_f32_32x32x16_bf16 v[160:175], a[24:27], a[228:231], v[160:175]
    ds_read_b64_tr_b16 a[8:9], v7 offset:53248
    ds_read_b64_tr_b16 a[10:11], v7 offset:54272
    v_rcp_f32 v33, v33
    v_mfma_f32_32x32x16_bf16 v[176:191], a[28:31], a[228:231], v[176:191]
    ds_read_b64_tr_b16 a[12:13], v10 offset:53248
    ds_read_b64_tr_b16 a[14:15], v10 offset:54272
    v_mul_f32 v123, v91, v123
    v_mul_f32 v120, v32, v120
    s_waitcnt lgkmcnt(4)
    v_mfma_f32_32x32x16_bf16 v[128:143], a[0:3], a[232:235], v[128:143]
    buffer_load_dwordx4 v18, s[16:19], s34 offen offset:2048 lds
    ds_read_b64_tr_b16 a[16:17], v7 offset:38912
    ds_read_b64_tr_b16 a[18:19], v7 offset:39936
    v_cvt_pk_bf16_f32 v43, v118, v119
    v_mfma_f32_32x32x16_bf16 v[144:159], a[4:7], a[232:235], v[144:159]
    ds_read_b64_tr_b16 a[20:21], v10 offset:38912
    ds_read_b64_tr_b16 a[22:23], v10 offset:39936
    v_exp_f32 v36, v36
    s_waitcnt lgkmcnt(4)
    v_mfma_f32_32x32x16_bf16 v[160:175], a[8:11], a[232:235], v[160:175]
    buffer_store_dwordx4 v[40:43], v2, s[20:23], s41 offen offset:2048 sc1
    ds_read_b64_tr_b16 a[24:25], v7 offset:55296
    ds_read_b64_tr_b16 a[26:27], v7 offset:56320
    v_mul_f32 v37, v28, v93
    v_fma_f32 v35, v35, v29, v29
    v_mfma_f32_32x32x16_bf16 v[176:191], a[12:15], a[232:235], v[176:191]
    buffer_load_dwordx4 v19, s[16:19], s34 offen offset:3072 lds
    ds_read_b64_tr_b16 a[28:29], v10 offset:55296
    ds_read_b64_tr_b16 a[30:31], v10 offset:56320
    v_rcp_f32 v34, v34
    s_waitcnt lgkmcnt(4)
    v_mfma_f32_32x32x16_bf16 v[128:143], a[16:19], a[236:239], v[128:143]
    ds_read_b64_tr_b16 a[0:1], v7 offset:40960
    ds_read_b64_tr_b16 a[2:3], v7 offset:41984
    v_mul_f32 v124, v92, v124
    v_mul_f32 v121, v33, v121
    v_exp_f32 v37, v37
    v_mfma_f32_32x32x16_bf16 v[144:159], a[20:23], a[236:239], v[144:159]
    ds_read_b64_tr_b16 a[4:5], v10 offset:40960
    ds_read_b64_tr_b16 a[6:7], v10 offset:41984
    s_add_u32 m0, s33, 36864
    s_add_u32 s34, s34, 229376
    v_mul_f32 v32, v28, v94
    s_waitcnt lgkmcnt(4)
    v_mfma_f32_32x32x16_bf16 v[160:175], a[24:27], a[236:239], v[160:175]
    buffer_load_dwordx4 v16, s[16:19], s34 offen offset:0 lds
    ds_read_b64_tr_b16 a[8:9], v7 offset:57344
    ds_read_b64_tr_b16 a[10:11], v7 offset:58368
    v_fma_f32 v36, v36, v29, v29
    v_rcp_f32 v35, v35
    v_mfma_f32_32x32x16_bf16 v[176:191], a[28:31], a[236:239], v[176:191]
    ds_read_b64_tr_b16 a[12:13], v10 offset:57344
    ds_read_b64_tr_b16 a[14:15], v10 offset:58368
    v_mul_f32 v125, v93, v125
    v_mul_f32 v122, v34, v122
    s_waitcnt lgkmcnt(4)
    v_mfma_f32_32x32x16_bf16 v[128:143], a[0:3], a[240:243], v[128:143]
    ds_read_b64_tr_b16 a[16:17], v7 offset:43008
    ds_read_b64_tr_b16 a[18:19], v7 offset:44032
    v_cvt_pk_bf16_f32 v44, v120, v121
    v_exp_f32 v32, v32
    v_mfma_f32_32x32x16_bf16 v[144:159], a[4:7], a[240:243], v[144:159]
    ds_read_b64_tr_b16 a[20:21], v10 offset:43008
    ds_read_b64_tr_b16 a[22:23], v10 offset:44032
    v_mul_f32 v33, v28, v95
    s_waitcnt lgkmcnt(4)
    v_mfma_f32_32x32x16_bf16 v[160:175], a[8:11], a[240:243], v[160:175]
    buffer_load_dwordx4 v17, s[16:19], s34 offen offset:1024 lds
    ds_read_b64_tr_b16 a[24:25], v7 offset:59392
    ds_read_b64_tr_b16 a[26:27], v7 offset:60416
    v_fma_f32 v37, v37, v29, v29
    v_rcp_f32 v36, v36
    v_mfma_f32_32x32x16_bf16 v[176:191], a[12:15], a[240:243], v[176:191]
    ds_read_b64_tr_b16 a[28:29], v10 offset:59392
    ds_read_b64_tr_b16 a[30:31], v10 offset:60416
    v_mul_f32 v126, v94, v126
    v_mul_f32 v123, v35, v123
    s_waitcnt lgkmcnt(4)
    v_mfma_f32_32x32x16_bf16 v[128:143], a[16:19], a[244:247], v[128:143]
    ds_read_b64_tr_b16 a[0:1], v7 offset:45056
    ds_read_b64_tr_b16 a[2:3], v7 offset:46080
    v_exp_f32 v33, v33
    v_mfma_f32_32x32x16_bf16 v[144:159], a[20:23], a[244:247], v[144:159]
    buffer_load_dwordx4 v18, s[16:19], s34 offen offset:2048 lds
    ds_read_b64_tr_b16 a[4:5], v10 offset:45056
    ds_read_b64_tr_b16 a[6:7], v10 offset:46080
    v_fma_f32 v32, v32, v29, v29
    v_rcp_f32 v37, v37
    s_waitcnt lgkmcnt(4)
    v_mfma_f32_32x32x16_bf16 v[160:175], a[24:27], a[244:247], v[160:175]
    ds_read_b64_tr_b16 a[8:9], v7 offset:61440
    ds_read_b64_tr_b16 a[10:11], v7 offset:62464
    v_mul_f32 v127, v95, v127
    v_mul_f32 v124, v36, v124
    v_mfma_f32_32x32x16_bf16 v[176:191], a[28:31], a[244:247], v[176:191]
    ds_read_b64_tr_b16 a[12:13], v10 offset:61440
    ds_read_b64_tr_b16 a[14:15], v10 offset:62464
    v_cvt_pk_bf16_f32 v45, v122, v123
    v_fma_f32 v33, v33, v29, v29
    s_waitcnt lgkmcnt(4)
    v_mfma_f32_32x32x16_bf16 v[128:143], a[0:3], a[248:251], v[128:143]
    buffer_load_dwordx4 v19, s[16:19], s34 offen offset:3072 lds
    ds_read_b64_tr_b16 a[16:17], v7 offset:47104
    ds_read_b64_tr_b16 a[18:19], v7 offset:48128
    v_rcp_f32 v32, v32
    v_mfma_f32_32x32x16_bf16 v[144:159], a[4:7], a[248:251], v[144:159]
    ds_read_b64_tr_b16 a[20:21], v10 offset:47104
    ds_read_b64_tr_b16 a[22:23], v10 offset:48128
    v_mul_f32 v125, v37, v125
    v_rcp_f32 v33, v33
    s_waitcnt lgkmcnt(4)
    v_mfma_f32_32x32x16_bf16 v[160:175], a[8:11], a[248:251], v[160:175]
    ds_read_b64_tr_b16 a[24:25], v7 offset:63488
    ds_read_b64_tr_b16 a[26:27], v7 offset:64512
    s_cmp_lg_u32 s24, 0
    s_cbranch_scc1 L_ct_6
    s_and_b32 s3, s35, 15
    s_mul_i32 s3, s3, 1024
    s_add_u32 s3, s3, 0x9f20
    v_lshlrev_b32 v14, 7, v1
    v_add_u32 v14, s3, v14
    v_min_u32 v14, 0xbde8, v14
    v_mov_b32 v15, s101
    v_add_co_u32 v14, vcc, s100, v14
    s_nop 1
    v_addc_co_u32 v15, vcc, 0, v15, vcc
    s_mov_b64 exec, 255
    global_load_dword v60, v[14:15], off
    s_mov_b64 exec, -1
L_ct_6:
    v_mul_f32 v126, v32, v126
    v_cvt_pk_bf16_f32 v46, v124, v125
    v_mfma_f32_32x32x16_bf16 v[176:191], a[12:15], a[248:251], v[176:191]
    ds_read_b64_tr_b16 a[28:29], v10 offset:63488
    ds_read_b64_tr_b16 a[30:31], v10 offset:64512
    v_mul_f32 v127, v33, v127
    v_cvt_pk_bf16_f32 v47, v126, v127
    s_waitcnt vmcnt(9)
    s_barrier
    s_waitcnt lgkmcnt(4)
    v_mfma_f32_32x32x16_bf16 v[128:143], a[16:19], a[252:255], v[128:143]
    ds_read_b64_tr_b16 a[0:1], v12 offset:0
    ds_read_b64_tr_b16 a[2:3], v12 offset:512
    v_mfma_f32_32x32x16_bf16 v[144:159], a[20:23], a[252:255], v[144:159]
    buffer_store_dwordx4 v[44:47], v2, s[20:23], s41 offen offset:3072 sc1
    ds_read_b64_tr_b16 a[4:5], v12 offset:16384
    ds_read_b64_tr_b16 a[6:7], v12 offset:16896
    s_waitcnt lgkmcnt(4)
    v_mfma_f32_32x32x16_bf16 v[160:175], a[24:27], a[252:255], v[160:175]
    ds_read_b64_tr_b16 a[8:9], v12 offset:1024
    ds_read_b64_tr_b16 a[10:11], v12 offset:1536
    v_mfma_f32_32x32x16_bf16 v[176:191], a[28:31], a[252:255], v[176:191]
    ds_read_b64_tr_b16 a[12:13], v12 offset:17408
    ds_read_b64_tr_b16 a[14:15], v12 offset:17920
    s_waitcnt lgkmcnt(4)
    v_mfma_f32_32x32x16_bf16 v[64:79], a[0:3], v[192:195], 0
    ds_read_b64_tr_b16 a[16:17], v12 offset:2048
    ds_read_b64_tr_b16 a[18:19], v12 offset:2560
    ds_read_b64_tr_b16 a[160:161], v8 offset:0
    v_mfma_f32_32x32x16_bf16 v[80:95], a[4:7], v[192:195], 0
    ds_read_b64_tr_b16 a[20:21], v12 offset:18432
    ds_read_b64_tr_b16 a[22:23], v12 offset:18944
    s_waitcnt lgkmcnt(5)
    v_mfma_f32_32x32x16_bf16 v[64:79], a[8:11], v[196:199], v[64:79]
    ds_read_b64_tr_b16 a[24:25], v12 offset:3072
    ds_read_b64_tr_b16 a[26:27], v12 offset:3584
    v_mfma_f32_32x32x16_bf16 v[80:95], a[12:15], v[196:199], v[80:95]
    ds_read_b64_tr_b16 a[28:29], v12 offset:19456
    ds_read_b64_tr_b16 a[30:31], v12 offset:19968
    s_lshr_b32 s3, s27, 1
    s_lshl_b32 s3, s3, 15
    s_lshl_b32 s4, s25, 11
    s_add_u32 s3, s3, s4
    s_add_u32 s51, s3, 0xf00000
    s_lshl_b32 s4, s25, 2
    s_sub_i32 s4, 8, s4
    s_max_i32 s4, s4, 0
    s_lshl_b32 s86, -1, s4
    s_and_b32 s86, s86, 0xfff
    s_mov_b32 s87, 0
    s_mov_b64 exec, s[86:87]
    buffer_load_dwordx2 v[24:25], v31, s[20:23], s51 offen sc1
    s_mov_b64 exec, -1
    v_mul_f32 v32, v28, v128
    v_exp_f32 v32, v32
    v_mul_f32 v33, v28, v129
    v_mul_f32 v160, v128, v160
    s_waitcnt lgkmcnt(4)
    v_mfma_f32_32x32x16_bf16 v[64:79], a[16:19], v[200:203], v[64:79]
    ds_read_b64_tr_b16 a[0:1], v12 offset:4096
    ds_read_b64_tr_b16 a[2:3], v12 offset:4608
    v_exp_f32 v33, v33
    v_mul_f32 v34, v28, v130
    v_fma_f32 v32, v32, v29, v29
    v_mul_f32 v161, v129, v161
    v_mfma_f32_32x32x16_bf16 v[80:95], a[20:23], v[200:203], v[80:95]
    ds_read_b64_tr_b16 a[4:5], v12 offset:20480
    ds_read_b64_tr_b16 a[6:7], v12 offset:20992
    ds_read_b64_tr_b16 a[162:163], v8 offset:1024
    v_exp_f32 v34, v34
    v_mul_f32 v35, v28, v131
    v_fma_f32 v33, v33, v29, v29
    s_waitcnt lgkmcnt(5)
    v_mfma_f32_32x32x16_bf16 v[64:79], a[24:27], v[204:207], v[64:79]
    ds_read_b64_tr_b16 a[8:9], v12 offset:5120
    ds_read_b64_tr_b16 a[10:11], v12 offset:5632
    v_rcp_f32 v32, v32
    v_mul_f32 v162, v130, v162
    v_exp_f32 v35, v35
    v_mfma_f32_32x32x16_bf16 v[80:95], a[28:31], v[204:207], v[80:95]
    ds_read_b64_tr_b16 a[12:13], v12 offset:21504
    ds_read_b64_tr_b16 a[14:15], v12 offset:22016
    ds_read_b64_tr_b16 a[164:165], v11 offset:0
    v_mul_f32 v36, v28, v132
    v_fma_f32 v34, v34, v29, v29
    v_rcp_f32 v33, v33
    s_waitcnt lgkmcnt(6)
    v_mfma_f32_32x32x16_bf16 v[64:79], a[0:3], v[208:211], v[64:79]
    ds_read_b64_tr_b16 a[16:17], v12 offset:6144
    ds_read_b64_tr_b16 a[18:19], v12 offset:6656
    v_mul_f32 v163, v131, v163
    v_mul_f32 v160, v32, v160
    v_exp_f32 v36, v36
    v_mul_f32 v37, v28, v133
    v_mfma_f32_32x32x16_bf16 v[80:95], a[4:7], v[208:211], v[80:95]
    ds_read_b64_tr_b16 a[20:21], v12 offset:22528
    ds_read_b64_tr_b16 a[22:23], v12 offset:23040
    ds_read_b64_tr_b16 a[166:167], v11 offset:1024
    v_fma_f32 v35, v35, v29, v29
    v_rcp_f32 v34, v34
    v_mul_f32 v164, v132, v164
    s_waitcnt lgkmcnt(6)
    v_mfma_f32_32x32x16_bf16 v[64:79], a[8:11], v[212:215], v[64:79]
    ds_read_b64_tr_b16 a[24:25], v12 offset:7168
    ds_read_b64_tr_b16 a[26:27], v12 offset:7680
    v_mul_f32 v161, v33, v161
    v_exp_f32 v37, v37
    v_mul_f32 v32, v28, v134
    v_fma_f32 v36, v36, v29, v29
    v_mfma_f32_32x32x16_bf16 v[80:95], a[12:15], v[212:215], v[80:95]
    ds_read_b64_tr_b16 a[28:29], v12 offset:23552
    ds_read_b64_tr_b16 a[30:31], v12 offset:24064
    ds_read_b64_tr_b16 a[168:169], v8 offset:2048
    v_rcp_f32 v35, v35
    v_mul_f32 v165, v133, v165
    v_mul_f32 v162, v34, v162
    s_waitcnt lgkmcnt(6)
    v_mfma_f32_32x32x16_bf16 v[64:79], a[16:19], v[216:219], v[64:79]
    ds_read_b64_tr_b16 a[0:1], v12 offset:8192
    ds_read_b64_tr_b16 a[2:3], v12 offset:8704
    v_cvt_pk_bf16_f32 v40, v160, v161
    v_exp_f32 v32, v32
    v_mul_f32 v33, v28, v135
    v_fma_f32 v37, v37, v29, v29
    v_mfma_f32_32x32x16_bf16 v[80:95], a[20:23], v[216:219], v[80:95]
    ds_read_b64_tr_b16 a[4:5], v12 offset:24576
    ds_read_b64_tr_b16 a[6:7], v12 offset:25088
    ds_read_b64_tr_b16 a[170:171], v8 offset:3072
    v_rcp_f32 v36, v36
    v_mul_f32 v166, v134, v166
    v_mul_f32 v163, v35, v163
    s_waitcnt lgkmcnt(6)
    v_mfma_f32_32x32x16_bf16 v[64:79], a[24:27], v[220:223], v[64:79]
    ds_read_b64_tr_b16 a[8:9], v12 offset:9216
    ds_read_b64_tr_b16 a[10:11], v12 offset:9728
    v_exp_f32 v33, v33
    v_mul_f32 v34, v28, v136
    v_fma_f32 v32, v32, v29, v29
    v_mfma_f32_32x32x16_bf16 v[80:95], a[28:31], v[220:223], v[80:95]
    ds_read_b64_tr_b16 a[12:13], v12 offset:25600
    ds_read_b64_tr_b16 a[14:15], v12 offset:26112
    s_waitcnt vmcnt(1)
    s_lshl_b32 s3, s28, 11
    s_lshl_b32 s4, s27, 7
    s_add_u32 s3, s3, s4
    s_add_u32 s3, s3, 0xf90000
    s_mov_b64 exec, 0xffff
    buffer_store_dwordx2 v[4:5], v3, s[20:23], s3 offen sc1
    s_mov_b64 exec, -1
    v_rcp_f32 v37, v37
    v_mul_f32 v167, v135, v167
    v_mul_f32 v164, v36, v164
    v_cvt_pk_bf16_f32 v41, v162, v163
    s_waitcnt lgkmcnt(5)
    v_mfma_f32_32x32x16_bf16 v[64:79], a[0:3], v[224:227], v[64:79]
    ds_read_b64_tr_b16 a[16:17], v12 offset:10240
    ds_read_b64_tr_b16 a[18:19], v12 offset:10752
    v_exp_f32 v34, v34
    v_mul_f32 v35, v28, v137
    v_fma_f32 v33, v33, v29, v29
    v_mfma_f32_32x32x16_bf16 v[80:95], a[4:7], v[224:227], v[80:95]
    ds_read_b64_tr_b16 a[20:21], v12 offset:26624
    ds_read_b64_tr_b16 a[22:23], v12 offset:27136
    ds_read_b64_tr_b16 a[172:173], v11 offset:2048
    v_rcp_f32 v32, v32
    v_mul_f32 v168, v136, v168
    v_mul_f32 v165, v37, v165
    s_waitcnt lgkmcnt(5)
    v_mfma_f32_32x32x16_bf16 v[64:79], a[8:11], v[228:231], v[64:79]
    ds_read_b64_tr_b16 a[24:25], v12 offset:11264
    ds_read_b64_tr_b16 a[26:27], v12 offset:11776
    v_exp_f32 v35, v35
    v_mul_f32 v36, v28, v138
    v_fma_f32 v34, v34, v29, v29
    v_rcp_f32 v33, v33
    v_mfma_f32_32x32x16_bf16 v[80:95], a[12:15], v[228:231], v[80:95]
    ds_read_b64_tr_b16 a[28:29], v12 offset:27648
    ds_read_b64_tr_b16 a[30:31], v12 offset:28160
    ds_read_b64_tr_b16 a[174:175], v11 offset:3072
    v_mul_f32 v169, v137, v169
    v_mul_f32 v166, v32, v166
    v_cvt_pk_bf16_f32 v42, v164, v165
    v_exp_f32 v36, v36
    s_waitcnt lgkmcnt(6)
    v_mfma_f32_32x32x16_bf16 v[64:79], a[16:19], v[232:235], v[64:79]
    ds_read_b64_tr_b16 a[0:1], v12 offset:12288
    ds_read_b64_tr_b16 a[2:3], v12 offset:12800
    v_mul_f32 v37, v28, v139
    v_fma_f32 v35, v35, v29, v29
    v_rcp_f32 v34, v34
    v_mul_f32 v170, v138, v170
    v_mfma_f32_32x32x16_bf16 v[80:95], a[20:23], v[232:235], v[80:95]
    ds_read_b64_tr_b16 a[4:5], v12 offset:28672
    ds_read_b64_tr_b16 a[6:7], v12 offset:29184
    s_waitcnt lgkmcnt(4)
    s_add_u32 m0, s48, 0
    s_bfe_u32 s76, s49, 0x80008
    s_lshl_b32 s76, s76, 14
    s_add_u32 s76, s76, s74
    v_mul_f32 v167, v33, v167
    v_exp_f32 v37, v37
    v_mul_f32 v32, v28, v140
    v_fma_f32 v36, v36, v29, v29
    v_mfma_f32_32x32x16_bf16 v[64:79], a[24:27], v[236:239], v[64:79]
    buffer_load_dwordx4 v56, s[56:59], s76 offen offset:0 lds
    ds_read_b64_tr_b16 a[8:9], v12 offset:13312
    ds_read_b64_tr_b16 a[10:11], v12 offset:13824
    v_rcp_f32 v35, v35
    v_mul_f32 v171, v139, v171
    v_mul_f32 v168, v34, v168
    v_mfma_f32_32x32x16_bf16 v[80:95], a[28:31], v[236:239], v[80:95]
    ds_read_b64_tr_b16 a[12:13], v12 offset:29696
    ds_read_b64_tr_b16 a[14:15], v12 offset:30208
    v_cvt_pk_bf16_f32 v43, v166, v167
    s_waitcnt lgkmcnt(4)
    v_mfma_f32_32x32x16_bf16 v[64:79], a[0:3], v[240:243], v[64:79]
    buffer_load_dwordx4 v57, s[56:59], s76 offen offset:1024 lds
    ds_read_b64_tr_b16 a[16:17], v12 offset:14336
    ds_read_b64_tr_b16 a[18:19], v12 offset:14848
    v_exp_f32 v32, v32
    v_mul_f32 v33, v28, v141
    v_fma_f32 v37, v37, v29, v29
    v_rcp_f32 v36, v36
    v_mfma_f32_32x32x16_bf16 v[80:95], a[4:7], v[240:243], v[80:95]
    buffer_store_dwordx4 v[40:43], v2, s[20:23], s42 offen offset:0 sc1
    ds_read_b64_tr_b16 a[20:21], v12 offset:30720
    ds_read_b64_tr_b16 a[22:23], v12 offset:31232
    v_mul_f32 v172, v140, v172
    v_mul_f32 v169, v35, v169
    v_exp_f32 v33, v33
    v_mul_f32 v34, v28, v142
    s_waitcnt lgkmcnt(4)
    v_mfma_f32_32x32x16_bf16 v[64:79], a[8:11], v[244:247], v[64:79]
    buffer_load_dwordx4 v58, s[56:59], s76 offen offset:2048 lds
    ds_read_b64_tr_b16 a[24:25], v12 offset:15360
    ds_read_b64_tr_b16 a[26:27], v12 offset:15872
    v_fma_f32 v32, v32, v29, v29
    v_rcp_f32 v37, v37
    v_mul_f32 v173, v141, v173
    v_mfma_f32_32x32x16_bf16 v[80:95], a[12:15], v[244:247], v[80:95]
    ds_read_b64_tr_b16 a[28:29], v12 offset:31744
    ds_read_b64_tr_b16 a[30:31], v12 offset:32256
    v_mul_f32 v170, v36, v170
    v_cvt_pk_bf16_f32 v44, v168, v169
    v_exp_f32 v34, v34
    v_mul_f32 v35, v28, v143
    s_barrier
    s_waitcnt lgkmcnt(4)
    v_mfma_f32_32x32x16_bf16 v[64:79], a[16:19], v[248:251], v[64:79]
    buffer_load_dwordx4 v59, s[56:59], s76 offen offset:3072 lds
    ds_read_b64_tr_b16 a[0:1], v12 offset:32768
    ds_read_b64_tr_b16 a[2:3], v12 offset:33280
    v_fma_f32 v33, v33, v29, v29
    v_rcp_f32 v32, v32
    v_mul_f32 v174, v142, v174
    v_mul_f32 v171, v37, v171
    v_mfma_f32_32x32x16_bf16 v[80:95], a[20:23], v[248:251], v[80:95]
    ds_read_b64_tr_b16 a[4:5], v12 offset:49152
    ds_read_b64_tr_b16 a[6:7], v12 offset:49664
    v_exp_f32 v35, v35
    v_mul_f32 v36, v28, v144
    v_fma_f32 v34, v34, v29, v29
    v_rcp_f32 v33, v33
    s_waitcnt lgkmcnt(4)
    v_mfma_f32_32x32x16_bf16 v[64:79], a[24:27], v[252:255], v[64:79]
    ds_read_b64_tr_b16 a[8:9], v12 offset:33792
    ds_read_b64_tr_b16 a[10:11], v12 offset:34304
    v_mul_f32 v175, v143, v175
    v_mul_f32 v172, v32, v172
    v_cvt_pk_bf16_f32 v45, v170, v171
    v_exp_f32 v36, v36
    v_mfma_f32_32x32x16_bf16 v[80:95], a[28:31], v[252:255], v[80:95]
    ds_read_b64_tr_b16 a[12:13], v12 offset:50176
    ds_read_b64_tr_b16 a[14:15], v12 offset:50688
    v_mul_f32 v37, v28, v145
    v_fma_f32 v35, v35, v29, v29
    v_rcp_f32 v34, v34
    v_mul_f32 v176, v144, v176
    s_waitcnt lgkmcnt(4)
    v_mfma_f32_32x32x16_bf16 v[64:79], a[0:3], a[192:195], v[64:79]
    ds_read_b64_tr_b16 a[16:17], v12 offset:34816
    ds_read_b64_tr_b16 a[18:19], v12 offset:35328
    s_waitcnt vmcnt(5)
    v_cmp_eq_u64 vcc, v[24:25], v[4:5]
    s_nop 0
    s_and_b64 vcc, vcc, s[86:87]
    s_cmp_eq_u64 vcc, s[86:87]
    s_cbranch_scc1 L_polld_8
    s_mov_b32 s93, 0x20000
L_poll_7:
    s_mov_b64 exec, s[86:87]
    buffer_load_dwordx2 v[24:25], v31, s[20:23], s51 offen sc1
    s_mov_b64 exec, -1
    s_waitcnt vmcnt(0)
    v_cmp_eq_u64 vcc, v[24:25], v[4:5]
    s_nop 0
    s_and_b64 vcc, vcc, s[86:87]
    s_cmp_eq_u64 vcc, s[86:87]
    s_cbranch_scc1 L_polld_8
    s_sub_u32 s93, s93, 1
    s_cmp_lg_u32 s93, 0
    s_cbranch_scc1 L_poll_7
L_polld_8:
    v_mul_f32 v173, v33, v173
    v_exp_f32 v37, v37
    v_mul_f32 v32, v28, v146
    v_fma_f32 v36, v36, v29, v29
    v_mfma_f32_32x32x16_bf16 v[80:95], a[4:7], a[192:195], v[80:95]
    ds_read_b64_tr_b16 a[20:21], v12 offset:51200
    ds_read_b64_tr_b16 a[22:23], v12 offset:51712
    v_rcp_f32 v35, v35
    v_mul_f32 v177, v145, v177
    v_mul_f32 v174, v34, v174
    v_cvt_pk_bf16_f32 v46, v172, v173
    s_waitcnt lgkmcnt(4)
    v_mfma_f32_32x32x16_bf16 v[64:79], a[8:11], a[196:199], v[64:79]
    ds_read_b64_tr_b16 a[24:25], v12 offset:35840
    ds_read_b64_tr_b16 a[26:27], v12 offset:36352
    s_mul_i32 s5, s27, 131072
    s_lshl_b32 s3, s25, 2
    s_add_u32 s7, s3, s24
    s_sub_i32 s7, s7, 8
    s_max_i32 s7, s7, 0
    s_lshl_b32 s4, s24, 1
    s_add_u32 s4, s4, s3
    s_sub_i32 s4, s4, 4
    s_max_i32 s67, s4, 0
    s_lshl_b32 s3, s24, 10
    s_add_u32 m0, s3, 65536
    s_lshl_b32 s6, s7, 10
    s_add_u32 s6, s6, s5
    s_add_u32 s6, s6, 0xb00000
    v_exp_f32 v32, v32
    v_mul_f32 v33, v28, v147
    v_fma_f32 v37, v37, v29, v29
    v_mfma_f32_32x32x16_bf16 v[80:95], a[12:15], a[196:199], v[80:95]
    buffer_load_dwordx4 v2, s[20:23], s6 offen offset:0 sc1 lds
    ds_read_b64_tr_b16 a[28:29], v12 offset:52224
    ds_read_b64_tr_b16 a[30:31], v12 offset:52736
    s_add_u32 m0, m0, 12288
    s_add_u32 s6, s6, 65536
    v_rcp_f32 v36, v36
    v_mul_f32 v178, v146, v178
    v_mul_f32 v175, v35, v175
    s_waitcnt lgkmcnt(4)
    v_mfma_f32_32x32x16_bf16 v[64:79], a[16:19], a[200:203], v[64:79]
    buffer_load_dwordx4 v2, s[20:23], s6 offen offset:0 sc1 lds
    ds_read_b64_tr_b16 a[0:1], v12 offset:36864
    ds_read_b64_tr_b16 a[2:3], v12 offset:37376
    s_lshl_b32 s3, s24, 11
    s_add_u32 m0, s3, 90112
    s_lshl_b32 s6, s7, 11
    s_add_u32 s6, s6, s5
    s_add_u32 s6, s6, 0xd00000
    v_exp_f32 v33, v33
    v_mul_f32 v34, v28, v148
    v_fma_f32 v32, v32, v29, v29
    v_rcp_f32 v37, v37
    v_mfma_f32_32x32x16_bf16 v[80:95], a[20:23], a[200:203], v[80:95]
    buffer_load_dwordx4 v2, s[20:23], s6 offen offset:0 sc1 lds
    ds_read_b64_tr_b16 a[4:5], v12 offset:53248
    ds_read_b64_tr_b16 a[6:7], v12 offset:53760
    v_mul_f32 v179, v147, v179
    v_mul_f32 v176, v36, v176
    v_cvt_pk_bf16_f32 v47, v174, v175
    s_waitcnt lgkmcnt(4)
    v_mfma_f32_32x32x16_bf16 v[64:79], a[24:27], a[204:207], v[64:79]
    buffer_load_dwordx4 v2, s[20:23], s6 offen offset:1024 sc1 lds
    ds_read_b64_tr_b16 a[8:9], v12 offset:37888
    ds_read_b64_tr_b16 a[10:11], v12 offset:38400
    v_exp_f32 v34, v34
    v_mul_f32 v35, v28, v149
    v_fma_f32 v33, v33, v29, v29
    v_mfma_f32_32x32x16_bf16 v[80:95], a[28:31], a[204:207], v[80:95]
    buffer_store_dwordx4 v[44:47], v2, s[20:23], s42 offen offset:1024 sc1
    ds_read_b64_tr_b16 a[12:13], v12 offset:54272
    ds_read_b64_tr_b16 a[14:15], v12 offset:54784
    s_lshl_b32 s3, s24, 11
    s_add_u32 m0, s3, 69632
    s_lshl_b32 s6, s67, 10
    s_add_u32 s6, s6, s5
    s_add_u32 s6, s6, 0xb00000
    v_rcp_f32 v32, v32
    v_mul_f32 v180, v148, v180
    v_mul_f32 v177, v37, v177
    s_waitcnt lgkmcnt(4)
    v_mfma_f32_32x32x16_bf16 v[64:79], a[0:3], a[208:211], v[64:79]
    buffer_load_dwordx4 v2, s[20:23], s6 offen offset:0 sc1 lds
    ds_read_b64_tr_b16 a[16:17], v12 offset:38912
    ds_read_b64_tr_b16 a[18:19], v12 offset:39424
    v_exp_f32 v35, v35
    v_mul_f32 v36, v28, v150
    v_fma_f32 v34, v34, v29, v29
    v_rcp_f32 v33, v33
    v_mfma_f32_32x32x16_bf16 v[80:95], a[4:7], a[208:211], v[80:95]
    buffer_load_dwordx4 v2, s[20:23], s6 offen offset:1024 sc1 lds
    ds_read_b64_tr_b16 a[20:21], v12 offset:55296
    ds_read_b64_tr_b16 a[22:23], v12 offset:55808
    s_add_u32 m0, m0, 12288
    s_add_u32 s6, s6, 65536
    v_mul_f32 v181, v149, v181
    v_mul_f32 v178, v32, v178
    v_cvt_pk_bf16_f32 v40, v176, v177
    v_exp_f32 v36, v36
    s_waitcnt lgkmcnt(4)
    v_mfma_f32_32x32x16_bf16 v[64:79], a[8:11], a[212:215], v[64:79]
    buffer_load_dwordx4 v2, s[20:23], s6 offen offset:0 sc1 lds
    ds_read_b64_tr_b16 a[24:25], v12 offset:39936
    ds_read_b64_tr_b16 a[26:27], v12 offset:40448
    v_mul_f32 v37, v28, v151
    v_fma_f32 v35, v35, v29, v29
    v_rcp_f32 v34, v34
    v_mfma_f32_32x32x16_bf16 v[80:95], a[12:15], a[212:215], v[80:95]
    buffer_load_dwordx4 v2, s[20:23], s6 offen offset:1024 sc1 lds
    ds_read_b64_tr_b16 a[28:29], v12 offset:56320
    ds_read_b64_tr_b16 a[30:31], v12 offset:56832
    s_lshl_b32 s3, s24, 12
    s_add_u32 m0, s3, 98304
    s_lshl_b32 s6, s67, 11
    s_add_u32 s6, s6, s5
    s_add_u32 s6, s6, 0xd00000
    v_mul_f32 v182, v150, v182
    v_mul_f32 v179, v33, v179
    v_exp_f32 v37, v37
    s_waitcnt lgkmcnt(4)
    v_mfma_f32_32x32x16_bf16 v[64:79], a[16:19], a[216:219], v[64:79]
    buffer_load_dwordx4 v2, s[20:23], s6 offen offset:0 sc1 lds
    ds_read_b64_tr_b16 a[0:1], v12 offset:40960
    ds_read_b64_tr_b16 a[2:3], v12 offset:41472
    v_mul_f32 v32, v28, v152
    v_fma_f32 v36, v36, v29, v29
    v_rcp_f32 v35, v35
    v_mul_f32 v183, v151, v183
    v_mfma_f32_32x32x16_bf16 v[80:95], a[20:23], a[216:219], v[80:95]
    buffer_load_dwordx4 v2, s[20:23], s6 offen offset:1024 sc1 lds
    ds_read_b64_tr_b16 a[4:5], v12 offset:57344
    ds_read_b64_tr_b16 a[6:7], v12 offset:57856
    v_mul_f32 v180, v34, v180
    v_cvt_pk_bf16_f32 v41, v178, v179
    v_exp_f32 v32, v32
    v_mul_f32 v33, v28, v153
    s_waitcnt lgkmcnt(4)
    v_mfma_f32_32x32x16_bf16 v[64:79], a[24:27], a[220:223], v[64:79]
    buffer_load_dwordx4 v2, s[20:23], s6 offen offset:2048 sc1 lds
    ds_read_b64_tr_b16 a[8:9], v12 offset:41984
    ds_read_b64_tr_b16 a[10:11], v12 offset:42496
    v_fma_f32 v37, v37, v29, v29
    v_rcp_f32 v36, v36
    v_mul_f32 v184, v152, v184
    v_mul_f32 v181, v35, v181
    v_mfma_f32_32x32x16_bf16 v[80:95], a[28:31], a[220:223], v[80:95]
    buffer_load_dwordx4 v2, s[20:23], s6 offen offset:3072 sc1 lds
    ds_read_b64_tr_b16 a[12:13], v12 offset:58368
    ds_read_b64_tr_b16 a[14:15], v12 offset:58880
    s_lshr_b32 s3, s27, 1
    s_lshl_b32 s3, s3, 15
    s_lshl_b32 s4, s25, 11
    s_add_u32 s3, s3, s4
    s_lshl_b32 s4, s24, 7
    s_add_u32 s3, s3, s4
    s_add_u32 s51, s3, 0xf01200
    s_mov_b32 s86, 1
    s_mov_b32 s87, 0
    s_mov_b64 exec, 0x1
    buffer_load_dwordx2 v[24:25], v31, s[20:23], s51 offen sc1
    s_mov_b64 exec, -1
    v_exp_f32 v33, v33
    v_mul_f32 v34, v28, v154
    v_fma_f32 v32, v32, v29, v29
    v_rcp_f32 v37, v37
    s_waitcnt lgkmcnt(4)
    v_mfma_f32_32x32x16_bf16 v[64:79], a[0:3], a[224:227], v[64:79]
    ds_read_b64_tr_b16 a[16:17], v12 offset:43008
    ds_read_b64_tr_b16 a[18:19], v12 offset:43520
    ds_read_b64_tr_b16 a[176:177], v8 offset:4096
    v_mul_f32 v185, v153, v185
    v_mul_f32 v182, v36, v182
    v_cvt_pk_bf16_f32 v42, v180, v181
    v_exp_f32 v34, v34
    v_mfma_f32_32x32x16_bf16 v[80:95], a[4:7], a[224:227], v[80:95]
    ds_read_b64_tr_b16 a[20:21], v12 offset:59392
    ds_read_b64_tr_b16 a[22:23], v12 offset:59904
    ds_read_b64_tr_b16 a[178:179], v8 offset:5120
    v_mul_f32 v35, v28, v155
    v_fma_f32 v33, v33, v29, v29
    v_rcp_f32 v32, v32
    s_waitcnt lgkmcnt(6)
    v_mfma_f32_32x32x16_bf16 v[64:79], a[8:11], a[228:231], v[64:79]
    ds_read_b64_tr_b16 a[24:25], v12 offset:44032
    ds_read_b64_tr_b16 a[26:27], v12 offset:44544
    ds_read_b64_tr_b16 a[180:181], v11 offset:4096
    v_mul_f32 v186, v154, v186
    v_mul_f32 v183, v37, v183
    v_exp_f32 v35, v35
    v_mfma_f32_32x32x16_bf16 v[80:95], a[12:15], a[228:231], v[80:95]
    ds_read_b64_tr_b16 a[28:29], v12 offset:60416
    ds_read_b64_tr_b16 a[30:31], v12 offset:60928
    ds_read_b64_tr_b16 a[182:183], v11 offset:5120
    v_mul_f32 v36, v28, v156
    v_fma_f32 v34, v34, v29, v29
    v_rcp_f32 v33, v33
    v_mul_f32 v187, v155, v187
    s_waitcnt lgkmcnt(7)
    v_mfma_f32_32x32x16_bf16 v[64:79], a[16:19], a[232:235], v[64:79]
    ds_read_b64_tr_b16 a[0:1], v12 offset:45056
    ds_read_b64_tr_b16 a[2:3], v12 offset:45568
    v_mul_f32 v184, v32, v184
    v_cvt_pk_bf16_f32 v43, v182, v183
    v_mfma_f32_32x32x16_bf16 v[80:95], a[20:23], a[232:235], v[80:95]
    ds_read_b64_tr_b16 a[4:5], v12 offset:61440
    ds_read_b64_tr_b16 a[6:7], v12 offset:61952
    ds_read_b64_tr_b16 a[184:185], v8 offset:6144
    v_exp_f32 v36, v36
    v_mul_f32 v37, v28, v157
    v_fma_f32 v35, v35, v29, v29
    v_rcp_f32 v34, v34
    s_waitcnt lgkmcnt(6)
    v_mfma_f32_32x32x16_bf16 v[64:79], a[24:27], a[236:239], v[64:79]
    buffer_store_dwordx4 v[40:43], v2, s[20:23], s42 offen offset:2048 sc1
    ds_read_b64_tr_b16 a[8:9], v12 offset:46080
    ds_read_b64_tr_b16 a[10:11], v12 offset:46592
    ds_read_b64_tr_b16 a[186:187], v8 offset:7168
    v_mul_f32 v188, v156, v188
    v_mul_f32 v185, v33, v185
    v_exp_f32 v37, v37
    v_mul_f32 v32, v28, v158
    v_mfma_f32_32x32x16_bf16 v[80:95], a[28:31], a[236:239], v[80:95]
    ds_read_b64_tr_b16 a[12:13], v12 offset:62464
    ds_read_b64_tr_b16 a[14:15], v12 offset:62976
    ds_read_b64_tr_b16 a[188:189], v11 offset:6144
    v_fma_f32 v36, v36, v29, v29
    v_rcp_f32 v35, v35
    v_mul_f32 v189, v157, v189
    s_waitcnt lgkmcnt(7)
    v_mfma_f32_32x32x16_bf16 v[64:79], a[0:3], a[240:243], v[64:79]
    ds_read_b64_tr_b16 a[16:17], v12 offset:47104
    ds_read_b64_tr_b16 a[18:19], v12 offset:47616
    ds_read_b64_tr_b16 a[190:191], v11 offset:7168
    v_mul_f32 v186, v34, v186
    v_cvt_pk_bf16_f32 v44, v184, v185
    v_exp_f32 v32, v32
    v_mul_f32 v33, v28, v159
    v_mfma_f32_32x32x16_bf16 v[80:95], a[4:7], a[240:243], v[80:95]
    ds_read_b64_tr_b16 a[20:21], v12 offset:63488
    ds_read_b64_tr_b16 a[22:23], v12 offset:64000
    s_waitcnt lgkmcnt(2)
    s_add_u32 m0, s48, 4096
    s_add_u32 s76, s76, 32768
    v_fma_f32 v37, v37, v29, v29
    v_rcp_f32 v36, v36
    v_mul_f32 v190, v158, v190
    v_mul_f32 v187, v35, v187
    v_mfma_f32_32x32x16_bf16 v[64:79], a[8:11], a[244:247], v[64:79]
    buffer_load_dwordx4 v56, s[56:59], s76 offen offset:0 lds
    ds_read_b64_tr_b16 a[24:25], v12 offset:48128
    ds_read_b64_tr_b16 a[26:27], v12 offset:48640
    v_exp_f32 v33, v33
    v_fma_f32 v32, v32, v29, v29
    v_rcp_f32 v37, v37
    v_mfma_f32_32x32x16_bf16 v[80:95], a[12:15], a[244:247], v[80:95]
    buffer_load_dwordx4 v57, s[56:59], s76 offen offset:1024 lds
    ds_read_b64_tr_b16 a[28:29], v12 offset:64512
    ds_read_b64_tr_b16 a[30:31], v12 offset:65024
    v_mul_f32 v191, v159, v191
    v_mul_f32 v188, v36, v188
    v_cvt_pk_bf16_f32 v45, v186, v187
    v_fma_f32 v33, v33, v29, v29
    v_rcp_f32 v32, v32
    s_waitcnt lgkmcnt(4)
    v_mfma_f32_32x32x16_bf16 v[64:79], a[16:19], a[248:251], v[64:79]
    buffer_load_dwordx4 v58, s[56:59], s76 offen offset:2048 lds
    v_mul_f32 v189, v37, v189
    v_rcp_f32 v33, v33
    v_mul_f32 v190, v32, v190
    v_mfma_f32_32x32x16_bf16 v[80:95], a[20:23], a[248:251], v[80:95]
    buffer_load_dwordx4 v59, s[56:59], s76 offen offset:3072 lds
    v_cvt_pk_bf16_f32 v46, v188, v189
    v_mul_f32 v191, v33, v191
    v_cvt_pk_bf16_f32 v47, v190, v191
    s_waitcnt lgkmcnt(0)
    v_mfma_f32_32x32x16_bf16 v[64:79], a[24:27], a[252:255], v[64:79]
    v_mfma_f32_32x32x16_bf16 v[80:95], a[28:31], a[252:255], v[80:95]
    buffer_store_dwordx4 v[44:47], v2, s[20:23], s42 offen offset:3072 sc1
    s_waitcnt vmcnt(6)
    v_cmp_eq_u64 vcc, v[24:25], v[4:5]
    s_nop 0
    s_and_b64 vcc, vcc, s[86:87]
    s_cmp_eq_u64 vcc, s[86:87]
    s_cbranch_scc1 L_polld_10
    s_mov_b32 s93, 0x20000
L_poll_9:
    s_mov_b64 exec, 0x1
    buffer_load_dwordx2 v[24:25], v31, s[20:23], s51 offen sc1
    s_mov_b64 exec, -1
    s_waitcnt vmcnt(0)
    v_cmp_eq_u64 vcc, v[24:25], v[4:5]
    s_nop 0
    s_and_b64 vcc, vcc, s[86:87]
    s_cmp_eq_u64 vcc, s[86:87]
    s_cbranch_scc1 L_polld_10
    s_sub_u32 s93, s93, 1
    s_cmp_lg_u32 s93, 0
    s_cbranch_scc1 L_poll_9
L_polld_10:
    s_mul_i32 s3, s27, 131072
    s_lshl_b32 s4, s28, 10
    s_add_u32 s4, s4, s3
    s_add_u32 s4, s4, 0x900000
    s_add_u32 s5, s4, 65536
    buffer_load_dwordx4 v[192:195], v2, s[20:23], s4 offen sc1
    buffer_load_dwordx4 v[196:199], v2, s[20:23], s5 offen sc1
    s_lshl_b32 s92, s31, 12
    s_lshl_b32 s3, s24, 9
    s_add_u32 s92, s92, s3
    s_add_u32 s92, s92, 0xf90000
    s_mov_b64 exec, 0xaa
    buffer_load_dwordx2 v[14:15], v31, s[20:23], s92 offen sc1
    s_mov_b64 exec, -1
    ds_read_b64_tr_b16 a[192:193], v8 offset:0
    ds_read_b64_tr_b16 a[194:195], v8 offset:1024
    ds_read_b64_tr_b16 a[196:197], v11 offset:0
    ds_read_b64_tr_b16 a[198:199], v11 offset:1024
    ds_read_b64_tr_b16 a[200:201], v8 offset:2048
    ds_read_b64_tr_b16 a[202:203], v8 offset:3072
    ds_read_b64_tr_b16 a[204:205], v11 offset:2048
    ds_read_b64_tr_b16 a[206:207], v11 offset:3072
    v_pk_mul_f32 v[32:33], v[28:29], v[64:65] op_sel_hi:[0,1]
    v_pk_mul_f32 v[34:35], v[28:29], v[66:67] op_sel_hi:[0,1]
    v_pk_mul_f32 v[36:37], v[28:29], v[68:69] op_sel_hi:[0,1]
    v_pk_mul_f32 v[38:39], v[28:29], v[70:71] op_sel_hi:[0,1]
    v_exp_f32 v32, v32
    v_exp_f32 v33, v33
    v_pk_mul_f32 v[80:81], v[64:65], v[80:81]
    v_exp_f32 v34, v34
    v_exp_f32 v35, v35
    v_pk_mul_f32 v[82:83], v[66:67], v[82:83]
    v_exp_f32 v36, v36
    v_exp_f32 v37, v37
    v_pk_mul_f32 v[84:85], v[68:69], v[84:85]
    v_exp_f32 v38, v38
    v_exp_f32 v39, v39
    v_pk_mul_f32 v[86:87], v[70:71], v[86:87]
    v_pk_fma_f32 v[32:33], v[32:33], v[28:29], v[28:29] op_sel:[0,1,1] op_sel_hi:[1,1,1]
    v_pk_fma_f32 v[34:35], v[34:35], v[28:29], v[28:29] op_sel:[0,1,1] op_sel_hi:[1,1,1]
    v_pk_fma_f32 v[36:37], v[36:37], v[28:29], v[28:29] op_sel:[0,1,1] op_sel_hi:[1,1,1]
    v_pk_fma_f32 v[38:39], v[38:39], v[28:29], v[28:29] op_sel:[0,1,1] op_sel_hi:[1,1,1]
    v_rcp_f32 v32, v32
    v_rcp_f32 v33, v33
    v_rcp_f32 v34, v34
    v_rcp_f32 v35, v35
    v_rcp_f32 v36, v36
    v_rcp_f32 v37, v37
    v_rcp_f32 v38, v38
    v_rcp_f32 v39, v39
    v_pk_mul_f32 v[80:81], v[32:33], v[80:81]
    v_pk_mul_f32 v[82:83], v[34:35], v[82:83]
    v_pk_mul_f32 v[84:85], v[36:37], v[84:85]
    v_pk_mul_f32 v[86:87], v[38:39], v[86:87]
    v_cvt_pk_bf16_f32 v40, v80, v81
    v_cvt_pk_bf16_f32 v41, v82, v83
    v_cvt_pk_bf16_f32 v42, v84, v85
    v_cvt_pk_bf16_f32 v43, v86, v87
    buffer_store_dwordx4 v[40:43], v2, s[20:23], s43 offen offset:0 sc1
    v_pk_mul_f32 v[48:49], v[28:29], v[72:73] op_sel_hi:[0,1]
    v_pk_mul_f32 v[50:51], v[28:29], v[74:75] op_sel_hi:[0,1]
    v_pk_mul_f32 v[52:53], v[28:29], v[76:77] op_sel_hi:[0,1]
    v_pk_mul_f32 v[54:55], v[28:29], v[78:79] op_sel_hi:[0,1]
    v_exp_f32 v48, v48
    v_exp_f32 v49, v49
    v_pk_mul_f32 v[88:89], v[72:73], v[88:89]
    v_exp_f32 v50, v50
    v_exp_f32 v51, v51
    v_pk_mul_f32 v[90:91], v[74:75], v[90:91]
    v_exp_f32 v52, v52
    v_exp_f32 v53, v53
    v_pk_mul_f32 v[92:93], v[76:77], v[92:93]
    v_exp_f32 v54, v54
    v_exp_f32 v55, v55
    v_pk_mul_f32 v[94:95], v[78:79], v[94:95]
    v_pk_fma_f32 v[48:49], v[48:49], v[28:29], v[28:29] op_sel:[0,1,1] op_sel_hi:[1,1,1]
    v_pk_fma_f32 v[50:51], v[50:51], v[28:29], v[28:29] op_sel:[0,1,1] op_sel_hi:[1,1,1]
    v_pk_fma_f32 v[52:53], v[52:53], v[28:29], v[28:29] op_sel:[0,1,1] op_sel_hi:[1,1,1]
    v_pk_fma_f32 v[54:55], v[54:55], v[28:29], v[28:29] op_sel:[0,1,1] op_sel_hi:[1,1,1]
    v_rcp_f32 v48, v48
    v_rcp_f32 v49, v49
    v_rcp_f32 v50, v50
    v_rcp_f32 v51, v51
    v_rcp_f32 v52, v52
    v_rcp_f32 v53, v53
    v_rcp_f32 v54, v54
    v_rcp_f32 v55, v55
    v_pk_mul_f32 v[88:89], v[48:49], v[88:89]
    v_pk_mul_f32 v[90:91], v[50:51], v[90:91]
    v_pk_mul_f32 v[92:93], v[52:53], v[92:93]
    v_pk_mul_f32 v[94:95], v[54:55], v[94:95]
    v_cvt_pk_bf16_f32 v44, v88, v89
    v_cvt_pk_bf16_f32 v45, v90, v91
    v_cvt_pk_bf16_f32 v46, v92, v93
    v_cvt_pk_bf16_f32 v47, v94, v95
    buffer_store_dwordx4 v[44:47], v2, s[20:23], s43 offen offset:1024 sc1
    v_and_b32 v48, 31, v1
    v_lshrrev_b32 v49, 5, v1
    v_lshlrev_b32 v49, 2, v49
    v_sub_u32 v48, v48, v49
    v_mov_b32 v49, 0xff800000
    v_cmp_le_i32 s[88:89], 0, v48
    v_cmp_le_i32 s[90:91], 1, v48
    s_nop 0
    v_cndmask_b32 v176, 0, v49, s[88:89]
    v_cmp_le_i32 s[88:89], 2, v48
    v_xor_b32 v160, v49, v176
    v_cndmask_b32 v177, 0, v49, s[90:91]
    v_cmp_le_i32 s[90:91], 3, v48
    v_xor_b32 v161, v49, v177
    v_cndmask_b32 v178, 0, v49, s[88:89]
    v_cmp_le_i32 s[88:89], 8, v48
    v_xor_b32 v162, v49, v178
    v_cndmask_b32 v179, 0, v49, s[90:91]
    v_cmp_le_i32 s[90:91], 9, v48
    v_xor_b32 v163, v49, v179
    v_cndmask_b32 v180, 0, v49, s[88:89]
    v_cmp_le_i32 s[88:89], 10, v48
    v_xor_b32 v164, v49, v180
    v_cndmask_b32 v181, 0, v49, s[90:91]
    v_cmp_le_i32 s[90:91], 11, v48
    v_xor_b32 v165, v49, v181
    v_cndmask_b32 v182, 0, v49, s[88:89]
    v_cmp_le_i32 s[88:89], 16, v48
    v_xor_b32 v166, v49, v182
    v_cndmask_b32 v183, 0, v49, s[90:91]
    v_cmp_le_i32 s[90:91], 17, v48
    v_xor_b32 v167, v49, v183
    v_cndmask_b32 v184, 0, v49, s[88:89]
    v_cmp_le_i32 s[88:89], 18, v48
    v_xor_b32 v168, v49, v184
    v_cndmask_b32 v185, 0, v49, s[90:91]
    v_cmp_le_i32 s[90:91], 19, v48
    v_xor_b32 v169, v49, v185
    v_cndmask_b32 v186, 0, v49, s[88:89]
    v_cmp_le_i32 s[88:89], 24, v48
    v_xor_b32 v170, v49, v186
    v_cndmask_b32 v187, 0, v49, s[90:91]
    v_cmp_le_i32 s[90:91], 25, v48
    v_xor_b32 v171, v49, v187
    v_cndmask_b32 v188, 0, v49, s[88:89]
    v_cmp_le_i32 s[88:89], 26, v48
    v_xor_b32 v172, v49, v188
    v_cndmask_b32 v189, 0, v49, s[90:91]
    v_cmp_le_i32 s[90:91], 27, v48
    v_xor_b32 v173, v49, v189
    v_cndmask_b32 v190, 0, v49, s[88:89]
    s_nop 0
    v_xor_b32 v174, v49, v190
    v_cndmask_b32 v191, 0, v49, s[90:91]
    v_xor_b32 v175, v49, v191
L_ATT:
    v_mov_b32 v220, 0x3f803f80
    v_mov_b32 v221, 0x3f803f80
    v_mov_b32 v222, 0x3f803f80
    v_mov_b32 v223, 0x3f803f80
    v_mov_b32 v40, 122880
    v_and_b32 v41, 11, v1
    v_cmp_eq_u32 vcc, 0, v41
    v_mov_b32 v41, 122896
    s_nop 0
    v_cndmask_b32 v40, v41, v40, vcc
    v_cndmask_b32 v220, 0, v220, vcc
    v_cndmask_b32 v221, 0, v221, vcc
    v_cndmask_b32 v222, 0, v222, vcc
    v_cndmask_b32 v223, 0, v223, vcc
    ds_write_b128 v40, v[220:223] offset:0
    ds_write_b128 v40, v[220:223] offset:1024
    ds_write_b128 v40, v[220:223] offset:2048
    ds_write_b128 v40, v[220:223] offset:3072
    s_mov_b32 s64, 0x0000ffff
    s_mov_b32 s65, 0x0000ffff
    s_mov_b32 s66, 0xffff0000
    s_mov_b32 s67, 0xffff0000
    s_sub_i32 s85, 8, s28
    s_max_i32 s85, s85, 0
    s_add_u32 s4, s85, s24
    s_lshl_b32 s5, s4, 10
    s_add_u32 s5, s5, 65536
    v_add_u32 v6, s5, v2
    s_lshl_b32 s5, s4, 11
    s_add_u32 s5, s5, 90112
    v_add_u32 v7, s5, v2
    v_mov_b32 v12, v6
    v_mov_b32 v13, v7
    v_mov_b32 v41, 2048
    v_cndmask_b32 v9, v40, v7, s[66:67]
    v_cndmask_b32 v7, v40, v7, s[64:65]
    v_cndmask_b32 v10, 0, v41, s[64:65]
    v_cndmask_b32 v26, 0, v41, s[66:67]
    s_lshl_b32 s3, s28, 11
    s_lshl_b32 s4, s27, 7
    s_add_u32 s3, s3, s4
    s_add_u32 s51, s3, 0xf50000
    s_lshl_b32 s3, s31, 1
    s_lshr_b32 s4, s24, 1
    s_add_u32 s5, s3, s4
    s_xor_b32 s6, s5, 1
    s_mul_i32 s88, s5, 147456
    s_mul_i32 s89, s6, 147456
    s_lshl_b32 s4, s24, 13
    s_add_u32 s4, s4, 114688
    s_add_u32 s90, s88, s4
    s_add_u32 s91, s89, s4
    s_mov_b32 s86, 0xaa
    s_mov_b32 s87, 0
    s_lshl_b32 s60, s24, 14
    s_mov_b32 s73, 0
    s_mov_b32 s34, s99
    s_waitcnt lgkmcnt(4)
    s_add_u32 m0, s48, 0
    s_bfe_u32 s76, s49, 0x80010
    s_lshl_b32 s76, s76, 14
    s_add_u32 s76, s76, s74
    buffer_load_dwordx4 v56, s[56:59], s76 offen offset:0 lds
    buffer_load_dwordx4 v57, s[56:59], s76 offen offset:1024 lds
    buffer_load_dwordx4 v58, s[56:59], s76 offen offset:2048 lds
    buffer_load_dwordx4 v59, s[56:59], s76 offen offset:3072 lds
    s_waitcnt vmcnt(9)
    ds_read_b64_tr_b16 a[208:209], v8 offset:4096
    ds_read_b64_tr_b16 a[210:211], v8 offset:5120
    ds_read_b64_tr_b16 a[212:213], v11 offset:4096
    ds_read_b64_tr_b16 a[214:215], v11 offset:5120
    ds_read_b64_tr_b16 a[216:217], v8 offset:6144
    ds_read_b64_tr_b16 a[218:219], v8 offset:7168
    ds_read_b64_tr_b16 a[220:221], v11 offset:6144
    ds_read_b64_tr_b16 a[222:223], v11 offset:7168
    s_waitcnt vmcnt(6)
    v_cmp_eq_u64 vcc, v[14:15], v[4:5]
    s_nop 0
    s_and_b64 vcc, vcc, s[86:87]
    s_cmp_eq_u64 vcc, s[86:87]
    s_cbranch_scc1 L_polld_12
    s_mov_b32 s93, 0x20000
L_poll_11:
    s_mov_b64 exec, 0xaa
    buffer_load_dwordx2 v[14:15], v31, s[20:23], s92 offen sc1
    s_mov_b64 exec, -1
    s_waitcnt vmcnt(0)
    v_cmp_eq_u64 vcc, v[14:15], v[4:5]
    s_nop 0
    s_and_b64 vcc, vcc, s[86:87]
    s_cmp_eq_u64 vcc, s[86:87]
    s_cbranch_scc1 L_polld_12
    s_sub_u32 s93, s93, 1
    s_cmp_lg_u32 s93, 0
    s_cbranch_scc1 L_poll_11
L_polld_12:
    s_add_u32 s92, s92, 0xfffc0000
    s_mov_b32 s86, 0xff
    v_and_b32 v40, 31, v1
    v_lshrrev_b32 v41, 5, v1
    v_lshlrev_b32 v40, 10, v40
    v_lshl_add_u32 v27, v41, 4, v40
    s_lshr_b32 s3, s24, 1
    s_lshl_b32 s4, s31, 1
    s_add_u32 s3, s3, s4
    s_lshl_b32 s3, s3, 15
    s_and_b32 s4, s24, 1
    s_lshl_b32 s4, s4, 6
    s_add_u32 s3, s3, s4
    s_lshl_b32 s4, s32, 7
    s_add_u32 s72, s3, s4
    buffer_load_dwordx4 v[48:51], v27, s[8:11], s72 offen
    buffer_load_dwordx4 v[52:55], v27, s[8:11], s72 offen offset:32
    s_waitcnt lgkmcnt(8)
    s_barrier
    ds_read_b128 v[200:203], v6 offset:0
    ds_read_b128 v[204:207], v6 offset:12288
    ds_read_b128 v[208:211], v7 offset:0
    ds_read_b128 v[212:215], v7 offset:1024
    s_waitcnt lgkmcnt(4)
    s_add_u32 m0, s48, 4096
    s_add_u32 s76, s76, 32768
    buffer_load_dwordx4 v56, s[56:59], s76 offen offset:0 lds
    buffer_load_dwordx4 v57, s[56:59], s76 offen offset:1024 lds
    buffer_load_dwordx4 v58, s[56:59], s76 offen offset:2048 lds
    buffer_load_dwordx4 v59, s[56:59], s76 offen offset:3072 lds
    s_mov_b32 m0, s60
    s_and_b32 s67, s31, 3
    s_lshl_b32 s67, s67, 1
    s_sub_u32 s67, s67, 1
    s_add_u32 s67, s67, 1
    s_and_b32 s67, s67, 7
    s_lshl_b32 s34, s67, 11
    s_add_u32 m0, s34, s60
    s_lshl_b32 s34, s67, 14
    s_add_u32 s34, s34, s99
    s_cmp_lg_u32 s85, 0
    s_cbranch_scc1 A_short
    s_waitcnt lgkmcnt(3)
    v_mfma_f32_32x32x16_bf16 v[128:143], v[200:203], v[192:195], v[176:191]
    s_mov_b32 s84, 6
    buffer_load_dwordx4 v56, s[80:83], s34 offen lds
    buffer_load_dwordx4 v57, s[80:83], s34 offen offset:1024 lds
    s_add_u32 s67, s67, 1
    s_and_b32 s67, s67, 7
    s_lshl_b32 s34, s67, 11
    s_add_u32 m0, s34, s60
    s_lshl_b32 s34, s67, 14
    s_add_u32 s34, s34, s99
    s_nop 2
    v_exp_f32 v128, v128
    v_exp_f32 v129, v129
    ds_read_b128 v[200:203], v6 offset:1024
    ds_read_b128 v[216:219], v9 offset:0
    ds_read_b128 v[220:223], v9 offset:1024
    v_exp_f32 v130, v130
    v_exp_f32 v131, v131
    v_exp_f32 v132, v132
    v_exp_f32 v133, v133
    v_cvt_pk_bf16_f32 v224, v128, v129
    v_cvt_pk_bf16_f32 v225, v130, v131
    s_waitcnt lgkmcnt(3)
    v_mfma_f32_32x32x16_bf16 v[144:159], v[204:207], v[196:199], v[176:191]
    v_exp_f32 v134, v134
    v_exp_f32 v135, v135
    v_exp_f32 v136, v136
    v_exp_f32 v137, v137
    v_cvt_pk_bf16_f32 v226, v132, v133
    v_cvt_pk_bf16_f32 v227, v134, v135
    v_exp_f32 v138, v138
    v_exp_f32 v139, v139
    v_mfma_f32_32x32x16_bf16 v[232:247], v[208:211], v[224:227], 0
    v_exp_f32 v140, v140
    v_exp_f32 v141, v141
    v_cvt_pk_bf16_f32 v228, v136, v137
    v_cvt_pk_bf16_f32 v229, v138, v139
    v_exp_f32 v142, v142
    v_exp_f32 v143, v143
    v_add_u32 v9, v26, v9
    v_cvt_pk_bf16_f32 v230, v140, v141
    v_cvt_pk_bf16_f32 v231, v142, v143
    v_exp_f32 v144, v144
    v_exp_f32 v145, v145
    v_mfma_f32_32x32x16_bf16 v[232:247], v[212:215], v[228:231], v[232:247]
    ds_read_b128 v[204:207], v6 offset:13312
    ds_read_b128 v[208:211], v7 offset:2048
    ds_read_b128 v[212:215], v7 offset:3072
    v_exp_f32 v146, v146
    v_exp_f32 v147, v147
    v_exp_f32 v148, v148
    v_exp_f32 v149, v149
    v_cvt_pk_bf16_f32 v224, v144, v145
    v_cvt_pk_bf16_f32 v225, v146, v147
    s_waitcnt lgkmcnt(3)
    v_mfma_f32_32x32x16_bf16 v[128:143], v[200:203], v[192:195], 0
    v_exp_f32 v150, v150
    v_exp_f32 v151, v151
    v_exp_f32 v152, v152
    v_exp_f32 v153, v153
    v_cvt_pk_bf16_f32 v226, v148, v149
    v_cvt_pk_bf16_f32 v227, v150, v151
    v_exp_f32 v154, v154
    v_exp_f32 v155, v155
    v_mfma_f32_32x32x16_bf16 v[64:79], v[216:219], v[224:227], 0
    v_exp_f32 v156, v156
    v_exp_f32 v157, v157
    v_cvt_pk_bf16_f32 v228, v152, v153
    v_cvt_pk_bf16_f32 v229, v154, v155
    v_exp_f32 v158, v158
    v_exp_f32 v159, v159
    v_add_u32 v6, 1024, v6
    v_add_u32 v7, v10, v7
    v_cvt_pk_bf16_f32 v230, v156, v157
    v_cvt_pk_bf16_f32 v231, v158, v159
A_mid:
    v_exp_f32 v128, v128
    v_exp_f32 v129, v129
    v_mfma_f32_32x32x16_bf16 v[64:79], v[220:223], v[228:231], v[64:79]
    ds_read_b128 v[200:203], v6 offset:1024
    ds_read_b128 v[216:219], v9 offset:0
    ds_read_b128 v[220:223], v9 offset:1024
    v_exp_f32 v130, v130
    v_exp_f32 v131, v131
    v_exp_f32 v132, v132
    v_exp_f32 v133, v133
    v_cvt_pk_bf16_f32 v224, v128, v129
    v_cvt_pk_bf16_f32 v225, v130, v131
    s_waitcnt lgkmcnt(3)
    v_mfma_f32_32x32x16_bf16 v[144:159], v[204:207], v[196:199], 0
    v_exp_f32 v134, v134
    v_exp_f32 v135, v135
    v_exp_f32 v136, v136
    v_exp_f32 v137, v137
    v_cvt_pk_bf16_f32 v226, v132, v133
    v_cvt_pk_bf16_f32 v227, v134, v135
    v_exp_f32 v138, v138
    v_exp_f32 v139, v139
    v_mfma_f32_32x32x16_bf16 v[232:247], v[208:211], v[224:227], v[232:247]
    buffer_load_dwordx4 v56, s[80:83], s34 offen lds
    buffer_load_dwordx4 v57, s[80:83], s34 offen offset:1024 lds
    s_add_u32 s67, s67, 1
    s_and_b32 s67, s67, 7
    s_lshl_b32 s34, s67, 11
    s_add_u32 m0, s34, s60
    s_lshl_b32 s34, s67, 14
    s_add_u32 s34, s34, s99
    v_exp_f32 v140, v140
    v_exp_f32 v141, v141
    v_cvt_pk_bf16_f32 v228, v136, v137
    v_cvt_pk_bf16_f32 v229, v138, v139
    v_exp_f32 v142, v142
    v_exp_f32 v143, v143
    v_add_u32 v9, v26, v9
    v_cvt_pk_bf16_f32 v230, v140, v141
    v_cvt_pk_bf16_f32 v231, v142, v143
    v_exp_f32 v144, v144
    v_exp_f32 v145, v145
    v_mfma_f32_32x32x16_bf16 v[232:247], v[212:215], v[228:231], v[232:247]
    ds_read_b128 v[204:207], v6 offset:13312
    ds_read_b128 v[208:211], v7 offset:2048
    ds_read_b128 v[212:215], v7 offset:3072
    v_exp_f32 v146, v146
    v_exp_f32 v147, v147
    v_exp_f32 v148, v148
    v_exp_f32 v149, v149
    v_cvt_pk_bf16_f32 v224, v144, v145
    v_cvt_pk_bf16_f32 v225, v146, v147
    s_waitcnt lgkmcnt(3)
    v_mfma_f32_32x32x16_bf16 v[128:143], v[200:203], v[192:195], 0
    v_exp_f32 v150, v150
    v_exp_f32 v151, v151
    v_exp_f32 v152, v152
    v_exp_f32 v153, v153
    v_cvt_pk_bf16_f32 v226, v148, v149
    v_cvt_pk_bf16_f32 v227, v150, v151
    v_exp_f32 v154, v154
    v_exp_f32 v155, v155
    v_mfma_f32_32x32x16_bf16 v[64:79], v[216:219], v[224:227], v[64:79]
    s_cmp_lg_u32 s84, 6
    s_cbranch_scc1 L_ph_13
    s_waitcnt vmcnt(14)
    s_mov_b64 exec, 0xffff
    buffer_store_dwordx2 v[4:5], v3, s[20:23], s51 offen sc1
    s_mov_b64 exec, -1
L_ph_13:
    v_exp_f32 v156, v156
    v_exp_f32 v157, v157
    v_cvt_pk_bf16_f32 v228, v152, v153
    v_cvt_pk_bf16_f32 v229, v154, v155
    v_exp_f32 v158, v158
    v_exp_f32 v159, v159
    v_add_u32 v6, 1024, v6
    v_add_u32 v7, v10, v7
    v_cvt_pk_bf16_f32 v230, v156, v157
    v_cvt_pk_bf16_f32 v231, v158, v159
    s_sub_u32 s84, s84, 1
    s_cmp_lg_u32 s84, 0
    s_cbranch_scc1 A_mid
A_b7:
    v_exp_f32 v128, v128
    v_exp_f32 v129, v129
    v_mfma_f32_32x32x16_bf16 v[64:79], v[220:223], v[228:231], v[64:79]
    ds_read_b128 v[200:203], v6 offset:1024
    ds_read_b128 v[216:219], v9 offset:0
    ds_read_b128 v[220:223], v9 offset:1024
    v_exp_f32 v130, v130
    v_exp_f32 v131, v131
    v_exp_f32 v132, v132
    v_exp_f32 v133, v133
    v_cvt_pk_bf16_f32 v224, v128, v129
    v_cvt_pk_bf16_f32 v225, v130, v131
    s_waitcnt lgkmcnt(3)
    v_mfma_f32_32x32x16_bf16 v[144:159], v[204:207], v[196:199], 0
    v_exp_f32 v134, v134
    v_exp_f32 v135, v135
    v_exp_f32 v136, v136
    v_exp_f32 v137, v137
    v_cvt_pk_bf16_f32 v226, v132, v133
    v_cvt_pk_bf16_f32 v227, v134, v135
    v_exp_f32 v138, v138
    v_exp_f32 v139, v139
    v_mfma_f32_32x32x16_bf16 v[232:247], v[208:211], v[224:227], v[232:247]
    buffer_load_dwordx4 v56, s[80:83], s34 offen lds
    buffer_load_dwordx4 v57, s[80:83], s34 offen offset:1024 lds
    s_add_u32 s67, s67, 1
    s_and_b32 s67, s67, 7
    s_lshl_b32 s34, s67, 11
    s_add_u32 m0, s34, s60
    s_lshl_b32 s34, s67, 14
    s_add_u32 s34, s34, s99
    s_bfe_u32 s78, s75, 0x80000
    s_lshl_b32 s78, s78, 10
    s_add_u32 s79, s78, s89
    s_add_u32 s78, s78, s88
    buffer_load_dwordx4 v[80:83], v2, s[20:23], s78 offen offset:0 sc1
    buffer_load_dwordx4 v[84:87], v2, s[20:23], s79 offen offset:0 sc1
    v_exp_f32 v140, v140
    v_exp_f32 v141, v141
    v_cvt_pk_bf16_f32 v228, v136, v137
    v_cvt_pk_bf16_f32 v229, v138, v139
    v_exp_f32 v142, v142
    v_exp_f32 v143, v143
    v_add_u32 v9, v26, v9
    v_cvt_pk_bf16_f32 v230, v140, v141
    v_cvt_pk_bf16_f32 v231, v142, v143
    v_exp_f32 v144, v144
    v_exp_f32 v145, v145
    v_mfma_f32_32x32x16_bf16 v[232:247], v[212:215], v[228:231], v[232:247]
    ds_read_b128 v[204:207], v6 offset:13312
    ds_read_b128 v[208:211], v7 offset:2048
    ds_read_b128 v[212:215], v7 offset:3072
    v_exp_f32 v146, v146
    v_exp_f32 v147, v147
    v_exp_f32 v148, v148
    v_exp_f32 v149, v149
    v_cvt_pk_bf16_f32 v224, v144, v145
    v_cvt_pk_bf16_f32 v225, v146, v147
    s_waitcnt lgkmcnt(3)
    v_mfma_f32_32x32x16_bf16 v[128:143], v[200:203], v[192:195], v[160:175]
    v_exp_f32 v150, v150
    v_exp_f32 v151, v151
    v_exp_f32 v152, v152
    v_exp_f32 v153, v153
    v_cvt_pk_bf16_f32 v226, v148, v149
    v_cvt_pk_bf16_f32 v227, v150, v151
    v_exp_f32 v154, v154
    v_exp_f32 v155, v155
    v_mfma_f32_32x32x16_bf16 v[64:79], v[216:219], v[224:227], v[64:79]
    buffer_load_dwordx4 v[88:91], v2, s[20:23], s78 offen offset:1024 sc1
    buffer_load_dwordx4 v[92:95], v2, s[20:23], s79 offen offset:1024 sc1
    buffer_load_dwordx4 v[96:99], v2, s[20:23], s78 offen offset:2048 sc1
    buffer_load_dwordx4 v[100:103], v2, s[20:23], s79 offen offset:2048 sc1
    v_exp_f32 v156, v156
    v_exp_f32 v157, v157
    v_cvt_pk_bf16_f32 v228, v152, v153
    v_cvt_pk_bf16_f32 v229, v154, v155
    v_exp_f32 v158, v158
    v_exp_f32 v159, v159
    v_add_u32 v6, 1024, v6
    v_add_u32 v7, v10, v7
    v_cvt_pk_bf16_f32 v230, v156, v157
    v_cvt_pk_bf16_f32 v231, v158, v159
A_b8:
    v_exp_f32 v128, v128
    v_exp_f32 v129, v129
    v_mfma_f32_32x32x16_bf16 v[64:79], v[220:223], v[228:231], v[64:79]
    ds_read_b128 v[216:219], v9 offset:0
    ds_read_b128 v[220:223], v9 offset:1024
    v_exp_f32 v130, v130
    v_exp_f32 v131, v131
    v_exp_f32 v132, v132
    v_exp_f32 v133, v133
    v_cvt_pk_bf16_f32 v224, v128, v129
    v_cvt_pk_bf16_f32 v225, v130, v131
    s_waitcnt lgkmcnt(2)
    v_mfma_f32_32x32x16_bf16 v[144:159], v[204:207], v[196:199], v[160:175]
    v_exp_f32 v134, v134
    v_exp_f32 v135, v135
    v_exp_f32 v136, v136
    v_exp_f32 v137, v137
    v_cvt_pk_bf16_f32 v226, v132, v133
    v_cvt_pk_bf16_f32 v227, v134, v135
    v_exp_f32 v138, v138
    v_exp_f32 v139, v139
    v_mfma_f32_32x32x16_bf16 v[232:247], v[208:211], v[224:227], v[232:247]
    s_mov_b64 exec, 0xff
    buffer_load_dwordx2 v[24:25], v31, s[20:23], s92 offen sc1
    s_mov_b64 exec, -1
    buffer_load_dwordx4 v[104:107], v2, s[20:23], s78 offen offset:3072 sc1
    buffer_load_dwordx4 v[108:111], v2, s[20:23], s79 offen offset:3072 sc1
    s_bfe_u32 s78, s75, 0x80008
    s_lshl_b32 s78, s78, 10
    s_add_u32 s79, s78, s89
    s_add_u32 s78, s78, s88
    buffer_load_dwordx4 v[112:115], v2, s[20:23], s78 offen offset:0 sc1
    buffer_load_dwordx4 v[116:119], v2, s[20:23], s79 offen offset:0 sc1
    v_exp_f32 v140, v140
    v_exp_f32 v141, v141
    v_cvt_pk_bf16_f32 v228, v136, v137
    v_cvt_pk_bf16_f32 v229, v138, v139
    v_exp_f32 v142, v142
    v_exp_f32 v143, v143
    v_cvt_pk_bf16_f32 v230, v140, v141
    v_cvt_pk_bf16_f32 v231, v142, v143
    v_exp_f32 v144, v144
    v_exp_f32 v145, v145
    v_mfma_f32_32x32x16_bf16 v[232:247], v[212:215], v[228:231], v[232:247]
    v_exp_f32 v146, v146
    v_exp_f32 v147, v147
    v_exp_f32 v148, v148
    v_exp_f32 v149, v149
    v_cvt_pk_bf16_f32 v224, v144, v145
    v_cvt_pk_bf16_f32 v225, v146, v147
    s_waitcnt lgkmcnt(0)
    v_exp_f32 v150, v150
    v_exp_f32 v151, v151
    v_exp_f32 v152, v152
    v_exp_f32 v153, v153
    v_cvt_pk_bf16_f32 v226, v148, v149
    v_cvt_pk_bf16_f32 v227, v150, v151
    v_exp_f32 v154, v154
    v_exp_f32 v155, v155
    v_mfma_f32_32x32x16_bf16 v[64:79], v[216:219], v[224:227], v[64:79]
    buffer_load_dwordx4 v[120:123], v2, s[20:23], s78 offen offset:1024 sc1
    buffer_load_dwordx4 v[124:127], v2, s[20:23], s79 offen offset:1024 sc1
    buffer_load_dwordx4 a[16:19], v2, s[20:23], s78 offen offset:2048 sc1
    buffer_load_dwordx4 a[20:23], v2, s[20:23], s79 offen offset:2048 sc1
    v_exp_f32 v156, v156
    v_exp_f32 v157, v157
    v_cvt_pk_bf16_f32 v228, v152, v153
    v_cvt_pk_bf16_f32 v229, v154, v155
    v_exp_f32 v158, v158
    v_exp_f32 v159, v159
    v_cvt_pk_bf16_f32 v230, v156, v157
    v_cvt_pk_bf16_f32 v231, v158, v159
    buffer_load_dwordx4 a[24:27], v2, s[20:23], s78 offen offset:3072 sc1
    buffer_load_dwordx4 a[28:31], v2, s[20:23], s79 offen offset:3072 sc1
    v_mfma_f32_32x32x16_bf16 v[64:79], v[220:223], v[228:231], v[64:79]
    s_mul_i32 s3, s28, 147456
    s_lshl_b32 s4, s27, 11
    s_add_u32 s3, s3, s4
    s_add_u32 s61, s3, 114688
    v_mov_b32 v218, 0x1f800000
    v_mov_b32 v219, 0x5f800000
    v_mov_b32 v60, 0x1f8
    v_pk_add_f32 v[208:209], v[232:233], v[234:235]
    v_pk_add_f32 v[210:211], v[236:237], v[238:239]
    v_cmp_le_f32 vcc, v218, v240
    v_cmp_ge_f32 s[4:5], v219, v240
    v_rcp_f32 v216, v240
    v_pk_add_f32 v[208:209], v[208:209], v[210:211]
    s_and_b64 vcc, vcc, s[4:5]
    v_pk_add_f32 v[212:213], v[72:73], v[74:75]
    v_pk_add_f32 v[214:215], v[76:77], v[78:79]
    v_cmp_le_f32 s[6:7], v218, v64
    v_cmp_ge_f32 s[4:5], v219, v64
    v_pk_add_f32 v[212:213], v[212:213], v[214:215]
    v_rcp_f32 v217, v64
    v_pk_add_f32 v[208:209], v[208:209], v[212:213]
    s_and_b64 vcc, vcc, s[6:7]
    s_and_b64 s[6:7], vcc, s[4:5]
    v_add_f32 v208, v208, v209
    v_cmp_class_f32 vcc, v208, v60
    s_nop 0
    s_and_b64 vcc, vcc, s[6:7]
    s_cmp_eq_u64 vcc, -1
    s_cbranch_scc0 A_fb
A_fin2:
    s_waitcnt vmcnt(10)
    v_cmp_eq_u64 vcc, v[24:25], v[4:5]
    s_nop 0
    s_and_b64 vcc, vcc, s[86:87]
    s_cmp_eq_u64 vcc, s[86:87]
    s_cbranch_scc1 L_polld_15
    s_mov_b32 s93, 0x20000
L_poll_14:
    s_mov_b64 exec, 0xff
    buffer_load_dwordx2 v[24:25], v31, s[20:23], s92 offen sc1
    s_mov_b64 exec, -1
    s_waitcnt vmcnt(0)
    v_cmp_eq_u64 vcc, v[24:25], v[4:5]
    s_nop 0
    s_and_b64 vcc, vcc, s[86:87]
    s_cmp_eq_u64 vcc, s[86:87]
    s_cbranch_scc1 L_polld_15
    s_sub_u32 s93, s93, 1
    s_cmp_lg_u32 s93, 0
    s_cbranch_scc1 L_poll_14
L_polld_15:
    s_bfe_u32 s78, s75, 0x80010
    s_lshl_b32 s78, s78, 10
    s_add_u32 s79, s78, s89
    s_add_u32 s78, s78, s88
    buffer_load_dwordx4 v[176:179], v2, s[20:23], s78 offen offset:0 sc1
    buffer_load_dwordx4 v[180:183], v2, s[20:23], s79 offen offset:0 sc1
A_have:
    s_waitcnt vmcnt(16)
    v_mfma_f32_32x32x16_bf16 v[128:143], a[32:35], v[80:83], 0
    buffer_load_dwordx4 v[184:187], v2, s[20:23], s78 offen offset:1024 sc1
    buffer_load_dwordx4 v[188:191], v2, s[20:23], s79 offen offset:1024 sc1
    v_mul_f32 v232, v232, v216
    v_mul_f32 v233, v233, v216
    v_mul_f32 v234, v234, v216
    v_mul_f32 v235, v235, v216
    v_mul_f32 v236, v236, v216
    v_mfma_f32_32x32x16_bf16 v[160:175], a[32:35], v[84:87], 0
    buffer_load_dwordx4 a[0:3], v2, s[20:23], s78 offen offset:2048 sc1
    buffer_load_dwordx4 a[4:7], v2, s[20:23], s79 offen offset:2048 sc1
    v_mul_f32 v237, v237, v216
    v_mul_f32 v238, v238, v216
    v_mul_f32 v239, v239, v216
    v_cvt_pk_bf16_f32 v208, v232, v233
    v_cvt_pk_bf16_f32 v209, v234, v235
    v_mfma_f32_32x32x16_bf16 v[144:159], a[36:39], v[80:83], 0
    buffer_load_dwordx4 a[8:11], v2, s[20:23], s78 offen offset:3072 sc1
    buffer_load_dwordx4 a[12:15], v2, s[20:23], s79 offen offset:3072 sc1
    v_cvt_pk_bf16_f32 v210, v236, v237
    v_cvt_pk_bf16_f32 v211, v238, v239
    v_mfma_f32_32x32x16_bf16 v[192:207], a[36:39], v[84:87], 0
    buffer_store_dwordx4 v[208:211], v2, s[20:23], s61 offen offset:0 sc1
    s_bfe_u32 s78, s75, 0x80018
    s_lshl_b32 s78, s78, 10
    s_add_u32 s79, s78, s89
    s_add_u32 s78, s78, s88
    buffer_load_dwordx4 v[248:251], v2, s[20:23], s78 offen offset:0 sc1
    buffer_load_dwordx4 v[252:255], v2, s[20:23], s79 offen offset:0 sc1
    v_mul_f32 v72, v72, v217
    v_mul_f32 v73, v73, v217
    v_mul_f32 v74, v74, v217
    v_mul_f32 v75, v75, v217
    v_mul_f32 v76, v76, v217
    s_waitcnt vmcnt(23)
    v_mfma_f32_32x32x16_bf16 v[128:143], a[40:43], v[88:91], v[128:143]
    buffer_load_dwordx4 v[32:35], v2, s[20:23], s78 offen offset:1024 sc1
    buffer_load_dwordx4 v[36:39], v2, s[20:23], s79 offen offset:1024 sc1
    v_mul_f32 v77, v77, v217
    v_mul_f32 v78, v78, v217
    v_mul_f32 v79, v79, v217
    v_cvt_pk_bf16_f32 v212, v72, v73
    v_cvt_pk_bf16_f32 v213, v74, v75
    v_mfma_f32_32x32x16_bf16 v[160:175], a[40:43], v[92:95], v[160:175]
    v_cvt_pk_bf16_f32 v214, v76, v77
    v_cvt_pk_bf16_f32 v215, v78, v79
    v_mfma_f32_32x32x16_bf16 v[144:159], a[44:47], v[88:91], v[144:159]
    buffer_store_dwordx4 v[212:215], v2, s[20:23], s61 offen offset:1024 sc1
    ds_read_b64_tr_b16 a[224:225], v8 offset:0
    ds_read_b64_tr_b16 a[226:227], v8 offset:1024
    v_mfma_f32_32x32x16_bf16 v[192:207], a[44:47], v[92:95], v[192:207]
    ds_read_b64_tr_b16 a[228:229], v11 offset:0
    ds_read_b64_tr_b16 a[230:231], v11 offset:1024
    s_waitcnt vmcnt(24)
    v_mfma_f32_32x32x16_bf16 v[128:143], a[48:51], v[96:99], v[128:143]
    ds_read_b64_tr_b16 a[232:233], v8 offset:2048
    ds_read_b64_tr_b16 a[234:235], v8 offset:3072
    v_mfma_f32_32x32x16_bf16 v[160:175], a[48:51], v[100:103], v[160:175]
    ds_read_b64_tr_b16 a[236:237], v11 offset:2048
    ds_read_b64_tr_b16 a[238:239], v11 offset:3072
    v_mfma_f32_32x32x16_bf16 v[144:159], a[52:55], v[96:99], v[144:159]
    ds_read_b64_tr_b16 a[240:241], v8 offset:4096
    ds_read_b64_tr_b16 a[242:243], v8 offset:5120
    v_mfma_f32_32x32x16_bf16 v[192:207], a[52:55], v[100:103], v[192:207]
    ds_read_b64_tr_b16 a[244:245], v11 offset:4096
    ds_read_b64_tr_b16 a[246:247], v11 offset:5120
    s_waitcnt vmcnt(22)
    v_mfma_f32_32x32x16_bf16 v[128:143], a[56:59], v[104:107], v[128:143]
    ds_read_b64_tr_b16 a[248:249], v8 offset:6144
    ds_read_b64_tr_b16 a[250:251], v8 offset:7168
    v_mfma_f32_32x32x16_bf16 v[160:175], a[56:59], v[108:111], v[160:175]
    ds_read_b64_tr_b16 a[252:253], v11 offset:6144
    ds_read_b64_tr_b16 a[254:255], v11 offset:7168
    s_sub_u32 s3, s60, s48
    v_add_u32 v8, s3, v8
    v_add_u32 v11, s3, v11
    v_lshlrev_b32 v64, 16, v48
    v_and_b32 v65, s50, v48
    v_mfma_f32_32x32x16_bf16 v[144:159], a[60:63], v[104:107], v[144:159]
    v_lshlrev_b32 v66, 16, v49
    v_and_b32 v67, s50, v49
    v_lshlrev_b32 v68, 16, v50
    v_and_b32 v69, s50, v50
    v_lshlrev_b32 v70, 16, v51
    v_mfma_f32_32x32x16_bf16 v[192:207], a[60:63], v[108:111], v[192:207]
    v_and_b32 v71, s50, v51
    v_lshlrev_b32 v72, 16, v52
    v_and_b32 v73, s50, v52
    v_lshlrev_b32 v74, 16, v53
    v_and_b32 v75, s50, v53
    s_waitcnt vmcnt(20)
    v_mfma_f32_32x32x16_bf16 v[128:143], a[64:67], v[112:115], v[128:143]
    v_lshlrev_b32 v76, 16, v54
    v_and_b32 v77, s50, v54
    v_lshlrev_b32 v78, 16, v55
    v_and_b32 v79, s50, v55
    s_xor_b32 s3, s24, 1
    s_lshl_b32 s3, s3, 14
    v_add_u32 v57, s3, v2
    v_mfma_f32_32x32x16_bf16 v[160:175], a[64:67], v[116:119], v[160:175]
    s_xor_b32 s3, s24, 2
    s_lshl_b32 s3, s3, 14
    v_add_u32 v58, s3, v2
    s_xor_b32 s3, s24, 3
    s_lshl_b32 s3, s3, 14
    v_add_u32 v59, s3, v2
    v_add_u32 v56, s60, v2
    v_mfma_f32_32x32x16_bf16 v[144:159], a[68:71], v[112:115], v[144:159]
    v_mfma_f32_32x32x16_bf16 v[192:207], a[68:71], v[116:119], v[192:207]
    s_waitcnt vmcnt(0)
    s_lshl_b32 s3, s28, 11
    s_lshl_b32 s4, s27, 7
    s_add_u32 s3, s3, s4
    s_add_u32 s3, s3, 0xf70000
    s_mov_b64 exec, 0xffff
    buffer_store_dwordx2 v[4:5], v3, s[20:23], s3 offen sc1
    s_mov_b64 exec, -1
    v_mfma_f32_32x32x16_bf16 v[128:143], a[72:75], v[120:123], v[128:143]
    v_mfma_f32_32x32x16_bf16 v[160:175], a[72:75], v[124:127], v[160:175]
    v_mfma_f32_32x32x16_bf16 v[144:159], a[76:79], v[120:123], v[144:159]
    v_mfma_f32_32x32x16_bf16 v[192:207], a[76:79], v[124:127], v[192:207]
    v_mfma_f32_32x32x16_bf16 v[128:143], a[80:83], a[16:19], v[128:143]
    v_mfma_f32_32x32x16_bf16 v[160:175], a[80:83], a[20:23], v[160:175]
    v_mfma_f32_32x32x16_bf16 v[144:159], a[84:87], a[16:19], v[144:159]
    v_mfma_f32_32x32x16_bf16 v[192:207], a[84:87], a[20:23], v[192:207]
    v_mfma_f32_32x32x16_bf16 v[128:143], a[88:91], a[24:27], v[128:143]
    buffer_load_dwordx4 v[40:43], v2, s[20:23], s78 offen offset:2048 sc1
    buffer_load_dwordx4 v[44:47], v2, s[20:23], s79 offen offset:2048 sc1
    v_mfma_f32_32x32x16_bf16 v[160:175], a[88:91], a[28:31], v[160:175]
    v_mfma_f32_32x32x16_bf16 v[144:159], a[92:95], a[24:27], v[144:159]
    v_mfma_f32_32x32x16_bf16 v[192:207], a[92:95], a[28:31], v[192:207]
    v_mfma_f32_32x32x16_bf16 v[128:143], a[96:99], v[176:179], v[128:143]
    s_bfe_u32 s78, s75, 0x80018
    s_lshl_b32 s78, s78, 10
    s_add_u32 s79, s78, s89
    s_add_u32 s78, s78, s88
    buffer_load_dwordx4 v[80:83], v2, s[20:23], s78 offen offset:3072 sc1
    buffer_load_dwordx4 v[84:87], v2, s[20:23], s79 offen offset:3072 sc1
    v_mfma_f32_32x32x16_bf16 v[160:175], a[96:99], v[180:183], v[160:175]
    v_mfma_f32_32x32x16_bf16 v[144:159], a[100:103], v[176:179], v[144:159]
    v_mfma_f32_32x32x16_bf16 v[192:207], a[100:103], v[180:183], v[192:207]
    v_mfma_f32_32x32x16_bf16 v[128:143], a[104:107], v[184:187], v[128:143]
    s_bfe_u32 s78, s49, 0x80000
    s_lshl_b32 s78, s78, 10
    s_add_u32 s79, s78, s89
    s_add_u32 s78, s78, s88
    buffer_load_dwordx4 v[88:91], v2, s[20:23], s78 offen offset:0 sc1
    buffer_load_dwordx4 v[92:95], v2, s[20:23], s79 offen offset:0 sc1
    v_mfma_f32_32x32x16_bf16 v[160:175], a[104:107], v[188:191], v[160:175]
    v_mfma_f32_32x32x16_bf16 v[144:159], a[108:111], v[184:187], v[144:159]
    v_mfma_f32_32x32x16_bf16 v[192:207], a[108:111], v[188:191], v[192:207]
    v_mfma_f32_32x32x16_bf16 v[128:143], a[112:115], a[0:3], v[128:143]
    buffer_load_dwordx4 v[96:99], v2, s[20:23], s78 offen offset:1024 sc1
    buffer_load_dwordx4 v[100:103], v2, s[20:23], s79 offen offset:1024 sc1
    ds_read_b64_tr_b16 a[32:33], v8 offset:0
    ds_read_b64_tr_b16 a[34:35], v8 offset:1024
    v_mfma_f32_32x32x16_bf16 v[160:175], a[112:115], a[4:7], v[160:175]
    ds_read_b64_tr_b16 a[36:37], v11 offset:0
    ds_read_b64_tr_b16 a[38:39], v11 offset:1024
    v_mfma_f32_32x32x16_bf16 v[144:159], a[116:119], a[0:3], v[144:159]
    ds_read_b64_tr_b16 a[40:41], v8 offset:2048
    ds_read_b64_tr_b16 a[42:43], v8 offset:3072
    v_mfma_f32_32x32x16_bf16 v[192:207], a[116:119], a[4:7], v[192:207]
    ds_read_b64_tr_b16 a[44:45], v11 offset:2048
    ds_read_b64_tr_b16 a[46:47], v11 offset:3072
    v_mfma_f32_32x32x16_bf16 v[128:143], a[120:123], a[8:11], v[128:143]
    buffer_load_dwordx4 v[104:107], v2, s[20:23], s78 offen offset:2048 sc1
    buffer_load_dwordx4 v[108:111], v2, s[20:23], s79 offen offset:2048 sc1
    ds_read_b64_tr_b16 a[48:49], v8 offset:4096
    ds_read_b64_tr_b16 a[50:51], v8 offset:5120
    v_mfma_f32_32x32x16_bf16 v[160:175], a[120:123], a[12:15], v[160:175]
    ds_read_b64_tr_b16 a[52:53], v11 offset:4096
    ds_read_b64_tr_b16 a[54:55], v11 offset:5120
    v_mfma_f32_32x32x16_bf16 v[144:159], a[124:127], a[8:11], v[144:159]
    ds_read_b64_tr_b16 a[56:57], v8 offset:6144
    ds_read_b64_tr_b16 a[58:59], v8 offset:7168
    v_mfma_f32_32x32x16_bf16 v[192:207], a[124:127], a[12:15], v[192:207]
    ds_read_b64_tr_b16 a[60:61], v11 offset:6144
    ds_read_b64_tr_b16 a[62:63], v11 offset:7168
    v_mfma_f32_32x32x16_bf16 v[128:143], a[128:131], v[248:251], v[128:143]
    buffer_load_dwordx4 v[112:115], v2, s[20:23], s78 offen offset:3072 sc1
    buffer_load_dwordx4 v[116:119], v2, s[20:23], s79 offen offset:3072 sc1
    ds_read_b64_tr_b16 a[64:65], v8 offset:8192
    ds_read_b64_tr_b16 a[66:67], v8 offset:9216
    v_mfma_f32_32x32x16_bf16 v[160:175], a[128:131], v[252:255], v[160:175]
    ds_read_b64_tr_b16 a[68:69], v11 offset:8192
    ds_read_b64_tr_b16 a[70:71], v11 offset:9216
    v_mfma_f32_32x32x16_bf16 v[144:159], a[132:135], v[248:251], v[144:159]
    ds_read_b64_tr_b16 a[72:73], v8 offset:10240
    ds_read_b64_tr_b16 a[74:75], v8 offset:11264
    v_mfma_f32_32x32x16_bf16 v[192:207], a[132:135], v[252:255], v[192:207]
    ds_read_b64_tr_b16 a[76:77], v11 offset:10240
    ds_read_b64_tr_b16 a[78:79], v11 offset:11264
    v_mfma_f32_32x32x16_bf16 v[128:143], a[136:139], v[32:35], v[128:143]
    s_bfe_u32 s78, s49, 0x80008
    s_lshl_b32 s78, s78, 10
    s_add_u32 s79, s78, s89
    s_add_u32 s78, s78, s88
    buffer_load_dwordx4 v[120:123], v2, s[20:23], s78 offen offset:0 sc1
    buffer_load_dwordx4 v[124:127], v2, s[20:23], s79 offen offset:0 sc1
    ds_read_b64_tr_b16 a[80:81], v8 offset:12288
    ds_read_b64_tr_b16 a[82:83], v8 offset:13312
    v_mfma_f32_32x32x16_bf16 v[160:175], a[136:139], v[36:39], v[160:175]
    ds_read_b64_tr_b16 a[84:85], v11 offset:12288
    ds_read_b64_tr_b16 a[86:87], v11 offset:13312
    v_mfma_f32_32x32x16_bf16 v[144:159], a[140:143], v[32:35], v[144:159]
    ds_read_b64_tr_b16 a[88:89], v8 offset:14336
    ds_read_b64_tr_b16 a[90:91], v8 offset:15360
    v_mfma_f32_32x32x16_bf16 v[192:207], a[140:143], v[36:39], v[192:207]
    ds_read_b64_tr_b16 a[92:93], v11 offset:14336
    ds_read_b64_tr_b16 a[94:95], v11 offset:15360
    s_waitcnt vmcnt(12)
    v_mfma_f32_32x32x16_bf16 v[128:143], a[144:147], v[40:43], v[128:143]
    v_mfma_f32_32x32x16_bf16 v[160:175], a[144:147], v[44:47], v[160:175]
    v_mfma_f32_32x32x16_bf16 v[144:159], a[148:151], v[40:43], v[144:159]
    v_mfma_f32_32x32x16_bf16 v[192:207], a[148:151], v[44:47], v[192:207]
    s_waitcnt vmcnt(10)
    v_mfma_f32_32x32x16_bf16 v[128:143], a[152:155], v[80:83], v[128:143]
    v_mfma_f32_32x32x16_bf16 v[160:175], a[152:155], v[84:87], v[160:175]
    v_mfma_f32_32x32x16_bf16 v[144:159], a[156:159], v[80:83], v[144:159]
    v_mfma_f32_32x32x16_bf16 v[192:207], a[156:159], v[84:87], v[192:207]
    s_waitcnt vmcnt(8)
    v_mfma_f32_32x32x16_bf16 v[128:143], a[160:163], v[88:91], v[128:143]
    buffer_load_dwordx4 v[80:83], v2, s[20:23], s78 offen offset:1024 sc1
    buffer_load_dwordx4 v[84:87], v2, s[20:23], s79 offen offset:1024 sc1
    v_mfma_f32_32x32x16_bf16 v[160:175], a[160:163], v[92:95], v[160:175]
    v_mfma_f32_32x32x16_bf16 v[144:159], a[164:167], v[88:91], v[144:159]
    v_mfma_f32_32x32x16_bf16 v[192:207], a[164:167], v[92:95], v[192:207]
    s_waitcnt vmcnt(8)
    v_mfma_f32_32x32x16_bf16 v[128:143], a[168:171], v[96:99], v[128:143]
    buffer_load_dwordx4 v[88:91], v2, s[20:23], s78 offen offset:2048 sc1
    buffer_load_dwordx4 v[92:95], v2, s[20:23], s79 offen offset:2048 sc1
    v_mfma_f32_32x32x16_bf16 v[160:175], a[168:171], v[100:103], v[160:175]
    v_mfma_f32_32x32x16_bf16 v[144:159], a[172:175], v[96:99], v[144:159]
    v_mfma_f32_32x32x16_bf16 v[192:207], a[172:175], v[100:103], v[192:207]
    s_waitcnt vmcnt(8)
    v_mfma_f32_32x32x16_bf16 v[128:143], a[176:179], v[104:107], v[128:143]
    buffer_load_dwordx4 v[96:99], v2, s[20:23], s78 offen offset:3072 sc1
    buffer_load_dwordx4 v[100:103], v2, s[20:23], s79 offen offset:3072 sc1
    v_mfma_f32_32x32x16_bf16 v[160:175], a[176:179], v[108:111], v[160:175]
    v_mfma_f32_32x32x16_bf16 v[144:159], a[180:183], v[104:107], v[144:159]
    v_mfma_f32_32x32x16_bf16 v[192:207], a[180:183], v[108:111], v[192:207]
    s_waitcnt vmcnt(8)
    v_mfma_f32_32x32x16_bf16 v[128:143], a[184:187], v[112:115], v[128:143]
    s_bfe_u32 s78, s49, 0x80010
    s_lshl_b32 s78, s78, 10
    s_add_u32 s79, s78, s89
    s_add_u32 s78, s78, s88
    buffer_load_dwordx4 v[104:107], v2, s[20:23], s78 offen offset:0 sc1
    buffer_load_dwordx4 v[108:111], v2, s[20:23], s79 offen offset:0 sc1
    v_mfma_f32_32x32x16_bf16 v[160:175], a[184:187], v[116:119], v[160:175]
    v_mfma_f32_32x32x16_bf16 v[144:159], a[188:191], v[112:115], v[144:159]
    v_mfma_f32_32x32x16_bf16 v[192:207], a[188:191], v[116:119], v[192:207]
    s_add_u32 s92, s92, 0x20000
    s_mov_b64 exec, 0xff
    buffer_load_dwordx2 v[24:25], v31, s[20:23], s92 offen sc1
    s_mov_b64 exec, -1
    s_waitcnt vmcnt(9)
    v_mfma_f32_32x32x16_bf16 v[128:143], a[192:195], v[120:123], v[128:143]
    buffer_load_dwordx4 v[112:115], v2, s[20:23], s78 offen offset:1024 sc1
    buffer_load_dwordx4 v[116:119], v2, s[20:23], s79 offen offset:1024 sc1
    v_mfma_f32_32x32x16_bf16 v[160:175], a[192:195], v[124:127], v[160:175]
    v_mfma_f32_32x32x16_bf16 v[144:159], a[196:199], v[120:123], v[144:159]
    v_mfma_f32_32x32x16_bf16 v[192:207], a[196:199], v[124:127], v[192:207]
    s_waitcnt vmcnt(9)
    v_mfma_f32_32x32x16_bf16 v[128:143], a[200:203], v[80:83], v[128:143]
    buffer_load_dwordx4 v[120:123], v2, s[20:23], s78 offen offset:2048 sc1
    buffer_load_dwordx4 v[124:127], v2, s[20:23], s79 offen offset:2048 sc1
    v_mfma_f32_32x32x16_bf16 v[160:175], a[200:203], v[84:87], v[160:175]
    v_mfma_f32_32x32x16_bf16 v[144:159], a[204:207], v[80:83], v[144:159]
    v_mfma_f32_32x32x16_bf16 v[192:207], a[204:207], v[84:87], v[192:207]
    s_waitcnt vmcnt(9)
    v_mfma_f32_32x32x16_bf16 v[128:143], a[208:211], v[88:91], v[128:143]
    buffer_load_dwordx4 v[80:83], v2, s[20:23], s78 offen offset:3072 sc1
    buffer_load_dwordx4 v[84:87], v2, s[20:23], s79 offen offset:3072 sc1
    v_mfma_f32_32x32x16_bf16 v[160:175], a[208:211], v[92:95], v[160:175]
    v_mfma_f32_32x32x16_bf16 v[144:159], a[212:215], v[88:91], v[144:159]
    v_mfma_f32_32x32x16_bf16 v[192:207], a[212:215], v[92:95], v[192:207]
    s_waitcnt vmcnt(9)
    v_mfma_f32_32x32x16_bf16 v[128:143], a[216:219], v[96:99], v[128:143]
    v_mfma_f32_32x32x16_bf16 v[160:175], a[216:219], v[100:103], v[160:175]
    v_mfma_f32_32x32x16_bf16 v[144:159], a[220:223], v[96:99], v[144:159]
    v_mfma_f32_32x32x16_bf16 v[192:207], a[220:223], v[100:103], v[192:207]
    s_waitcnt vmcnt(6)
    v_cmp_eq_u64 vcc, v[24:25], v[4:5]
    s_nop 0
    s_and_b64 vcc, vcc, s[86:87]
    s_cmp_eq_u64 vcc, s[86:87]
    s_cbranch_scc1 L_polld_17
    s_mov_b32 s93, 0x20000
L_poll_16:
    s_mov_b64 exec, 0xff
    buffer_load_dwordx2 v[24:25], v31, s[20:23], s92 offen sc1
    s_mov_b64 exec, -1
    s_waitcnt vmcnt(0)
    v_cmp_eq_u64 vcc, v[24:25], v[4:5]
    s_nop 0
    s_and_b64 vcc, vcc, s[86:87]
    s_cmp_eq_u64 vcc, s[86:87]
    s_cbranch_scc1 L_polld_17
    s_sub_u32 s93, s93, 1
    s_cmp_lg_u32 s93, 0
    s_cbranch_scc1 L_poll_16
L_polld_17:
    s_waitcnt lgkmcnt(15)
    v_mfma_f32_32x32x16_bf16 v[128:143], a[224:227], v[104:107], v[128:143]
    s_add_u32 s78, s90, 0
    s_add_u32 s79, s91, 0
    buffer_load_dwordx4 v[176:179], v2, s[20:23], s78 offen offset:0 sc1
    buffer_load_dwordx4 v[180:183], v2, s[20:23], s79 offen offset:0 sc1
    v_mfma_f32_32x32x16_bf16 v[160:175], a[224:227], v[108:111], v[160:175]
    v_mfma_f32_32x32x16_bf16 v[144:159], a[228:231], v[104:107], v[144:159]
    buffer_load_dwordx4 v[184:187], v2, s[20:23], s78 offen offset:1024 sc1
    buffer_load_dwordx4 v[188:191], v2, s[20:23], s79 offen offset:1024 sc1
    v_mfma_f32_32x32x16_bf16 v[192:207], a[228:231], v[108:111], v[192:207]
    s_waitcnt vmcnt(8)
    v_mfma_f32_32x32x16_bf16 v[128:143], a[232:235], v[112:115], v[128:143]
    buffer_load_dwordx4 v[32:35], v2, s[20:23], s78 offen offset:2048 sc1
    buffer_load_dwordx4 v[36:39], v2, s[20:23], s79 offen offset:2048 sc1
    v_mfma_f32_32x32x16_bf16 v[160:175], a[232:235], v[116:119], v[160:175]
    v_mfma_f32_32x32x16_bf16 v[144:159], a[236:239], v[112:115], v[144:159]
    buffer_load_dwordx4 v[40:43], v2, s[20:23], s78 offen offset:3072 sc1
    buffer_load_dwordx4 v[44:47], v2, s[20:23], s79 offen offset:3072 sc1
    v_mfma_f32_32x32x16_bf16 v[192:207], a[236:239], v[116:119], v[192:207]
    s_waitcnt vmcnt(10)
    v_mfma_f32_32x32x16_bf16 v[128:143], a[240:243], v[120:123], v[128:143]
    s_add_u32 s78, s90, 4096
    s_add_u32 s79, s91, 4096
    buffer_load_dwordx4 v[248:251], v2, s[20:23], s78 offen offset:0 sc1
    buffer_load_dwordx4 v[252:255], v2, s[20:23], s79 offen offset:0 sc1
    v_mfma_f32_32x32x16_bf16 v[160:175], a[240:243], v[124:127], v[160:175]
    v_mfma_f32_32x32x16_bf16 v[144:159], a[244:247], v[120:123], v[144:159]
    buffer_load_dwordx4 v[208:211], v2, s[20:23], s78 offen offset:1024 sc1
    buffer_load_dwordx4 v[212:215], v2, s[20:23], s79 offen offset:1024 sc1
    v_mfma_f32_32x32x16_bf16 v[192:207], a[244:247], v[124:127], v[192:207]
    s_waitcnt vmcnt(12)
    v_mfma_f32_32x32x16_bf16 v[128:143], a[248:251], v[80:83], v[128:143]
    buffer_load_dwordx4 v[216:219], v2, s[20:23], s78 offen offset:2048 sc1
    buffer_load_dwordx4 v[220:223], v2, s[20:23], s79 offen offset:2048 sc1
    v_mfma_f32_32x32x16_bf16 v[160:175], a[248:251], v[84:87], v[160:175]
    v_mfma_f32_32x32x16_bf16 v[144:159], a[252:255], v[80:83], v[144:159]
    buffer_load_dwordx4 v[224:227], v2, s[20:23], s78 offen offset:3072 sc1
    buffer_load_dwordx4 v[228:231], v2, s[20:23], s79 offen offset:3072 sc1
    v_mfma_f32_32x32x16_bf16 v[192:207], a[252:255], v[84:87], v[192:207]
    s_waitcnt vmcnt(14)
    s_waitcnt lgkmcnt(0)
    v_mfma_f32_32x32x16_bf16 v[128:143], a[32:35], v[176:179], v[128:143]
    v_mfma_f32_32x32x16_bf16 v[160:175], a[32:35], v[180:183], v[160:175]
    v_mfma_f32_32x32x16_bf16 v[144:159], a[36:39], v[176:179], v[144:159]
    v_mfma_f32_32x32x16_bf16 v[192:207], a[36:39], v[180:183], v[192:207]
    s_waitcnt vmcnt(12)
    v_mfma_f32_32x32x16_bf16 v[128:143], a[40:43], v[184:187], v[128:143]
    v_mfma_f32_32x32x16_bf16 v[160:175], a[40:43], v[188:191], v[160:175]
    v_mfma_f32_32x32x16_bf16 v[144:159], a[44:47], v[184:187], v[144:159]
    v_mfma_f32_32x32x16_bf16 v[192:207], a[44:47], v[188:191], v[192:207]
    s_waitcnt vmcnt(10)
    v_mfma_f32_32x32x16_bf16 v[128:143], a[48:51], v[32:35], v[128:143]
    v_mfma_f32_32x32x16_bf16 v[160:175], a[48:51], v[36:39], v[160:175]
    v_mfma_f32_32x32x16_bf16 v[144:159], a[52:55], v[32:35], v[144:159]
    v_mfma_f32_32x32x16_bf16 v[192:207], a[52:55], v[36:39], v[192:207]
    s_waitcnt vmcnt(8)
    v_mfma_f32_32x32x16_bf16 v[128:143], a[56:59], v[40:43], v[128:143]
    v_mfma_f32_32x32x16_bf16 v[160:175], a[56:59], v[44:47], v[160:175]
    v_mfma_f32_32x32x16_bf16 v[144:159], a[60:63], v[40:43], v[144:159]
    v_mfma_f32_32x32x16_bf16 v[192:207], a[60:63], v[44:47], v[192:207]
    s_waitcnt vmcnt(0)
    v_mfma_f32_32x32x16_bf16 v[144:159], a[68:71], v[248:251], v[144:159]
    v_mfma_f32_32x32x16_bf16 v[144:159], a[76:79], v[208:211], v[144:159]
    v_mfma_f32_32x32x16_bf16 v[144:159], a[84:87], v[216:219], v[144:159]
    v_mfma_f32_32x32x16_bf16 v[144:159], a[92:95], v[224:227], v[144:159]
    v_mfma_f32_32x32x16_bf16 v[160:175], a[64:67], v[252:255], v[160:175]
    v_mfma_f32_32x32x16_bf16 v[160:175], a[72:75], v[212:215], v[160:175]
    v_mfma_f32_32x32x16_bf16 v[160:175], a[80:83], v[220:223], v[160:175]
    s_nop 8
    ds_write_b128 v56, v[144:147] offset:0
    ds_write_b128 v56, v[148:151] offset:1024
    v_mfma_f32_32x32x16_bf16 v[160:175], a[88:91], v[228:231], v[160:175]
    ds_write_b128 v56, v[152:155] offset:2048
    ds_write_b128 v56, v[156:159] offset:3072
    v_mfma_f32_32x32x16_bf16 v[192:207], a[68:71], v[252:255], v[192:207]
    v_mfma_f32_32x32x16_bf16 v[192:207], a[76:79], v[212:215], v[192:207]
    v_mfma_f32_32x32x16_bf16 v[192:207], a[84:87], v[220:223], v[192:207]
    s_nop 6
    ds_write_b128 v56, v[160:163] offset:4096
    ds_write_b128 v56, v[164:167] offset:5120
    v_mfma_f32_32x32x16_bf16 v[192:207], a[92:95], v[228:231], v[192:207]
    ds_write_b128 v56, v[168:171] offset:6144
    ds_write_b128 v56, v[172:175] offset:7168
    v_mfma_f32_32x32x16_bf16 v[128:143], a[64:67], v[248:251], v[128:143]
    v_mfma_f32_32x32x16_bf16 v[128:143], a[72:75], v[208:211], v[128:143]
    v_mfma_f32_32x32x16_bf16 v[128:143], a[80:83], v[216:219], v[128:143]
    s_nop 6
    ds_write_b128 v56, v[192:195] offset:8192
    ds_write_b128 v56, v[196:199] offset:9216
    v_mfma_f32_32x32x16_bf16 v[128:143], a[88:91], v[224:227], v[128:143]
    ds_write_b128 v56, v[200:203] offset:10240
    ds_write_b128 v56, v[204:207] offset:11264
    s_waitcnt lgkmcnt(0)
    s_barrier
    ds_read_b128 v[80:83], v57 offset:0
    ds_read_b128 v[84:87], v57 offset:1024
    ds_read_b128 v[88:91], v57 offset:2048
    ds_read_b128 v[92:95], v57 offset:3072
    ds_read_b128 v[96:99], v58 offset:4096
    ds_read_b128 v[100:103], v58 offset:5120
    ds_read_b128 v[104:107], v58 offset:6144
    ds_read_b128 v[108:111], v58 offset:7168
    ds_read_b128 v[112:115], v59 offset:8192
    ds_read_b128 v[116:119], v59 offset:9216
    ds_read_b128 v[120:123], v59 offset:10240
    ds_read_b128 v[124:127], v59 offset:11264
    s_waitcnt lgkmcnt(8)
    v_pk_add_f32 v[128:129], v[128:129], v[80:81]
    v_pk_add_f32 v[130:131], v[130:131], v[82:83]
    v_pk_add_f32 v[132:133], v[132:133], v[84:85]
    v_pk_add_f32 v[134:135], v[134:135], v[86:87]
    v_pk_add_f32 v[136:137], v[136:137], v[88:89]
    v_pk_add_f32 v[138:139], v[138:139], v[90:91]
    v_pk_add_f32 v[140:141], v[140:141], v[92:93]
    v_pk_add_f32 v[142:143], v[142:143], v[94:95]
    s_waitcnt lgkmcnt(4)
    v_pk_add_f32 v[128:129], v[128:129], v[96:97]
    v_pk_add_f32 v[130:131], v[130:131], v[98:99]
    v_pk_add_f32 v[132:133], v[132:133], v[100:101]
    v_pk_add_f32 v[134:135], v[134:135], v[102:103]
    v_pk_add_f32 v[136:137], v[136:137], v[104:105]
    v_pk_add_f32 v[138:139], v[138:139], v[106:107]
    v_pk_add_f32 v[140:141], v[140:141], v[108:109]
    v_pk_add_f32 v[142:143], v[142:143], v[110:111]
    s_waitcnt lgkmcnt(0)
    v_pk_add_f32 v[128:129], v[128:129], v[112:113]
    v_pk_add_f32 v[130:131], v[130:131], v[114:115]
    v_pk_add_f32 v[132:133], v[132:133], v[116:117]
    v_pk_add_f32 v[134:135], v[134:135], v[118:119]
    v_pk_add_f32 v[136:137], v[136:137], v[120:121]
    v_pk_add_f32 v[138:139], v[138:139], v[122:123]
    v_pk_add_f32 v[140:141], v[140:141], v[124:125]
    v_pk_add_f32 v[142:143], v[142:143], v[126:127]
    v_permlane32_swap_b32 v128, v132
    v_permlane32_swap_b32 v129, v133
    v_permlane32_swap_b32 v130, v134
    v_permlane32_swap_b32 v131, v135
    v_permlane32_swap_b32 v136, v140
    v_permlane32_swap_b32 v137, v141
    v_permlane32_swap_b32 v138, v142
    v_permlane32_swap_b32 v139, v143
    v_pk_add_f32 v[64:65], v[64:65], v[128:129]
    v_pk_add_f32 v[66:67], v[66:67], v[130:131]
    v_pk_add_f32 v[68:69], v[68:69], v[132:133]
    v_pk_add_f32 v[70:71], v[70:71], v[134:135]
    v_pk_add_f32 v[72:73], v[72:73], v[136:137]
    v_pk_add_f32 v[74:75], v[74:75], v[138:139]
    v_pk_add_f32 v[76:77], v[76:77], v[140:141]
    v_pk_add_f32 v[78:79], v[78:79], v[142:143]
    v_cvt_pk_bf16_f32 v32, v64, v65
    v_cvt_pk_bf16_f32 v33, v66, v67
    v_cvt_pk_bf16_f32 v34, v68, v69
    v_cvt_pk_bf16_f32 v35, v70, v71
    v_cvt_pk_bf16_f32 v36, v72, v73
    v_cvt_pk_bf16_f32 v37, v74, v75
    v_cvt_pk_bf16_f32 v38, v76, v77
    v_cvt_pk_bf16_f32 v39, v78, v79
    buffer_store_dwordx4 v[32:35], v27, s[52:55], s72 offen
    buffer_store_dwordx4 v[36:39], v27, s[52:55], s72 offen offset:32
    s_endpgm
A_short:
    v_mov_b32 v232, 0
    v_mov_b32 v64, 0
    v_mov_b32 v233, 0
    v_mov_b32 v65, 0
    v_mov_b32 v234, 0
    v_mov_b32 v66, 0
    v_mov_b32 v235, 0
    v_mov_b32 v67, 0
    v_mov_b32 v236, 0
    v_mov_b32 v68, 0
    v_mov_b32 v237, 0
    v_mov_b32 v69, 0
    v_mov_b32 v238, 0
    v_mov_b32 v70, 0
    v_mov_b32 v239, 0
    v_mov_b32 v71, 0
    v_mov_b32 v240, 0
    v_mov_b32 v72, 0
    v_mov_b32 v241, 0
    v_mov_b32 v73, 0
    v_mov_b32 v242, 0
    v_mov_b32 v74, 0
    v_mov_b32 v243, 0
    v_mov_b32 v75, 0
    v_mov_b32 v244, 0
    v_mov_b32 v76, 0
    v_mov_b32 v245, 0
    v_mov_b32 v77, 0
    v_mov_b32 v246, 0
    v_mov_b32 v78, 0
    v_mov_b32 v247, 0
    v_mov_b32 v79, 0
    v_mov_b32 v228, 0
    v_mov_b32 v229, 0
    v_mov_b32 v230, 0
    v_mov_b32 v231, 0
    s_cmp_le_u32 s85, 1
    s_cbranch_scc1 A_sh1
    s_waitcnt vmcnt(10)
    s_mov_b64 exec, 0xffff
    buffer_store_dwordx2 v[4:5], v3, s[20:23], s51 offen sc1
    s_mov_b64 exec, -1
A_sh1:
    s_bfe_u32 s78, s75, 0x80000
    s_lshl_b32 s78, s78, 10
    s_add_u32 s79, s78, s89
    s_add_u32 s78, s78, s88
    buffer_load_dwordx4 v[80:83], v2, s[20:23], s78 offen offset:0 sc1
    buffer_load_dwordx4 v[84:87], v2, s[20:23], s79 offen offset:0 sc1
    buffer_load_dwordx4 v[88:91], v2, s[20:23], s78 offen offset:1024 sc1
    buffer_load_dwordx4 v[92:95], v2, s[20:23], s79 offen offset:1024 sc1
    buffer_load_dwordx4 v[96:99], v2, s[20:23], s78 offen offset:2048 sc1
    buffer_load_dwordx4 v[100:103], v2, s[20:23], s79 offen offset:2048 sc1
    s_mov_b32 s84, s85
A_sh2:
    buffer_load_dwordx4 v56, s[80:83], s34 offen lds
    buffer_load_dwordx4 v57, s[80:83], s34 offen offset:1024 lds
    s_add_u32 s67, s67, 1
    s_and_b32 s67, s67, 7
    s_lshl_b32 s34, s67, 11
    s_add_u32 m0, s34, s60
    s_lshl_b32 s34, s67, 14
    s_add_u32 s34, s34, s99
    s_sub_u32 s84, s84, 1
    s_cmp_lg_u32 s84, 0
    s_cbranch_scc1 A_sh2
    s_waitcnt lgkmcnt(0)
    s_cmp_eq_u32 s85, 8
    s_cbranch_scc1 A_sh3
    v_mfma_f32_32x32x16_bf16 v[128:143], v[200:203], v[192:195], 0
    s_sub_u32 s84, 7, s85
    s_nop 9
    s_cmp_eq_u32 s85, 7
    s_cbranch_scc1 A_b7
    s_branch A_mid
A_sh3:
    s_cmp_lg_u32 s27, 0
    s_cbranch_scc1 A_sh4
    v_lshrrev_b32 v40, 4, v1
    v_and_b32 v41, 15, v1
    v_lshlrev_b32 v41, 7, v41
    v_lshl_add_u32 v40, v40, 13, v41
    s_mov_b32 s93, 0x20000
A_ep:
    s_mov_b32 s3, 0xf50000
    buffer_load_dwordx2 v[32:33], v40, s[20:23], s3 offen sc1
    s_mov_b32 s3, 0xf58000
    buffer_load_dwordx2 v[34:35], v40, s[20:23], s3 offen sc1
    s_mov_b32 s3, 0xf60000
    buffer_load_dwordx2 v[36:37], v40, s[20:23], s3 offen sc1
    s_mov_b32 s3, 0xf68000
    buffer_load_dwordx2 v[38:39], v40, s[20:23], s3 offen sc1
    s_waitcnt vmcnt(0)
    v_cmp_eq_u64 vcc, v[32:33], v[4:5]
    v_cmp_eq_u64 s[4:5], v[34:35], v[4:5]
    v_cmp_eq_u64 s[6:7], v[36:37], v[4:5]
    s_and_b64 vcc, vcc, s[4:5]
    v_cmp_eq_u64 s[4:5], v[38:39], v[4:5]
    s_and_b64 vcc, vcc, s[6:7]
    s_and_b64 vcc, vcc, s[4:5]
    s_cmp_eq_u64 vcc, -1
    s_cbranch_scc1 A_ep2
    s_sub_u32 s93, s93, 1
    s_cmp_lg_u32 s93, 0
    s_cbranch_scc1 A_ep
A_ep2:
    s_mov_b32 s3, 0xfb0000
    s_mov_b64 exec, 0xffff
    buffer_store_dwordx2 v[4:5], v3, s[20:23], s3 offen sc1
    s_mov_b64 exec, -1
A_sh4:
    v_mfma_f32_32x32x16_bf16 v[128:143], v[200:203], v[192:195], v[160:175]
    s_nop 11
    s_branch A_b8
A_fb:
    v_mov_b32 v60, 0xff800000
    s_mov_b32 s67, 0xffff0000
    v_xor_b32 v144, v60, v160
    v_xor_b32 v145, v60, v161
    v_xor_b32 v146, v60, v162
    v_xor_b32 v147, v60, v163
    v_xor_b32 v148, v60, v164
    v_xor_b32 v149, v60, v165
    v_xor_b32 v150, v60, v166
    v_xor_b32 v151, v60, v167
    v_xor_b32 v152, v60, v168
    v_xor_b32 v153, v60, v169
    v_xor_b32 v154, v60, v170
    v_xor_b32 v155, v60, v171
    v_xor_b32 v156, v60, v172
    v_xor_b32 v157, v60, v173
    v_xor_b32 v158, v60, v174
    v_xor_b32 v159, v60, v175
    v_mov_b32 v208, 0x3f803f80
    v_mov_b32 v209, 0x3f803f80
    v_mov_b32 v210, 0x3f803f80
    v_mov_b32 v211, 0x3f803f80
    v_mov_b32 v212, 0x3f803f80
    v_mov_b32 v213, 0x3f803f80
    v_mov_b32 v214, 0x3f803f80
    v_mov_b32 v215, 0x3f803f80
    v_mov_b32 v216, 0x3f803f80
    v_mov_b32 v217, 0x3f803f80
    v_mov_b32 v218, 0x3f803f80
    v_mov_b32 v219, 0x3f803f80
    v_mov_b32 v220, 0x3f803f80
    v_mov_b32 v221, 0x3f803f80
    v_mov_b32 v222, 0x3f803f80
    v_mov_b32 v223, 0x3f803f80
    v_mov_b32 v6, v12
    v_mov_b32 v7, v13
    s_mov_b32 s84, s85
    v_mov_b32 v60, 0xff800000
A_fb00:
    ds_read_b128 v[200:203], v6 offset:0
    s_waitcnt lgkmcnt(0)
    s_cmp_eq_u32 s84, 0
    s_cbranch_scc1 A_fb00_e
    s_cmp_eq_u32 s84, 8
    s_cbranch_scc1 A_fb00_d
    v_mfma_f32_32x32x16_bf16 v[128:143], v[200:203], v[192:195], 0
    s_branch A_fb00_j
A_fb00_e:
    v_mfma_f32_32x32x16_bf16 v[128:143], v[200:203], v[192:195], v[144:159]
    s_branch A_fb00_j
A_fb00_d:
    v_mfma_f32_32x32x16_bf16 v[128:143], v[200:203], v[192:195], v[160:175]
A_fb00_j:
    s_nop 15
    v_max_f32 v60, v60, v128
    v_max_f32 v60, v60, v129
    v_max_f32 v60, v60, v130
    v_max_f32 v60, v60, v131
    v_max_f32 v60, v60, v132
    v_max_f32 v60, v60, v133
    v_max_f32 v60, v60, v134
    v_max_f32 v60, v60, v135
    v_max_f32 v60, v60, v136
    v_max_f32 v60, v60, v137
    v_max_f32 v60, v60, v138
    v_max_f32 v60, v60, v139
    v_max_f32 v60, v60, v140
    v_max_f32 v60, v60, v141
    v_max_f32 v60, v60, v142
    v_max_f32 v60, v60, v143
    v_add_u32 v6, 1024, v6
    v_add_u32 v7, 2048, v7
    s_add_u32 s84, s84, 1
    s_cmp_le_u32 s84, 8
    s_cbranch_scc1 A_fb00
    v_mov_b32 v61, v60
    s_nop 1
    v_permlane32_swap_b32 v60, v61
    v_max_f32 v60, v60, v61
    v_mov_b32 v6, v12
    v_mov_b32 v7, v13
    s_mov_b32 s84, s85
    v_mov_b32 v232, 0
    v_mov_b32 v233, 0
    v_mov_b32 v234, 0
    v_mov_b32 v235, 0
    v_mov_b32 v236, 0
    v_mov_b32 v237, 0
    v_mov_b32 v238, 0
    v_mov_b32 v239, 0
    v_mov_b32 v240, 0
    v_mov_b32 v241, 0
    v_mov_b32 v242, 0
    v_mov_b32 v243, 0
    v_mov_b32 v244, 0
    v_mov_b32 v245, 0
    v_mov_b32 v246, 0
    v_mov_b32 v247, 0
A_fb01:
    ds_read_b128 v[200:203], v6 offset:0
    s_mov_b64 exec, s[64:65]
    ds_read_b128 v[208:211], v7 offset:0
    ds_read_b128 v[212:215], v7 offset:1024
    s_mov_b64 exec, -1
    s_waitcnt lgkmcnt(0)
    s_cmp_eq_u32 s84, 0
    s_cbranch_scc1 A_fb01_e
    s_cmp_eq_u32 s84, 8
    s_cbranch_scc1 A_fb01_d
    v_mfma_f32_32x32x16_bf16 v[128:143], v[200:203], v[192:195], 0
    s_branch A_fb01_j
A_fb01_e:
    v_mfma_f32_32x32x16_bf16 v[128:143], v[200:203], v[192:195], v[144:159]
    s_branch A_fb01_j
A_fb01_d:
    v_mfma_f32_32x32x16_bf16 v[128:143], v[200:203], v[192:195], v[160:175]
A_fb01_j:
    s_nop 15
    v_sub_f32 v128, v128, v60
    v_sub_f32 v129, v129, v60
    v_sub_f32 v130, v130, v60
    v_sub_f32 v131, v131, v60
    v_sub_f32 v132, v132, v60
    v_sub_f32 v133, v133, v60
    v_sub_f32 v134, v134, v60
    v_sub_f32 v135, v135, v60
    v_sub_f32 v136, v136, v60
    v_sub_f32 v137, v137, v60
    v_sub_f32 v138, v138, v60
    v_sub_f32 v139, v139, v60
    v_sub_f32 v140, v140, v60
    v_sub_f32 v141, v141, v60
    v_sub_f32 v142, v142, v60
    v_sub_f32 v143, v143, v60
    v_exp_f32 v128, v128
    v_exp_f32 v129, v129
    v_exp_f32 v130, v130
    v_exp_f32 v131, v131
    v_exp_f32 v132, v132
    v_exp_f32 v133, v133
    v_exp_f32 v134, v134
    v_exp_f32 v135, v135
    v_exp_f32 v136, v136
    v_exp_f32 v137, v137
    v_exp_f32 v138, v138
    v_exp_f32 v139, v139
    v_exp_f32 v140, v140
    v_exp_f32 v141, v141
    v_exp_f32 v142, v142
    v_exp_f32 v143, v143
    v_cvt_pk_bf16_f32 v224, v128, v129
    v_cvt_pk_bf16_f32 v225, v130, v131
    v_cvt_pk_bf16_f32 v226, v132, v133
    v_cvt_pk_bf16_f32 v227, v134, v135
    v_cvt_pk_bf16_f32 v228, v136, v137
    v_cvt_pk_bf16_f32 v229, v138, v139
    v_cvt_pk_bf16_f32 v230, v140, v141
    v_cvt_pk_bf16_f32 v231, v142, v143
    v_mfma_f32_32x32x16_bf16 v[232:247], v[208:211], v[224:227], v[232:247]
    s_nop 0
    v_mfma_f32_32x32x16_bf16 v[232:247], v[212:215], v[228:231], v[232:247]
    v_add_u32 v6, 1024, v6
    v_add_u32 v7, 2048, v7
    s_add_u32 s84, s84, 1
    s_cmp_le_u32 s84, 8
    s_cbranch_scc1 A_fb01
    v_mov_b32 v6, v12
    v_mov_b32 v7, v13
    s_mov_b32 s84, s85
    v_mov_b32 v60, 0xff800000
A_fb10:
    ds_read_b128 v[200:203], v6 offset:12288
    s_waitcnt lgkmcnt(0)
    s_cmp_eq_u32 s84, 0
    s_cbranch_scc1 A_fb10_e
    s_cmp_eq_u32 s84, 8
    s_cbranch_scc1 A_fb10_d
    v_mfma_f32_32x32x16_bf16 v[128:143], v[200:203], v[196:199], 0
    s_branch A_fb10_j
A_fb10_e:
    v_mfma_f32_32x32x16_bf16 v[128:143], v[200:203], v[196:199], v[144:159]
    s_branch A_fb10_j
A_fb10_d:
    v_mfma_f32_32x32x16_bf16 v[128:143], v[200:203], v[196:199], v[160:175]
A_fb10_j:
    s_nop 15
    v_max_f32 v60, v60, v128
    v_max_f32 v60, v60, v129
    v_max_f32 v60, v60, v130
    v_max_f32 v60, v60, v131
    v_max_f32 v60, v60, v132
    v_max_f32 v60, v60, v133
    v_max_f32 v60, v60, v134
    v_max_f32 v60, v60, v135
    v_max_f32 v60, v60, v136
    v_max_f32 v60, v60, v137
    v_max_f32 v60, v60, v138
    v_max_f32 v60, v60, v139
    v_max_f32 v60, v60, v140
    v_max_f32 v60, v60, v141
    v_max_f32 v60, v60, v142
    v_max_f32 v60, v60, v143
    v_add_u32 v6, 1024, v6
    v_add_u32 v7, 2048, v7
    s_add_u32 s84, s84, 1
    s_cmp_le_u32 s84, 8
    s_cbranch_scc1 A_fb10
    v_mov_b32 v61, v60
    s_nop 1
    v_permlane32_swap_b32 v60, v61
    v_max_f32 v60, v60, v61
    v_mov_b32 v6, v12
    v_mov_b32 v7, v13
    s_mov_b32 s84, s85
    v_mov_b32 v64, 0
    v_mov_b32 v65, 0
    v_mov_b32 v66, 0
    v_mov_b32 v67, 0
    v_mov_b32 v68, 0
    v_mov_b32 v69, 0
    v_mov_b32 v70, 0
    v_mov_b32 v71, 0
    v_mov_b32 v72, 0
    v_mov_b32 v73, 0
    v_mov_b32 v74, 0
    v_mov_b32 v75, 0
    v_mov_b32 v76, 0
    v_mov_b32 v77, 0
    v_mov_b32 v78, 0
    v_mov_b32 v79, 0
A_fb11:
    ds_read_b128 v[200:203], v6 offset:12288
    s_mov_b64 exec, s[66:67]
    ds_read_b128 v[216:219], v7 offset:0
    ds_read_b128 v[220:223], v7 offset:1024
    s_mov_b64 exec, -1
    s_waitcnt lgkmcnt(0)
    s_cmp_eq_u32 s84, 0
    s_cbranch_scc1 A_fb11_e
    s_cmp_eq_u32 s84, 8
    s_cbranch_scc1 A_fb11_d
    v_mfma_f32_32x32x16_bf16 v[128:143], v[200:203], v[196:199], 0
    s_branch A_fb11_j
A_fb11_e:
    v_mfma_f32_32x32x16_bf16 v[128:143], v[200:203], v[196:199], v[144:159]
    s_branch A_fb11_j
A_fb11_d:
    v_mfma_f32_32x32x16_bf16 v[128:143], v[200:203], v[196:199], v[160:175]
A_fb11_j:
    s_nop 15
    v_sub_f32 v128, v128, v60
    v_sub_f32 v129, v129, v60
    v_sub_f32 v130, v130, v60
    v_sub_f32 v131, v131, v60
    v_sub_f32 v132, v132, v60
    v_sub_f32 v133, v133, v60
    v_sub_f32 v134, v134, v60
    v_sub_f32 v135, v135, v60
    v_sub_f32 v136, v136, v60
    v_sub_f32 v137, v137, v60
    v_sub_f32 v138, v138, v60
    v_sub_f32 v139, v139, v60
    v_sub_f32 v140, v140, v60
    v_sub_f32 v141, v141, v60
    v_sub_f32 v142, v142, v60
    v_sub_f32 v143, v143, v60
    v_exp_f32 v128, v128
    v_exp_f32 v129, v129
    v_exp_f32 v130, v130
    v_exp_f32 v131, v131
    v_exp_f32 v132, v132
    v_exp_f32 v133, v133
    v_exp_f32 v134, v134
    v_exp_f32 v135, v135
    v_exp_f32 v136, v136
    v_exp_f32 v137, v137
    v_exp_f32 v138, v138
    v_exp_f32 v139, v139
    v_exp_f32 v140, v140
    v_exp_f32 v141, v141
    v_exp_f32 v142, v142
    v_exp_f32 v143, v143
    v_cvt_pk_bf16_f32 v224, v128, v129
    v_cvt_pk_bf16_f32 v225, v130, v131
    v_cvt_pk_bf16_f32 v226, v132, v133
    v_cvt_pk_bf16_f32 v227, v134, v135
    v_cvt_pk_bf16_f32 v228, v136, v137
    v_cvt_pk_bf16_f32 v229, v138, v139
    v_cvt_pk_bf16_f32 v230, v140, v141
    v_cvt_pk_bf16_f32 v231, v142, v143
    v_mfma_f32_32x32x16_bf16 v[64:79], v[216:219], v[224:227], v[64:79]
    s_nop 0
    v_mfma_f32_32x32x16_bf16 v[64:79], v[220:223], v[228:231], v[64:79]
    v_add_u32 v6, 1024, v6
    v_add_u32 v7, 2048, v7
    s_add_u32 s84, s84, 1
    s_cmp_le_u32 s84, 8
    s_cbranch_scc1 A_fb11
    s_nop 15
    v_rcp_f32 v216, v240
    v_rcp_f32 v217, v64
    s_nop 4
    s_branch A_fin2
L_end:
    s_endpgm
.section .rodata,"a"
.p2align 6
.amdhsa_kernel parallel_sum__sliding_block__swiglu_ffn__prompt_kernel
  .amdhsa_next_free_vgpr 512
  .amdhsa_next_free_sgpr 102
  .amdhsa_accum_offset 256
  .amdhsa_group_segment_fixed_size 0
  .amdhsa_kernarg_size 80
  .amdhsa_user_sgpr_count 2
  .amdhsa_user_sgpr_kernarg_segment_ptr 1
  .amdhsa_system_sgpr_workgroup_id_x 1
.end_amdhsa_kernel
```
